```python
import torch

def _softmax(x, axis=-1):
    return torch.softmax(x, dim=axis)

def _gelu(x):
    return torch.nn.functional.gelu(x, approximate='tanh')

def _silu(x):
    return torch.nn.functional.silu(x)

def _sigmoid(x):
    return torch.sigmoid(x)

def _layernorm(x, axis=-1, eps=1e-05):
    m = x.mean(dim=axis, keepdim=True)
    v = x.var(dim=axis, keepdim=True, unbiased=False)
    return (x - m) / torch.sqrt(v + eps)

def _scatter_add(tgt, idx, src, axis=0):
    return tgt.clone().index_add_(axis, idx, src)

def _segment_sum(src, seg, n):
    out = torch.zeros((n,) + src.shape[1:], dtype=src.dtype)
    return out.index_add_(0, seg, src)

def _pad(x, pw):
    flat = tuple((v for pair in reversed(pw) for v in pair))
    return torch.nn.functional.pad(x, flat)
kernel_name = 'parallel_sum__memory_aug_recurrent_mem_tr__dense_activation_silu__prompt'

def setup_inputs():

    _w = lambda a: (lambda t: t.to(torch.bfloat16) if t.is_floating_point() else t)(torch.as_tensor(a))

    def _A_setup():
        B, S, Dm = (1, 2048, 448)
        H, Dh = (16, 256)
        M, seg = (8, 32)
        seg = min(seg, S)
        S = S // seg * seg
        return {'x': _w((lambda *s: torch.randn(*s, dtype=torch.bfloat16) * 0.05)(B, S, Dm)), 'mem0': _w((lambda *s: torch.randn(*s, dtype=torch.bfloat16) * 0.2)(B, M, Dm)), 'Wq': _w((lambda *s: torch.randn(*s, dtype=torch.bfloat16) * 1.6)(Dm, H, Dh) * Dm ** (-0.5)), 'Wk': _w((lambda *s: torch.randn(*s, dtype=torch.bfloat16) * 1.6)(Dm, H, Dh) * Dm ** (-0.5)), 'Wv': _w((lambda *s: torch.randn(*s, dtype=torch.bfloat16) * 0.2)(Dm, H, Dh) * Dm ** (-0.5)), 'Wo': _w((lambda *s: torch.randn(*s, dtype=torch.bfloat16) * 0.2)(H, Dh, Dm) * (H * Dh) ** (-0.5)), 'seg_len': seg}
    _A_in = _A_setup()

    def _B_setup():
        B, S, D, F = (1, 2048, 448, 1792)
        return {'x': _w((lambda *s: torch.randn(*s, dtype=torch.bfloat16) * 0.05)(B, S, D)), 'w1': _w((lambda *s: torch.randn(*s, dtype=torch.bfloat16) * 0.8)(D, F) * D ** (-0.5)), 'w2': _w((lambda *s: torch.randn(*s, dtype=torch.bfloat16) * 0.1)(F, D) * F ** (-0.5))}
    _B_in = _B_setup()
    return {'A_x': _A_in['x'], 'A_mem0': _A_in['mem0'], 'A_Wq': _A_in['Wq'], 'A_Wk': _A_in['Wk'], 'A_Wv': _A_in['Wv'], 'A_Wo': _A_in['Wo'], 'A_seg_len': _A_in['seg_len'], 'B_x': _B_in['x'], 'B_w1': _B_in['w1'], 'B_w2': _B_in['w2']}

def reference(A_x, A_mem0, A_Wq, A_Wk, A_Wv, A_Wo, A_seg_len, B_x, B_w1, B_w2):

    def _A_ref(x, mem0, Wq, Wk, Wv, Wo, seg_len):
        B, S, Dm = x.shape
        H, Dh = (Wq.shape[1], Wq.shape[2])
        M = mem0.shape[1]
        scale = Dh ** (-0.5)
        n_seg = S // seg_len
        L = M + seg_len
        idx = torch.arange(L)
        mask = (idx[:, None] < M) | (idx[:, None] >= idx[None, :])
        mem = mem0
        outs = []
        for s in range(n_seg):
            xs = x[:, s * seg_len:(s + 1) * seg_len, :].clone()
            h = torch.concatenate([mem, xs], axis=1)
            q = torch.einsum('btd,dhe->bhte', h, Wq)
            k = torch.einsum('btd,dhe->bhte', h, Wk)
            v = torch.einsum('btd,dhe->bhte', h, Wv)
            scores = torch.einsum('bhqe,bhke->bhqk', q, k) * scale
            scores = torch.where(mask[None, None], scores, -1000000000.0)
            p = _softmax(scores, axis=-1)
            o = torch.einsum('bhqk,bhke->bhqe', p, v)
            o = torch.einsum('bhte,hed->btd', o, Wo)
            mem = o[:, :M, :].clone()
            outs.append(o[:, M:, :])
        return torch.concatenate(outs, axis=1)

    def _B_ref(x, w1, w2):
        h = torch.einsum('bsd,df->bsf', x, w1)
        h = _silu(h)
        out = torch.einsum('bsf,fd->bsd', h, w2)
        return out
    x = A_x
    xn = _layernorm(x, axis=-1)
    return x + _A_ref(xn, A_mem0, A_Wq, A_Wk, A_Wv, A_Wo, A_seg_len) + _B_ref(xn, B_w1, B_w2)
```

```asm
; @launch grid=(256,1,1) block=(256,1,1) lds=163840
.amdgcn_target "amdgcn-amd-amdhsa--gfx950"
.text
.globl parallel_sum__memory_aug_recurrent_mem_tr__dense_activation_silu__prompt_kernel
.p2align 8
.type parallel_sum__memory_aug_recurrent_mem_tr__dense_activation_silu__prompt_kernel,@function
parallel_sum__memory_aug_recurrent_mem_tr__dense_activation_silu__prompt_kernel:
    s_load_dwordx2 s[36:37], s[0:1], 0
    s_load_dwordx8 s[40:47], s[0:1], 64
    s_load_dwordx2 s[48:49], s[0:1], 96
    s_load_dwordx4 s[72:75], s[0:1], 0
    s_load_dwordx8 s[76:83], s[0:1], 16
    v_lshrrev_b32 v2, 6, v0
    v_and_b32 v1, 63, v0
    s_nop 0
    v_readfirstlane_b32 s20, v2
    s_getreg_b32 s21, hwreg(HW_REG_XCC_ID, 0, 4)
    s_mov_b32 s23, 0x100000
    s_waitcnt lgkmcnt(0)
    s_mov_b32 s4, s48
    s_mov_b32 s5, s49
    s_mov_b32 s6, 0x10000000
    s_mov_b32 s7, 0x20000
    s_mov_b32 s16, s46
    s_mov_b32 s17, s47
    s_mov_b32 s18, 0x100
    s_mov_b32 s19, 0x20000
    s_cmp_ge_u32 s21, 8
    s_cbranch_scc1 M_exit
    s_cmp_ge_u32 s2, 256
    s_cbranch_scc1 M_end
    s_cmp_lg_u32 s20, 0
    s_cbranch_scc1 M_tk
    s_lshl_b32 s22, s21, 4
    v_mov_b32 v255, 1
    s_mov_b64 exec, 1
    buffer_atomic_add v255, off, s[16:19], s22 sc0
    s_mov_b64 exec, -1
M_tk:
    s_and_b32 s65, s2, 7
    s_lshr_b32 s66, s2, 3
    s_cmp_lg_u32 s65, 0
    s_cbranch_scc1 J_role
L_role:
    s_lshl_b32 s24, s66, 2
    s_add_u32 s24, s24, s20
    v_lshlrev_b32 v12, 4, v1
    v_and_b32 v10, 15, v1
    v_lshrrev_b32 v11, 4, v1
    s_mov_b32 s64, s66
    s_mov_b32 s8, s72
    s_mov_b32 s9, s73
    s_mov_b32 s10, 0x1c0000
    s_mov_b32 s11, 0x20000
    s_lshl_b32 s27, s64, 2
    s_add_u32 s27, s27, s20
    s_mul_i32 s27, s27, 3584
    v_mul_u32_u24 v13, 0x380, v11
    v_lshl_add_u32 v13, v10, 3, v13
    buffer_load_dwordx2 v[230:231], v13, s[8:11], s27 offen offset:0
    buffer_load_dwordx2 v[232:233], v13, s[8:11], s27 offen offset:128
    buffer_load_dwordx2 v[234:235], v13, s[8:11], s27 offen offset:256
    buffer_load_dwordx2 v[236:237], v13, s[8:11], s27 offen offset:384
    buffer_load_dwordx2 v[238:239], v13, s[8:11], s27 offen offset:512
    buffer_load_dwordx2 v[240:241], v13, s[8:11], s27 offen offset:640
    buffer_load_dwordx2 v[242:243], v13, s[8:11], s27 offen offset:768
    v_mov_b32 v4, -1
    v_mov_b32 v244, 0
    v_mov_b32 v5, -1
    v_mov_b32 v245, 0
    v_mov_b32 v6, -1
    v_mov_b32 v246, 0
    v_mov_b32 v7, -1
    v_mov_b32 v247, 0
    s_cmp_lg_u32 s24, 1
    s_cbranch_scc1 L_nz
    s_mov_b32 s26, 0x3fc8000
    v_lshrrev_b32 v13, 3, v1
    v_mul_u32_u24 v13, 512, v13
    v_bfe_u32 v14, v1, 1, 2
    v_mul_u32_u24 v14, 128, v14
    v_add_u32 v13, v13, v14
    v_and_b32 v14, 1, v1
    v_lshl_add_u32 v13, v14, 4, v13
    buffer_store_dwordx4 v[244:247], v13, s[4:7], s26 offen sc1
    s_add_u32 s26, s26, 4096
    buffer_store_dwordx4 v[244:247], v13, s[4:7], s26 offen sc1
    s_add_u32 s26, s26, 4096
    buffer_store_dwordx4 v[244:247], v13, s[4:7], s26 offen sc1
    s_add_u32 s26, s26, 4096
    buffer_store_dwordx4 v[244:247], v13, s[4:7], s26 offen sc1
    s_add_u32 s26, s26, 4096
    buffer_store_dwordx4 v[244:247], v12, s[4:7], s26 offen sc1
    s_waitcnt vmcnt(0)
    v_mov_b32 v13, 1
    s_mov_b64 exec, 1
    buffer_store_dword v13, off, s[16:19], 0 offset:128 sc1
    s_mov_b64 exec, -1
L_nz:
    s_lshl_b32 s26, s66, 12
    v_lshlrev_b32 v3, 4, v0
    v_add_u32 v3, s26, v3
    s_add_u32 s12, s48, 0x1140000
    s_addc_u32 s13, s49, 0
    s_mov_b32 s14, 0x7000
    s_mov_b32 s15, 0x20000
    buffer_store_dwordx4 v[244:247], v3, s[12:15], 0 offen sc1
    s_add_u32 s12, s48, 0x1031c00
    s_addc_u32 s13, s49, 0
    s_mov_b32 s14, 0x6e400
    s_mov_b32 s15, 0x20000
    s_mov_b32 s26, 0x0
    buffer_store_dwordx4 v[4:7], v3, s[12:15], s26 offen sc1
    s_mov_b32 s26, 0x20000
    buffer_store_dwordx4 v[4:7], v3, s[12:15], s26 offen sc1
    s_mov_b32 s26, 0x40000
    buffer_store_dwordx4 v[4:7], v3, s[12:15], s26 offen sc1
    s_mov_b32 s26, 0x60000
    buffer_store_dwordx4 v[4:7], v3, s[12:15], s26 offen sc1
    s_add_u32 s12, s48, 0xfc1c00
    s_addc_u32 s13, s49, 0
    s_mov_b32 s14, 0x6e400
    s_mov_b32 s15, 0x20000
    s_mov_b32 s26, 0x0
    buffer_store_dwordx4 v[4:7], v3, s[12:15], s26 offen sc1
    s_mov_b32 s26, 0x20000
    buffer_store_dwordx4 v[4:7], v3, s[12:15], s26 offen sc1
    s_mov_b32 s26, 0x40000
    buffer_store_dwordx4 v[4:7], v3, s[12:15], s26 offen sc1
    s_mov_b32 s26, 0x60000
    buffer_store_dwordx4 v[4:7], v3, s[12:15], s26 offen sc1
    s_add_u32 s12, s48, 0x10a0000
    s_addc_u32 s13, s49, 0
    s_mov_b32 s14, 0xa0000
    s_mov_b32 s15, 0x20000
    s_mov_b32 s26, 0x0
    buffer_store_dwordx4 v[4:7], v3, s[12:15], s26 offen sc1
    s_mov_b32 s26, 0x20000
    buffer_store_dwordx4 v[4:7], v3, s[12:15], s26 offen sc1
    s_mov_b32 s26, 0x40000
    buffer_store_dwordx4 v[4:7], v3, s[12:15], s26 offen sc1
    s_mov_b32 s26, 0x60000
    buffer_store_dwordx4 v[4:7], v3, s[12:15], s26 offen sc1
    s_mov_b32 s26, 0x80000
    buffer_store_dwordx4 v[4:7], v3, s[12:15], s26 offen sc1
    s_add_u32 s12, s48, 0x342c000
    s_addc_u32 s13, s49, 0
    s_mov_b32 s14, 0x1c000
    s_mov_b32 s15, 0x20000
    s_mov_b32 s26, 0x0
    buffer_store_dwordx4 v[4:7], v3, s[12:15], s26 offen sc1
    s_add_u32 s12, s48, 0x36be000
    s_addc_u32 s13, s49, 0
    s_mov_b32 s14, 0xa000
    s_mov_b32 s15, 0x20000
    s_mov_b32 s26, 0x0
    buffer_store_dwordx4 v[4:7], v3, s[12:15], s26 offen sc1
    s_cmp_lg_u32 s24, 0
    s_cbranch_scc1 L_end
    s_mov_b32 s52, s74
    s_mov_b32 s53, s75
    s_mov_b32 s54, 0x1c00
    s_mov_b32 s55, 0x20000
    v_lshrrev_b32 v11, 4, v1
    v_and_b32 v13, 7, v1
    v_mul_u32_u24 v13, 0x380, v13
    v_bfe_u32 v14, v1, 3, 1
    v_lshl_add_u32 v13, v14, 6, v13
    v_lshl_add_u32 v13, v11, 4, v13
    buffer_load_dwordx4 v[140:143], v13, s[52:55], 0 offen offset:0
    buffer_load_dwordx4 v[144:147], v13, s[52:55], 0 offen offset:128
    buffer_load_dwordx4 v[148:151], v13, s[52:55], 0 offen offset:256
    buffer_load_dwordx4 v[152:155], v13, s[52:55], 0 offen offset:384
    buffer_load_dwordx4 v[156:159], v13, s[52:55], 0 offen offset:512
    buffer_load_dwordx4 v[160:163], v13, s[52:55], 0 offen offset:640
    buffer_load_dwordx4 v[164:167], v13, s[52:55], 0 offen offset:768
    s_waitcnt vmcnt(0)
    v_min_u32 v140, -2, v140
    v_min_u32 v141, -2, v141
    v_min_u32 v142, -2, v142
    v_min_u32 v143, -2, v143
    v_min_u32 v144, -2, v144
    v_min_u32 v145, -2, v145
    v_min_u32 v146, -2, v146
    v_min_u32 v147, -2, v147
    v_min_u32 v148, -2, v148
    v_min_u32 v149, -2, v149
    v_min_u32 v150, -2, v150
    v_min_u32 v151, -2, v151
    v_min_u32 v152, -2, v152
    v_min_u32 v153, -2, v153
    v_min_u32 v154, -2, v154
    v_min_u32 v155, -2, v155
    v_min_u32 v156, -2, v156
    v_min_u32 v157, -2, v157
    v_min_u32 v158, -2, v158
    v_min_u32 v159, -2, v159
    v_min_u32 v160, -2, v160
    v_min_u32 v161, -2, v161
    v_min_u32 v162, -2, v162
    v_min_u32 v163, -2, v163
    v_min_u32 v164, -2, v164
    v_min_u32 v165, -2, v165
    v_min_u32 v166, -2, v166
    v_min_u32 v167, -2, v167
    s_mov_b32 s26, 0xfc0000
    buffer_store_dwordx4 v[140:143], v12, s[4:7], s26 offen sc1
    s_mov_b32 s26, 0xfc0400
    buffer_store_dwordx4 v[144:147], v12, s[4:7], s26 offen sc1
    s_mov_b32 s26, 0xfc0800
    buffer_store_dwordx4 v[148:151], v12, s[4:7], s26 offen sc1
    s_mov_b32 s26, 0xfc0c00
    buffer_store_dwordx4 v[152:155], v12, s[4:7], s26 offen sc1
    s_mov_b32 s26, 0xfc1000
    buffer_store_dwordx4 v[156:159], v12, s[4:7], s26 offen sc1
    s_mov_b32 s26, 0xfc1400
    buffer_store_dwordx4 v[160:163], v12, s[4:7], s26 offen sc1
    s_mov_b32 s26, 0xfc1800
    buffer_store_dwordx4 v[164:167], v12, s[4:7], s26 offen sc1
    s_mov_b32 s26, 0x1030000
    buffer_store_dwordx4 v[140:143], v12, s[4:7], s26 offen sc1
    s_mov_b32 s26, 0x1030400
    buffer_store_dwordx4 v[144:147], v12, s[4:7], s26 offen sc1
    s_mov_b32 s26, 0x1030800
    buffer_store_dwordx4 v[148:151], v12, s[4:7], s26 offen sc1
    s_mov_b32 s26, 0x1030c00
    buffer_store_dwordx4 v[152:155], v12, s[4:7], s26 offen sc1
    s_mov_b32 s26, 0x1031000
    buffer_store_dwordx4 v[156:159], v12, s[4:7], s26 offen sc1
    s_mov_b32 s26, 0x1031400
    buffer_store_dwordx4 v[160:163], v12, s[4:7], s26 offen sc1
    s_mov_b32 s26, 0x1031800
    buffer_store_dwordx4 v[164:167], v12, s[4:7], s26 offen sc1
L_end:
    s_waitcnt vmcnt(16)
    v_lshlrev_b32 v32, 16, v230
    v_and_b32 v33, 0xffff0000, v230
    v_lshlrev_b32 v34, 16, v231
    v_and_b32 v35, 0xffff0000, v231
    v_lshlrev_b32 v36, 16, v232
    v_and_b32 v37, 0xffff0000, v232
    v_lshlrev_b32 v38, 16, v233
    v_and_b32 v39, 0xffff0000, v233
    v_lshlrev_b32 v40, 16, v234
    v_and_b32 v41, 0xffff0000, v234
    v_lshlrev_b32 v42, 16, v235
    v_and_b32 v43, 0xffff0000, v235
    v_lshlrev_b32 v44, 16, v236
    v_and_b32 v45, 0xffff0000, v236
    v_lshlrev_b32 v46, 16, v237
    v_and_b32 v47, 0xffff0000, v237
    v_lshlrev_b32 v48, 16, v238
    v_and_b32 v49, 0xffff0000, v238
    v_lshlrev_b32 v50, 16, v239
    v_and_b32 v51, 0xffff0000, v239
    v_lshlrev_b32 v52, 16, v240
    v_and_b32 v53, 0xffff0000, v240
    v_lshlrev_b32 v54, 16, v241
    v_and_b32 v55, 0xffff0000, v241
    v_lshlrev_b32 v56, 16, v242
    v_and_b32 v57, 0xffff0000, v242
    v_lshlrev_b32 v58, 16, v243
    v_and_b32 v59, 0xffff0000, v243
    v_mov_b32 v16, v32
    v_mov_b32 v17, v33
    v_mov_b32 v18, v34
    v_mov_b32 v19, v35
    v_add_f32 v16, v16, v36
    v_add_f32 v17, v17, v37
    v_add_f32 v18, v18, v38
    v_add_f32 v19, v19, v39
    v_add_f32 v16, v16, v40
    v_add_f32 v17, v17, v41
    v_add_f32 v18, v18, v42
    v_add_f32 v19, v19, v43
    v_add_f32 v16, v16, v44
    v_add_f32 v17, v17, v45
    v_add_f32 v18, v18, v46
    v_add_f32 v19, v19, v47
    v_add_f32 v16, v16, v48
    v_add_f32 v17, v17, v49
    v_add_f32 v18, v18, v50
    v_add_f32 v19, v19, v51
    v_add_f32 v16, v16, v52
    v_add_f32 v17, v17, v53
    v_add_f32 v18, v18, v54
    v_add_f32 v19, v19, v55
    v_add_f32 v16, v16, v56
    v_add_f32 v17, v17, v57
    v_add_f32 v18, v18, v58
    v_add_f32 v19, v19, v59
    v_add_f32 v16, v16, v17
    v_add_f32 v18, v18, v19
    v_add_f32 v16, v16, v18
    s_nop 1
    v_add_f32_dpp v16, v16, v16 row_ror:8 row_mask:0xf bank_mask:0xf
    s_nop 1
    v_add_f32_dpp v16, v16, v16 row_ror:4 row_mask:0xf bank_mask:0xf
    s_nop 1
    v_add_f32_dpp v16, v16, v16 row_ror:2 row_mask:0xf bank_mask:0xf
    s_nop 1
    v_add_f32_dpp v16, v16, v16 row_ror:1 row_mask:0xf bank_mask:0xf
    v_mul_f32 v20, 0x3b124925, v16
    v_sub_f32 v21, v32, v20
    v_mul_f32 v16, v21, v21
    v_sub_f32 v21, v33, v20
    v_mul_f32 v17, v21, v21
    v_sub_f32 v21, v34, v20
    v_mul_f32 v18, v21, v21
    v_sub_f32 v21, v35, v20
    v_mul_f32 v19, v21, v21
    v_sub_f32 v21, v36, v20
    v_fmac_f32 v16, v21, v21
    v_sub_f32 v22, v37, v20
    v_fmac_f32 v17, v22, v22
    v_sub_f32 v21, v38, v20
    v_fmac_f32 v18, v21, v21
    v_sub_f32 v22, v39, v20
    v_fmac_f32 v19, v22, v22
    v_sub_f32 v21, v40, v20
    v_fmac_f32 v16, v21, v21
    v_sub_f32 v22, v41, v20
    v_fmac_f32 v17, v22, v22
    v_sub_f32 v21, v42, v20
    v_fmac_f32 v18, v21, v21
    v_sub_f32 v22, v43, v20
    v_fmac_f32 v19, v22, v22
    v_sub_f32 v21, v44, v20
    v_fmac_f32 v16, v21, v21
    v_sub_f32 v22, v45, v20
    v_fmac_f32 v17, v22, v22
    v_sub_f32 v21, v46, v20
    v_fmac_f32 v18, v21, v21
    v_sub_f32 v22, v47, v20
    v_fmac_f32 v19, v22, v22
    v_sub_f32 v21, v48, v20
    v_fmac_f32 v16, v21, v21
    v_sub_f32 v22, v49, v20
    v_fmac_f32 v17, v22, v22
    v_sub_f32 v21, v50, v20
    v_fmac_f32 v18, v21, v21
    v_sub_f32 v22, v51, v20
    v_fmac_f32 v19, v22, v22
    v_sub_f32 v21, v52, v20
    v_fmac_f32 v16, v21, v21
    v_sub_f32 v22, v53, v20
    v_fmac_f32 v17, v22, v22
    v_sub_f32 v21, v54, v20
    v_fmac_f32 v18, v21, v21
    v_sub_f32 v22, v55, v20
    v_fmac_f32 v19, v22, v22
    v_sub_f32 v21, v56, v20
    v_fmac_f32 v16, v21, v21
    v_sub_f32 v22, v57, v20
    v_fmac_f32 v17, v22, v22
    v_sub_f32 v21, v58, v20
    v_fmac_f32 v18, v21, v21
    v_sub_f32 v22, v59, v20
    v_fmac_f32 v19, v22, v22
    v_add_f32 v16, v16, v17
    v_add_f32 v18, v18, v19
    v_add_f32 v16, v16, v18
    s_nop 1
    v_add_f32_dpp v16, v16, v16 row_ror:8 row_mask:0xf bank_mask:0xf
    s_nop 1
    v_add_f32_dpp v16, v16, v16 row_ror:4 row_mask:0xf bank_mask:0xf
    s_nop 1
    v_add_f32_dpp v16, v16, v16 row_ror:2 row_mask:0xf bank_mask:0xf
    s_nop 1
    v_add_f32_dpp v16, v16, v16 row_ror:1 row_mask:0xf bank_mask:0xf
    v_mul_f32 v16, 0x3b124925, v16
    v_cvt_pk_bf16_f32 v16, v16, v16
    v_lshlrev_b32 v16, 16, v16
    v_add_f32 v16, 0x3727c5ac, v16
    v_cvt_pk_bf16_f32 v16, v16, v16
    v_lshlrev_b32 v16, 16, v16
    v_sqrt_f32 v16, v16
    s_nop 0
    v_cvt_pk_bf16_f32 v16, v16, v16
    v_lshlrev_b32 v16, 16, v16
    v_rcp_f32 v16, v16
    v_cvt_pk_bf16_f32 v20, v20, v20
    v_lshlrev_b32 v20, 16, v20
    s_lshl_b32 s26, s20, 2
    v_add_u32 v13, s26, v11
    v_lshrrev_b32 v14, 1, v13
    v_lshrrev_b32 v15, 1, v10
    v_xor_b32 v14, v14, v15
    v_mul_u32_u24 v13, 0x380, v13
    v_lshl_add_u32 v13, v14, 4, v13
    v_and_b32 v14, 1, v10
    v_lshl_add_u32 v13, v14, 3, v13
    v_sub_f32 v32, v32, v20
    v_sub_f32 v33, v33, v20
    v_cvt_pk_bf16_f32 v21, v32, v33
    v_lshlrev_b32 v32, 16, v21
    v_and_b32 v33, 0xffff0000, v21
    v_mul_f32 v32, v16, v32
    v_mul_f32 v33, v16, v33
    v_cvt_pk_bf16_f32 v230, v32, v33
    v_sub_f32 v34, v34, v20
    v_sub_f32 v35, v35, v20
    v_cvt_pk_bf16_f32 v21, v34, v35
    v_lshlrev_b32 v34, 16, v21
    v_and_b32 v35, 0xffff0000, v21
    v_mul_f32 v34, v16, v34
    v_mul_f32 v35, v16, v35
    v_cvt_pk_bf16_f32 v231, v34, v35
    ds_write_b64 v13, v[230:231] offset:0
    v_sub_f32 v36, v36, v20
    v_sub_f32 v37, v37, v20
    v_cvt_pk_bf16_f32 v21, v36, v37
    v_lshlrev_b32 v36, 16, v21
    v_and_b32 v37, 0xffff0000, v21
    v_mul_f32 v36, v16, v36
    v_mul_f32 v37, v16, v37
    v_cvt_pk_bf16_f32 v232, v36, v37
    v_sub_f32 v38, v38, v20
    v_sub_f32 v39, v39, v20
    v_cvt_pk_bf16_f32 v21, v38, v39
    v_lshlrev_b32 v38, 16, v21
    v_and_b32 v39, 0xffff0000, v21
    v_mul_f32 v38, v16, v38
    v_mul_f32 v39, v16, v39
    v_cvt_pk_bf16_f32 v233, v38, v39
    ds_write_b64 v13, v[232:233] offset:128
    v_sub_f32 v40, v40, v20
    v_sub_f32 v41, v41, v20
    v_cvt_pk_bf16_f32 v21, v40, v41
    v_lshlrev_b32 v40, 16, v21
    v_and_b32 v41, 0xffff0000, v21
    v_mul_f32 v40, v16, v40
    v_mul_f32 v41, v16, v41
    v_cvt_pk_bf16_f32 v234, v40, v41
    v_sub_f32 v42, v42, v20
    v_sub_f32 v43, v43, v20
    v_cvt_pk_bf16_f32 v21, v42, v43
    v_lshlrev_b32 v42, 16, v21
    v_and_b32 v43, 0xffff0000, v21
    v_mul_f32 v42, v16, v42
    v_mul_f32 v43, v16, v43
    v_cvt_pk_bf16_f32 v235, v42, v43
    ds_write_b64 v13, v[234:235] offset:256
    v_sub_f32 v44, v44, v20
    v_sub_f32 v45, v45, v20
    v_cvt_pk_bf16_f32 v21, v44, v45
    v_lshlrev_b32 v44, 16, v21
    v_and_b32 v45, 0xffff0000, v21
    v_mul_f32 v44, v16, v44
    v_mul_f32 v45, v16, v45
    v_cvt_pk_bf16_f32 v236, v44, v45
    v_sub_f32 v46, v46, v20
    v_sub_f32 v47, v47, v20
    v_cvt_pk_bf16_f32 v21, v46, v47
    v_lshlrev_b32 v46, 16, v21
    v_and_b32 v47, 0xffff0000, v21
    v_mul_f32 v46, v16, v46
    v_mul_f32 v47, v16, v47
    v_cvt_pk_bf16_f32 v237, v46, v47
    ds_write_b64 v13, v[236:237] offset:384
    v_sub_f32 v48, v48, v20
    v_sub_f32 v49, v49, v20
    v_cvt_pk_bf16_f32 v21, v48, v49
    v_lshlrev_b32 v48, 16, v21
    v_and_b32 v49, 0xffff0000, v21
    v_mul_f32 v48, v16, v48
    v_mul_f32 v49, v16, v49
    v_cvt_pk_bf16_f32 v238, v48, v49
    v_sub_f32 v50, v50, v20
    v_sub_f32 v51, v51, v20
    v_cvt_pk_bf16_f32 v21, v50, v51
    v_lshlrev_b32 v50, 16, v21
    v_and_b32 v51, 0xffff0000, v21
    v_mul_f32 v50, v16, v50
    v_mul_f32 v51, v16, v51
    v_cvt_pk_bf16_f32 v239, v50, v51
    ds_write_b64 v13, v[238:239] offset:512
    v_sub_f32 v52, v52, v20
    v_sub_f32 v53, v53, v20
    v_cvt_pk_bf16_f32 v21, v52, v53
    v_lshlrev_b32 v52, 16, v21
    v_and_b32 v53, 0xffff0000, v21
    v_mul_f32 v52, v16, v52
    v_mul_f32 v53, v16, v53
    v_cvt_pk_bf16_f32 v240, v52, v53
    v_sub_f32 v54, v54, v20
    v_sub_f32 v55, v55, v20
    v_cvt_pk_bf16_f32 v21, v54, v55
    v_lshlrev_b32 v54, 16, v21
    v_and_b32 v55, 0xffff0000, v21
    v_mul_f32 v54, v16, v54
    v_mul_f32 v55, v16, v55
    v_cvt_pk_bf16_f32 v241, v54, v55
    ds_write_b64 v13, v[240:241] offset:640
    v_sub_f32 v56, v56, v20
    v_sub_f32 v57, v57, v20
    v_cvt_pk_bf16_f32 v21, v56, v57
    v_lshlrev_b32 v56, 16, v21
    v_and_b32 v57, 0xffff0000, v21
    v_mul_f32 v56, v16, v56
    v_mul_f32 v57, v16, v57
    v_cvt_pk_bf16_f32 v242, v56, v57
    v_sub_f32 v58, v58, v20
    v_sub_f32 v59, v59, v20
    v_cvt_pk_bf16_f32 v21, v58, v59
    v_lshlrev_b32 v58, 16, v21
    v_and_b32 v59, 0xffff0000, v21
    v_mul_f32 v58, v16, v58
    v_mul_f32 v59, v16, v59
    v_cvt_pk_bf16_f32 v243, v58, v59
    ds_write_b64 v13, v[242:243] offset:768
    v_mul_u32_u24 v2, 0x380, v10
    v_lshrrev_b32 v3, 1, v10
    s_and_b32 s26, s20, 1
    s_waitcnt lgkmcnt(0)
    s_barrier
    s_cmp_ge_u32 s20, 2
    s_cbranch_scc1 L_k
    v_and_b32 v14, 1, v11
    v_lshl_add_u32 v2, v14, 3, v2
    v_lshrrev_b32 v14, 1, v11
    v_xor_b32 v3, v3, v14
    s_lshl_b32 s27, s26, 1
    v_xor_b32 v3, s27, v3
    v_lshl_add_u32 v4, v3, 4, v2
    v_xor_b32 v3, 4, v3
    v_lshl_add_u32 v5, v3, 4, v2
    ds_read_b64 v[32:33], v4 offset:0
    ds_read_b64 v[34:35], v5 offset:0
    ds_read_b64 v[36:37], v4 offset:128
    ds_read_b64 v[38:39], v5 offset:128
    ds_read_b64 v[40:41], v4 offset:256
    ds_read_b64 v[42:43], v5 offset:256
    ds_read_b64 v[44:45], v4 offset:384
    ds_read_b64 v[46:47], v5 offset:384
    ds_read_b64 v[48:49], v4 offset:512
    ds_read_b64 v[50:51], v5 offset:512
    ds_read_b64 v[52:53], v4 offset:640
    ds_read_b64 v[54:55], v5 offset:640
    ds_read_b64 v[56:57], v4 offset:768
    ds_read_b64 v[58:59], v5 offset:768
    s_mul_i32 s27, s64, 14336
    s_lshl_b32 s26, s26, 10
    s_add_u32 s26, s26, s27
    s_add_u32 s26, s26, 0xe00000
    s_waitcnt lgkmcnt(0)
    v_swap_b32 v33, v34
    v_swap_b32 v37, v38
    v_swap_b32 v41, v42
    v_swap_b32 v45, v46
    v_swap_b32 v49, v50
    v_swap_b32 v53, v54
    v_swap_b32 v57, v58
    buffer_store_dwordx4 v[32:35], v12, s[4:7], s26 offen offset:0 sc1
    buffer_store_dwordx4 v[36:39], v12, s[4:7], s26 offen offset:2048 sc1
    s_add_u32 s26, s26, 4096
    buffer_store_dwordx4 v[40:43], v12, s[4:7], s26 offen offset:0 sc1
    buffer_store_dwordx4 v[44:47], v12, s[4:7], s26 offen offset:2048 sc1
    s_add_u32 s26, s26, 4096
    buffer_store_dwordx4 v[48:51], v12, s[4:7], s26 offen offset:0 sc1
    buffer_store_dwordx4 v[52:55], v12, s[4:7], s26 offen offset:2048 sc1
    s_add_u32 s26, s26, 4096
    buffer_store_dwordx4 v[56:59], v12, s[4:7], s26 offen offset:0 sc1
    s_branch L_t3
L_k:
    v_xor_b32 v3, v3, v11
    s_lshl_b32 s27, s26, 2
    v_xor_b32 v3, s27, v3
    v_lshl_add_u32 v4, v3, 4, v2
    ds_read_b128 v[32:35], v4 offset:0
    ds_read_b128 v[36:39], v4 offset:128
    ds_read_b128 v[40:43], v4 offset:256
    ds_read_b128 v[44:47], v4 offset:384
    ds_read_b128 v[48:51], v4 offset:512
    ds_read_b128 v[52:55], v4 offset:640
    ds_read_b128 v[56:59], v4 offset:768
    v_lshrrev_b32 v13, 1, v11
    v_and_b32 v14, 1, v11
    v_lshlrev_b32 v14, 9, v14
    v_lshl_add_u32 v14, v10, 4, v14
    v_lshl_add_u32 v14, v13, 10, v14
    s_lshr_b32 s27, s64, 1
    s_lshl_b32 s27, s27, 15
    s_and_b32 s28, s64, 1
    s_lshl_b32 s28, s28, 11
    s_add_u32 s27, s27, s28
    s_add_u32 s27, s27, 0x3dc8000
    s_lshl_b32 s28, s26, 10
    s_add_u32 s28, s28, s27
    s_lshl_b32 s29, s26, 13
    s_add_u32 s29, s29, s27
    s_lshl_b32 s31, s26, 14
    s_add_u32 s31, s31, s27
    s_waitcnt lgkmcnt(0)
    s_add_u32 s27, s28, 0
    buffer_store_dwordx4 v[32:35], v12, s[4:7], s27 offen sc1
    s_add_u32 s27, s28, 8192
    buffer_store_dwordx4 v[36:39], v12, s[4:7], s27 offen sc1
    s_add_u32 s27, s28, 16384
    buffer_store_dwordx4 v[40:43], v12, s[4:7], s27 offen sc1
    s_add_u32 s27, s28, 24576
    buffer_store_dwordx4 v[44:47], v12, s[4:7], s27 offen sc1
    s_add_u32 s27, s29, 4096
    buffer_store_dwordx4 v[48:51], v14, s[4:7], s27 offen sc1
    s_add_u32 s27, s29, 20480
    buffer_store_dwordx4 v[52:55], v14, s[4:7], s27 offen sc1
    s_add_u32 s27, s31, 4352
    buffer_store_dwordx4 v[56:59], v14, s[4:7], s27 offen sc1
    s_add_u32 s27, s31, 12544
    buffer_store_dwordx4 v[56:59], v14, s[4:7], s27 offen sc1
L_t3:
    s_cmp_lg_u32 s20, 0
    s_cbranch_scc1 L_gate_1
L_Li_2:
    s_sub_u32 s23, s23, 1
    s_cbranch_scc1 M_exit
    buffer_load_dword v3, off, s[16:19], 0 offset:128 sc1
    s_waitcnt vmcnt(0)
    v_cmp_gt_u32 vcc, 1, v3
    s_cbranch_vccnz L_Li_2
L_gate_1:
    s_barrier
    s_waitcnt vmcnt(0)
    s_barrier
    s_cmp_lg_u32 s20, 0
    s_cbranch_scc1 L_sig_3
    s_lshl_b32 s30, s64, 2
    s_add_u32 s30, s30, 0x3fcc000
    v_mov_b32 v2, 1
    s_mov_b64 exec, 1
    buffer_store_dword v2, off, s[4:7], s30 sc1
    s_mov_b64 exec, -1
L_sig_3:
M_roles:
    v_mov_b32 v3, 0
    s_cmp_lg_u32 s20, 0
    s_cbranch_scc1 M_t2
    s_mov_b64 exec, 1
    ds_write_b32 v3, v255
    s_mov_b64 exec, -1
M_t2:
    s_waitcnt lgkmcnt(0)
    s_barrier
    ds_read_b32 v2, v3
    s_waitcnt lgkmcnt(0)
    v_readfirstlane_b32 s22, v2
    s_barrier
    s_mov_b32 s58, s22
    s_cmp_ge_u32 s22, 32
    s_cbranch_scc1 M_exit
    s_lshl_b32 s59, s21, 5
    s_add_u32 s59, s59, s22
    s_lshl_b32 s59, s59, 2
    s_add_u32 s59, s59, s20
    s_and_b32 s59, s59, 127
    s_cmp_lg_u32 s21, 0
    s_cbranch_scc1 W_roles
    s_cmp_eq_u32 s22, 30
    s_cbranch_scc1 R_role
    s_cmp_eq_u32 s22, 31
    s_cbranch_scc1 F_role
    s_sub_u32 s25, s22, 16
    s_cmp_ge_u32 s22, 16
    s_cbranch_scc1 B_role
    s_mov_b32 s25, s22
    s_cmp_eq_u32 s20, 1
    s_cbranch_scc1 A_w1
    s_cmp_eq_u32 s20, 2
    s_cbranch_scc1 A_w2
    s_cmp_eq_u32 s20, 3
    s_cbranch_scc1 A_w3
A_w0:
    v_mov_b32 v84, v1
    v_lshlrev_b32 v113, 4, v1
    s_mul_i32 s26, s25, 0x62000
    s_add_u32 s26, s26, 0x0
    v_and_b32 v85, 7, v1
    v_min_u32 v85, 6, v85
    v_lshlrev_b32 v85, 2, v85
    s_mul_i32 s27, s25, 512
    s_add_u32 s27, s27, 0x3fca000
    v_mov_b32 v86, 0
    v_and_b32 v91, 31, v1
    v_lshlrev_b32 v91, 2, v91
    v_cmp_gt_u32 vcc, 1, v86
    s_cbranch_vccz L_Awok_4
L_Aw_5:
    s_sub_u32 s23, s23, 1
    s_cbranch_scc1 M_exit
    buffer_load_dword v86, v85, s[4:7], s27 offen sc1
    s_waitcnt vmcnt(0)
    v_cmp_gt_u32 vcc, 1, v86
    s_cbranch_vccnz L_Aw_5
L_Awok_4:
    v_cmp_gt_u32 vcc, 2, v86
    s_cbranch_vccz L_Ag_6
    buffer_load_dword v86, v85, s[4:7], s27 offen sc1
L_Ag_6:
    s_add_u32 s63, s26, 0x0
    buffer_load_dwordx4 a[0:3], v113, s[4:7], s63 offen
    buffer_load_dwordx4 a[4:7], v113, s[4:7], s63 offen offset:1024
    s_add_u32 s63, s26, 0x800
    buffer_load_dwordx4 a[8:11], v113, s[4:7], s63 offen
    buffer_load_dwordx4 a[12:15], v113, s[4:7], s63 offen offset:1024
    s_add_u32 s63, s26, 0x1000
    buffer_load_dwordx4 a[16:19], v113, s[4:7], s63 offen
    buffer_load_dwordx4 a[20:23], v113, s[4:7], s63 offen offset:1024
    s_add_u32 s63, s26, 0x1800
    buffer_load_dwordx4 a[24:27], v113, s[4:7], s63 offen
    buffer_load_dwordx4 a[28:31], v113, s[4:7], s63 offen offset:1024
    s_add_u32 s63, s26, 0x2000
    buffer_load_dwordx4 a[32:35], v113, s[4:7], s63 offen
    buffer_load_dwordx4 a[36:39], v113, s[4:7], s63 offen offset:1024
    s_add_u32 s63, s26, 0x2800
    buffer_load_dwordx4 a[40:43], v113, s[4:7], s63 offen
    buffer_load_dwordx4 a[44:47], v113, s[4:7], s63 offen offset:1024
    s_add_u32 s63, s26, 0x3000
    buffer_load_dwordx4 a[48:51], v113, s[4:7], s63 offen
    buffer_load_dwordx4 a[52:55], v113, s[4:7], s63 offen offset:1024
    s_waitcnt vmcnt(42)
    s_cbranch_vccz L_Ag_7
    s_waitcnt vmcnt(14)
L_Ag_7:
    v_cmp_gt_u32 vcc, 2, v86
    s_cbranch_vccz L_Awok_8
L_Aw_9:
    s_sub_u32 s23, s23, 1
    s_cbranch_scc1 M_exit
    buffer_load_dword v86, v85, s[4:7], s27 offen sc1
    s_waitcnt vmcnt(0)
    v_cmp_gt_u32 vcc, 2, v86
    s_cbranch_vccnz L_Aw_9
L_Awok_8:
    v_cmp_gt_u32 vcc, 3, v86
    s_cbranch_vccz L_Ag_10
    buffer_load_dword v86, v85, s[4:7], s27 offen sc1
L_Ag_10:
    s_add_u32 s63, s26, 0x3800
    buffer_load_dwordx4 a[56:59], v113, s[4:7], s63 offen
    buffer_load_dwordx4 a[60:63], v113, s[4:7], s63 offen offset:1024
    s_add_u32 s63, s26, 0x4000
    buffer_load_dwordx4 a[64:67], v113, s[4:7], s63 offen
    buffer_load_dwordx4 a[68:71], v113, s[4:7], s63 offen offset:1024
    s_add_u32 s63, s26, 0x4800
    buffer_load_dwordx4 a[72:75], v113, s[4:7], s63 offen
    buffer_load_dwordx4 a[76:79], v113, s[4:7], s63 offen offset:1024
    s_add_u32 s63, s26, 0x5000
    buffer_load_dwordx4 a[80:83], v113, s[4:7], s63 offen
    buffer_load_dwordx4 a[84:87], v113, s[4:7], s63 offen offset:1024
    s_add_u32 s63, s26, 0x5800
    buffer_load_dwordx4 a[88:91], v113, s[4:7], s63 offen
    buffer_load_dwordx4 a[92:95], v113, s[4:7], s63 offen offset:1024
    s_add_u32 s63, s26, 0x6000
    buffer_load_dwordx4 a[96:99], v113, s[4:7], s63 offen
    buffer_load_dwordx4 a[100:103], v113, s[4:7], s63 offen offset:1024
    s_add_u32 s63, s26, 0x6800
    buffer_load_dwordx4 a[104:107], v113, s[4:7], s63 offen
    buffer_load_dwordx4 a[108:111], v113, s[4:7], s63 offen offset:1024
    s_waitcnt vmcnt(42)
    s_cbranch_vccz L_Ag_11
    s_waitcnt vmcnt(14)
L_Ag_11:
    v_cmp_gt_u32 vcc, 3, v86
    s_cbranch_vccz L_Awok_12
L_Aw_13:
    s_sub_u32 s23, s23, 1
    s_cbranch_scc1 M_exit
    buffer_load_dword v86, v85, s[4:7], s27 offen sc1
    s_waitcnt vmcnt(0)
    v_cmp_gt_u32 vcc, 3, v86
    s_cbranch_vccnz L_Aw_13
L_Awok_12:
    v_cmp_gt_u32 vcc, 4, v86
    s_cbranch_vccz L_Ag_14
    buffer_load_dword v86, v85, s[4:7], s27 offen sc1
L_Ag_14:
    s_add_u32 s63, s26, 0x7000
    buffer_load_dwordx4 a[112:115], v113, s[4:7], s63 offen
    buffer_load_dwordx4 a[116:119], v113, s[4:7], s63 offen offset:1024
    s_add_u32 s63, s26, 0x7800
    buffer_load_dwordx4 a[120:123], v113, s[4:7], s63 offen
    buffer_load_dwordx4 a[124:127], v113, s[4:7], s63 offen offset:1024
    s_add_u32 s63, s26, 0x8000
    buffer_load_dwordx4 a[128:131], v113, s[4:7], s63 offen
    buffer_load_dwordx4 a[132:135], v113, s[4:7], s63 offen offset:1024
    s_add_u32 s63, s26, 0x8800
    buffer_load_dwordx4 a[136:139], v113, s[4:7], s63 offen
    buffer_load_dwordx4 a[140:143], v113, s[4:7], s63 offen offset:1024
    s_add_u32 s63, s26, 0x9000
    buffer_load_dwordx4 a[144:147], v113, s[4:7], s63 offen
    buffer_load_dwordx4 a[148:151], v113, s[4:7], s63 offen offset:1024
    s_add_u32 s63, s26, 0x9800
    buffer_load_dwordx4 a[152:155], v113, s[4:7], s63 offen
    buffer_load_dwordx4 a[156:159], v113, s[4:7], s63 offen offset:1024
    s_add_u32 s63, s26, 0xa000
    buffer_load_dwordx4 a[160:163], v113, s[4:7], s63 offen
    buffer_load_dwordx4 a[164:167], v113, s[4:7], s63 offen offset:1024
    s_waitcnt vmcnt(42)
    s_cbranch_vccz L_Ag_15
    s_waitcnt vmcnt(14)
L_Ag_15:
    v_cmp_gt_u32 vcc, 4, v86
    s_cbranch_vccz L_Awok_16
L_Aw_17:
    s_sub_u32 s23, s23, 1
    s_cbranch_scc1 M_exit
    buffer_load_dword v86, v85, s[4:7], s27 offen sc1
    s_waitcnt vmcnt(0)
    v_cmp_gt_u32 vcc, 4, v86
    s_cbranch_vccnz L_Aw_17
L_Awok_16:
    v_cmp_gt_u32 vcc, 5, v86
    s_cbranch_vccz L_Ag_18
    buffer_load_dword v86, v85, s[4:7], s27 offen sc1
L_Ag_18:
    s_add_u32 s63, s26, 0xa800
    buffer_load_dwordx4 a[168:171], v113, s[4:7], s63 offen
    buffer_load_dwordx4 a[172:175], v113, s[4:7], s63 offen offset:1024
    s_add_u32 s63, s26, 0xb000
    buffer_load_dwordx4 a[176:179], v113, s[4:7], s63 offen
    buffer_load_dwordx4 a[180:183], v113, s[4:7], s63 offen offset:1024
    s_add_u32 s63, s26, 0xb800
    buffer_load_dwordx4 a[184:187], v113, s[4:7], s63 offen
    buffer_load_dwordx4 a[188:191], v113, s[4:7], s63 offen offset:1024
    s_add_u32 s63, s26, 0xc000
    buffer_load_dwordx4 a[192:195], v113, s[4:7], s63 offen
    buffer_load_dwordx4 a[196:199], v113, s[4:7], s63 offen offset:1024
    s_add_u32 s63, s26, 0xc800
    buffer_load_dwordx4 a[200:203], v113, s[4:7], s63 offen
    buffer_load_dwordx4 a[204:207], v113, s[4:7], s63 offen offset:1024
    s_add_u32 s63, s26, 0xd000
    buffer_load_dwordx4 a[208:211], v113, s[4:7], s63 offen
    buffer_load_dwordx4 a[212:215], v113, s[4:7], s63 offen offset:1024
    s_add_u32 s63, s26, 0xd800
    buffer_load_dwordx4 a[216:219], v113, s[4:7], s63 offen
    buffer_load_dwordx4 a[220:223], v113, s[4:7], s63 offen offset:1024
    s_waitcnt vmcnt(42)
    s_cbranch_vccz L_Ag_19
    s_waitcnt vmcnt(14)
L_Ag_19:
    v_cmp_gt_u32 vcc, 5, v86
    s_cbranch_vccz L_Awok_20
L_Aw_21:
    s_sub_u32 s23, s23, 1
    s_cbranch_scc1 M_exit
    buffer_load_dword v86, v85, s[4:7], s27 offen sc1
    s_waitcnt vmcnt(0)
    v_cmp_gt_u32 vcc, 5, v86
    s_cbranch_vccnz L_Aw_21
L_Awok_20:
    s_mov_b32 s63, 0x3fcc000
    buffer_load_dword v88, v91, s[4:7], s63 offen sc1
    v_mov_b32 v89, 1
    v_cmp_gt_u32 vcc, 6, v86
    s_cbranch_vccz L_Ag_22
    buffer_load_dword v86, v85, s[4:7], s27 offen sc1
L_Ag_22:
    s_add_u32 s63, s26, 0xe000
    buffer_load_dwordx4 a[224:227], v113, s[4:7], s63 offen
    buffer_load_dwordx4 a[228:231], v113, s[4:7], s63 offen offset:1024
    s_add_u32 s63, s26, 0xe800
    buffer_load_dwordx4 a[232:235], v113, s[4:7], s63 offen
    buffer_load_dwordx4 a[236:239], v113, s[4:7], s63 offen offset:1024
    s_add_u32 s63, s26, 0xf000
    buffer_load_dwordx4 a[240:243], v113, s[4:7], s63 offen
    buffer_load_dwordx4 a[244:247], v113, s[4:7], s63 offen offset:1024
    s_add_u32 s63, s26, 0xf800
    buffer_load_dwordx4 a[248:251], v113, s[4:7], s63 offen
    buffer_load_dwordx4 a[252:255], v113, s[4:7], s63 offen offset:1024
    s_add_u32 s63, s26, 0x10000
    buffer_load_dwordx4 v[120:123], v113, s[4:7], s63 offen
    buffer_load_dwordx4 v[124:127], v113, s[4:7], s63 offen offset:1024
    s_add_u32 s63, s26, 0x10800
    buffer_load_dwordx4 v[128:131], v113, s[4:7], s63 offen
    buffer_load_dwordx4 v[132:135], v113, s[4:7], s63 offen offset:1024
    s_add_u32 s63, s26, 0x11000
    buffer_load_dwordx4 v[136:139], v113, s[4:7], s63 offen
    buffer_load_dwordx4 v[140:143], v113, s[4:7], s63 offen offset:1024
    s_waitcnt vmcnt(42)
    s_cbranch_vccz L_Ag_23
    s_waitcnt vmcnt(14)
L_Ag_23:
    v_cmp_gt_u32 vcc, 6, v86
    s_cbranch_vccz L_Awok_24
L_Aw_25:
    s_sub_u32 s23, s23, 1
    s_cbranch_scc1 M_exit
    buffer_load_dword v86, v85, s[4:7], s27 offen sc1
    s_waitcnt vmcnt(0)
    v_cmp_gt_u32 vcc, 6, v86
    s_cbranch_vccnz L_Aw_25
L_Awok_24:
    v_cmp_gt_u32 vcc, 7, v86
    s_cbranch_vccz L_Ag_26
    buffer_load_dword v86, v85, s[4:7], s27 offen sc1
L_Ag_26:
    s_add_u32 s63, s26, 0x11800
    buffer_load_dwordx4 v[144:147], v113, s[4:7], s63 offen
    buffer_load_dwordx4 v[148:151], v113, s[4:7], s63 offen offset:1024
    s_add_u32 s63, s26, 0x12000
    buffer_load_dwordx4 v[152:155], v113, s[4:7], s63 offen
    buffer_load_dwordx4 v[156:159], v113, s[4:7], s63 offen offset:1024
    s_add_u32 s63, s26, 0x12800
    buffer_load_dwordx4 v[160:163], v113, s[4:7], s63 offen
    buffer_load_dwordx4 v[164:167], v113, s[4:7], s63 offen offset:1024
    s_add_u32 s63, s26, 0x13000
    buffer_load_dwordx4 v[168:171], v113, s[4:7], s63 offen
    buffer_load_dwordx4 v[172:175], v113, s[4:7], s63 offen offset:1024
    s_add_u32 s63, s26, 0x13800
    buffer_load_dwordx4 v[176:179], v113, s[4:7], s63 offen
    buffer_load_dwordx4 v[180:183], v113, s[4:7], s63 offen offset:1024
    s_add_u32 s63, s26, 0x14000
    buffer_load_dwordx4 v[184:187], v113, s[4:7], s63 offen
    buffer_load_dwordx4 v[188:191], v113, s[4:7], s63 offen offset:1024
    s_add_u32 s63, s26, 0x14800
    buffer_load_dwordx4 v[192:195], v113, s[4:7], s63 offen
    buffer_load_dwordx4 v[196:199], v113, s[4:7], s63 offen offset:1024
    s_waitcnt vmcnt(42)
    s_cbranch_vccz L_Ag_27
    s_waitcnt vmcnt(14)
L_Ag_27:
    v_cmp_gt_u32 vcc, 7, v86
    s_cbranch_vccz L_Awok_28
L_Aw_29:
    s_sub_u32 s23, s23, 1
    s_cbranch_scc1 M_exit
    buffer_load_dword v86, v85, s[4:7], s27 offen sc1
    s_waitcnt vmcnt(0)
    v_cmp_gt_u32 vcc, 7, v86
    s_cbranch_vccnz L_Aw_29
L_Awok_28:
    s_add_u32 s63, s26, 0x15000
    buffer_load_dwordx4 v[200:203], v113, s[4:7], s63 offen
    buffer_load_dwordx4 v[204:207], v113, s[4:7], s63 offen offset:1024
    s_add_u32 s63, s26, 0x15800
    buffer_load_dwordx4 v[208:211], v113, s[4:7], s63 offen
    buffer_load_dwordx4 v[212:215], v113, s[4:7], s63 offen offset:1024
    s_add_u32 s63, s26, 0x16000
    buffer_load_dwordx4 v[216:219], v113, s[4:7], s63 offen
    buffer_load_dwordx4 v[220:223], v113, s[4:7], s63 offen offset:1024
    s_add_u32 s63, s26, 0x16800
    buffer_load_dwordx4 v[224:227], v113, s[4:7], s63 offen
    buffer_load_dwordx4 v[228:231], v113, s[4:7], s63 offen offset:1024
    s_add_u32 s63, s26, 0x17000
    buffer_load_dwordx4 v[232:235], v113, s[4:7], s63 offen
    buffer_load_dwordx4 v[236:239], v113, s[4:7], s63 offen offset:1024
    s_add_u32 s63, s26, 0x17800
    buffer_load_dwordx4 v[240:243], v113, s[4:7], s63 offen
    buffer_load_dwordx4 v[244:247], v113, s[4:7], s63 offen offset:1024
    s_add_u32 s63, s26, 0x18000
    buffer_load_dwordx4 v[248:251], v113, s[4:7], s63 offen
    buffer_load_dwordx4 v[252:255], v113, s[4:7], s63 offen offset:1024
    s_waitcnt vmcnt(42)
    v_min_u32 v88, v88, v89
    v_cmp_eq_u32 vcc, 0, v88
    s_cbranch_vccz L_Aiok_32
    v_and_b32 v91, 31, v84
    v_lshlrev_b32 v91, 2, v91
L_Ai_33:
    s_sub_u32 s23, s23, 1
    s_cbranch_scc1 M_exit
    s_mov_b32 s63, 0x3fcc000
    buffer_load_dword v88, v91, s[4:7], s63 offen sc1
    v_mov_b32 v89, 1
    s_waitcnt vmcnt(0)
    v_min_u32 v88, v88, v89
    v_cmp_eq_u32 vcc, 0, v88
    s_cbranch_vccnz L_Ai_33
L_Aiok_32:
    v_and_b32 v0, 15, v84
    v_lshrrev_b32 v1, 4, v84
    v_and_b32 v2, 7, v84
    v_bfe_u32 v3, v84, 3, 1
    v_mov_b32 v4, 0x4444
    v_mov_b32 v5, 0xeeee
    v_cmp_eq_u32 vcc, 1, v3
    s_nop 1
    v_cndmask_b32 v112, v4, v5, vcc
    v_and_b32 v4, 1, v1
    v_lshlrev_b32 v4, 2, v4
    v_sub_u32 v4, v2, v4
    v_mov_b32 v6, 0
    v_cmp_eq_u32 vcc, 0, v4
    v_mov_b32 v5, 0x3f80
    s_nop 0
    v_cndmask_b32 v6, v6, v5, vcc
    v_cmp_eq_u32 vcc, 1, v4
    v_mov_b32 v5, 0x3f800000
    s_nop 0
    v_cndmask_b32 v6, v6, v5, vcc
    v_cmp_eq_u32 vcc, 0, v3
    s_nop 1
    v_cndmask_b32 v108, 0, v6, vcc
    v_cmp_eq_u32 vcc, 1, v3
    s_nop 1
    v_cndmask_b32 v110, 0, v6, vcc
    v_mov_b32 v6, 0
    v_cmp_eq_u32 vcc, 2, v4
    v_mov_b32 v5, 0x3f80
    s_nop 0
    v_cndmask_b32 v6, v6, v5, vcc
    v_cmp_eq_u32 vcc, 3, v4
    v_mov_b32 v5, 0x3f800000
    s_nop 0
    v_cndmask_b32 v6, v6, v5, vcc
    v_cmp_eq_u32 vcc, 0, v3
    s_nop 1
    v_cndmask_b32 v109, 0, v6, vcc
    v_cmp_eq_u32 vcc, 1, v3
    s_nop 1
    v_cndmask_b32 v111, 0, v6, vcc
    v_lshlrev_b32 v4, 4, v2
    v_lshl_add_u32 v114, v1, 8, v4
    v_lshrrev_b32 v5, 1, v1
    v_lshl_add_u32 v4, v5, 8, v4
    v_and_b32 v6, 1, v1
    v_cmp_eq_u32 vcc, 1, v6
    v_mov_b32 v7, 4096
    v_mov_b32 v8, 6144
    v_cndmask_b32 v7, v7, v8, vcc
    v_add_u32 v115, v4, v7
    v_lshl_add_u32 v4, v6, 2, v5
    v_mul_u32_u24 v4, 208, v4
    v_lshl_add_u32 v4, v0, 2, v4
    v_add_u32 v116, 40960, v4
    v_lshrrev_b32 v4, 5, v84
    v_and_b32 v9, 31, v84
    v_bfe_u32 v12, v9, 2, 1
    v_and_b32 v13, 2, v9
    v_or_b32 v12, v12, v13
    v_bfe_u32 v13, v9, 3, 1
    v_lshl_or_b32 v12, v13, 2, v12
    v_and_b32 v13, 1, v9
    v_lshl_or_b32 v12, v13, 3, v12
    v_bfe_u32 v14, v9, 1, 1
    v_lshl_or_b32 v13, v13, 1, v14
    v_or_b32 v13, 16, v13
    v_cmp_gt_u32 s[28:29], 20, v9
    v_cmp_gt_u32 vcc, 16, v9
    v_add_u32 v10, 0, v4
    v_mul_u32_u24 v11, 208, v10
    v_cndmask_b32 v9, v13, v12, vcc
    v_cndmask_b32 v12, 0, v9, s[28:29]
    v_lshl_add_u32 v11, v12, 3, v11
    v_add_u32 v118, 40960, v11
    v_mov_b32 v12, 47616
    v_cndmask_b32 v117, v12, v118, s[28:29]
    s_and_b32 s27, s25, 1
    s_bfe_u32 s30, s25, 0x10001
    s_lshr_b32 s31, s25, 2
    v_bfe_u32 v12, v9, 2, 1
    v_lshlrev_b32 v12, 8, v12
    v_and_b32 v13, 1, v9
    v_lshl_add_u32 v12, v13, 7, v12
    v_bfe_u32 v14, v9, 1, 1
    v_lshl_add_u32 v12, v14, 3, v12
    v_bfe_u32 v15, v9, 3, 1
    v_lshl_add_u32 v12, v15, 2, v12
    s_lshl_b32 s32, s30, 10
    s_lshl_b32 s33, s27, 9
    s_add_u32 s32, s32, s33
    v_add_u32 v12, s32, v12
    v_lshlrev_b32 v14, 3, v14
    v_lshl_add_u32 v14, v13, 7, v14
    s_lshl_b32 s32, s27, 2
    s_lshl_b32 s33, s30, 8
    s_add_u32 s32, s32, s33
    s_add_u32 s32, s32, 2048
    v_add_u32 v14, s32, v14
    v_cmp_gt_u32 vcc, 16, v9
    s_nop 1
    v_cndmask_b32 v12, v14, v12, vcc
    v_lshl_add_u32 v12, v10, 4, v12
    s_mul_i32 s32, s31, 2560
    v_add_u32 v12, s32, v12
    v_mov_b32 v13, 0x40000000
    v_cndmask_b32 v119, v13, v12, s[28:29]
    v_mov_b32 v4, 0xff800000
    v_mov_b32 v5, v4
    v_mov_b32 v6, 47616
    ds_write_b64 v6, v[4:5]
    s_mov_b64 s[56:57], s[28:29]
    s_mov_b32 s33, 0x42800000
    s_mov_b32 s24, 0
    s_mov_b32 s26, 0xfc0000
    s_mov_b32 s27, 0x10a0000
    s_mov_b32 s28, 0x3dc8000
    s_mov_b32 m0, 8192
    s_add_u32 s29, s28, 4096
    buffer_load_dwordx4 v113, s[4:7], s28 offen offset:0 lds
    buffer_load_dwordx4 v113, s[4:7], s28 offen offset:1024 lds
    buffer_load_dwordx4 v113, s[4:7], s28 offen offset:2048 lds
    buffer_load_dwordx4 v113, s[4:7], s28 offen offset:3072 lds
    s_mov_b32 m0, 12288
    s_nop 0
    buffer_load_dwordx4 v113, s[4:7], s29 offen offset:2048 lds
    buffer_load_dwordx4 v113, s[4:7], s29 offen offset:3072 lds
    buffer_load_dwordx4 v113, s[4:7], s29 offen offset:0 lds
    buffer_load_dwordx4 v113, s[4:7], s29 offen offset:1024 lds
    s_add_u32 s28, s28, 32768
A_top0:
    s_waitcnt vmcnt(0)
    ds_read_b128 v[60:63], v113 offset:8192
    ds_read_b128 v[64:67], v113 offset:9216
    ds_read_b128 v[68:71], v113 offset:10240
    ds_read_b128 v[72:75], v113 offset:11264
    v_mov_b64 v[32:33], 0
    v_mov_b64 v[34:35], 0
    v_mov_b64 v[36:37], 0
    v_mov_b64 v[38:39], 0
    v_mov_b64 v[40:41], 0
    v_mov_b64 v[42:43], 0
    v_mov_b64 v[44:45], 0
    v_mov_b64 v[46:47], 0
    v_mov_b64 v[48:49], 0
    v_mov_b64 v[50:51], 0
    v_mov_b64 v[52:53], 0
    v_mov_b64 v[54:55], 0
    v_mov_b64 v[56:57], 0
    v_mov_b64 v[58:59], 0
    s_add_u32 s30, s26, 0
    s_add_u32 s31, s26, 1024
    s_waitcnt lgkmcnt(0)
    buffer_load_dwordx4 v[0:3], v113, s[4:7], s30 offen sc1
    buffer_load_dwordx4 v[4:7], v113, s[4:7], s31 offen sc1
L_Apoll_34:
    s_sub_u32 s23, s23, 1
    s_cbranch_scc1 M_exit
    buffer_load_dwordx4 v[0:3], v113, s[4:7], s30 offen sc1
    buffer_load_dwordx4 v[4:7], v113, s[4:7], s31 offen sc1
    s_waitcnt vmcnt(2)
    v_max3_u32 v84, v0, v1, v2
    v_max3_u32 v84, v84, v3, v4
    v_max3_u32 v84, v84, v5, v6
    v_max_u32 v84, v84, v7
    v_cmp_eq_u32 vcc, -1, v84
    s_cbranch_vccnz L_Apoll_34
    ds_write_b128 v113, v[0:3] offset:0
    ds_write_b128 v113, v[4:7] offset:1024
    v_smfmac_f32_16x16x64_bf16 v[32:35], v[0:3], a[0:7], v112
    v_smfmac_f32_16x16x64_bf16 v[36:39], v[0:3], a[56:63], v112
    v_smfmac_f32_16x16x64_bf16 v[40:43], v[0:3], a[112:119], v112
    v_smfmac_f32_16x16x64_bf16 v[44:47], v[0:3], a[168:175], v112
    v_smfmac_f32_16x16x64_bf16 v[48:51], v[0:3], a[224:231], v112
    v_smfmac_f32_16x16x64_bf16 v[52:55], v[0:3], v[144:151], v112
    s_waitcnt lgkmcnt(0)
    s_barrier
    ds_read_b128 v[8:11], v113 offset:2048
    ds_read_b128 v[16:19], v113 offset:3072
    v_smfmac_f32_16x16x64_bf16 v[56:59], v[0:3], v[200:207], v112
    ds_read_b128 v[20:23], v113 offset:4096
    v_smfmac_f32_16x16x64_bf16 v[32:35], v[4:7], a[8:15], v112
    ds_read_b128 v[24:27], v113 offset:5120
    v_smfmac_f32_16x16x64_bf16 v[36:39], v[4:7], a[64:71], v112
    ds_read_b128 v[28:31], v113 offset:6144
    v_smfmac_f32_16x16x64_bf16 v[40:43], v[4:7], a[120:127], v112
    ds_read_b128 v[76:79], v114 offset:0
    v_smfmac_f32_16x16x64_bf16 v[44:47], v[4:7], a[176:183], v112
    ds_read_b128 v[80:83], v114 offset:128
    v_smfmac_f32_16x16x64_bf16 v[48:51], v[4:7], a[232:239], v112
    v_smfmac_f32_16x16x64_bf16 v[52:55], v[4:7], v[152:159], v112
    v_smfmac_f32_16x16x64_bf16 v[56:59], v[4:7], v[208:215], v112
    s_waitcnt lgkmcnt(6)
    v_smfmac_f32_16x16x64_bf16 v[32:35], v[8:11], a[16:23], v112
    s_waitcnt vmcnt(0)
    ds_read_b128 v[0:3], v113 offset:14336
    v_smfmac_f32_16x16x64_bf16 v[36:39], v[8:11], a[72:79], v112
    ds_read_b128 v[4:7], v113 offset:15360
    v_smfmac_f32_16x16x64_bf16 v[40:43], v[8:11], a[128:135], v112
    v_smfmac_f32_16x16x64_bf16 v[44:47], v[8:11], a[184:191], v112
    s_mov_b32 m0, 8192
    s_add_u32 s29, s28, 4096
    buffer_load_dwordx4 v113, s[4:7], s28 offen offset:0 lds
    v_smfmac_f32_16x16x64_bf16 v[48:51], v[8:11], a[240:247], v112
    v_smfmac_f32_16x16x64_bf16 v[52:55], v[8:11], v[160:167], v112
    buffer_load_dwordx4 v113, s[4:7], s28 offen offset:1024 lds
    v_smfmac_f32_16x16x64_bf16 v[56:59], v[8:11], v[216:223], v112
    s_waitcnt lgkmcnt(4)
    v_smfmac_f32_16x16x64_bf16 v[32:35], v[16:19], a[24:31], v112
    ds_read_b128 v[8:11], v113 offset:12288
    v_smfmac_f32_16x16x64_bf16 v[32:35], v[20:23], a[32:39], v112
    ds_read_b128 v[12:15], v113 offset:13312
    v_smfmac_f32_16x16x64_bf16 v[32:35], v[24:27], a[40:47], v112
    buffer_load_dwordx4 v113, s[4:7], s28 offen offset:2048 lds
    v_smfmac_f32_16x16x64_bf16 v[32:35], v[28:31], a[48:55], v112
    v_smfmac_f32_16x16x64_bf16 v[36:39], v[16:19], a[80:87], v112
    buffer_load_dwordx4 v113, s[4:7], s28 offen offset:3072 lds
    v_smfmac_f32_16x16x64_bf16 v[36:39], v[20:23], a[88:95], v112
    v_cvt_pk_bf16_f32 v84, v32, v33
    v_smfmac_f32_16x16x64_bf16 v[36:39], v[24:27], a[96:103], v112
    v_cvt_pk_bf16_f32 v85, v34, v35
    v_smfmac_f32_16x16x64_bf16 v[36:39], v[28:31], a[104:111], v112
    v_mov_b64 v[32:33], 0
    v_smfmac_f32_16x16x64_bf16 v[40:43], v[16:19], a[136:143], v112
    v_mov_b64 v[34:35], 0
    v_smfmac_f32_16x16x64_bf16 v[40:43], v[20:23], a[144:151], v112
    v_cvt_pk_bf16_f32 v86, v36, v37
    v_smfmac_f32_16x16x64_bf16 v[40:43], v[24:27], a[152:159], v112
    v_cvt_pk_bf16_f32 v87, v38, v39
    v_smfmac_f32_16x16x64_bf16 v[40:43], v[28:31], a[160:167], v112
    v_mov_b64 v[36:37], 0
    v_mfma_f32_16x16x32_bf16 v[92:95], v[84:87], v[108:111], 0
    s_waitcnt lgkmcnt(0)
    s_mov_b32 m0, 12288
    s_nop 0
    buffer_load_dwordx4 v113, s[4:7], s29 offen offset:2048 lds
    v_smfmac_f32_16x16x64_bf16 v[44:47], v[16:19], a[192:199], v112
    v_mov_b64 v[38:39], 0
    v_smfmac_f32_16x16x64_bf16 v[44:47], v[20:23], a[200:207], v112
    v_cvt_pk_bf16_f32 v88, v40, v41
    v_smfmac_f32_16x16x64_bf16 v[44:47], v[24:27], a[208:215], v112
    v_cvt_pk_bf16_f32 v89, v42, v43
    v_smfmac_f32_16x16x64_bf16 v[44:47], v[28:31], a[216:223], v112
    v_cvt_pk_bf16_f32 v100, v92, v93
    v_smfmac_f32_16x16x64_bf16 v[48:51], v[16:19], a[248:255], v112
    v_cvt_pk_bf16_f32 v101, v94, v95
    v_smfmac_f32_16x16x64_bf16 v[48:51], v[20:23], v[120:127], v112
    v_cvt_pk_bf16_f32 v90, v44, v45
    v_smfmac_f32_16x16x64_bf16 v[48:51], v[24:27], v[128:135], v112
    v_cvt_pk_bf16_f32 v91, v46, v47
    v_smfmac_f32_16x16x64_bf16 v[48:51], v[28:31], v[136:143], v112
    v_mov_b64 v[40:41], 0
    v_mfma_f32_16x16x32_bf16 v[96:99], v[88:91], v[108:111], 0
    buffer_load_dwordx4 v113, s[4:7], s29 offen offset:3072 lds
    v_smfmac_f32_16x16x64_bf16 v[52:55], v[16:19], v[168:175], v112
    v_mov_b64 v[42:43], 0
    v_smfmac_f32_16x16x64_bf16 v[52:55], v[20:23], v[176:183], v112
    v_cvt_pk_bf16_f32 v84, v48, v49
    v_smfmac_f32_16x16x64_bf16 v[52:55], v[24:27], v[184:191], v112
    v_cvt_pk_bf16_f32 v85, v50, v51
    v_smfmac_f32_16x16x64_bf16 v[52:55], v[28:31], v[192:199], v112
    v_cvt_pk_bf16_f32 v102, v96, v97
    v_smfmac_f32_16x16x64_bf16 v[56:59], v[16:19], v[224:231], v112
    v_cvt_pk_bf16_f32 v103, v98, v99
    v_smfmac_f32_16x16x64_bf16 v[56:59], v[20:23], v[232:239], v112
    v_cvt_pk_bf16_f32 v86, v52, v53
    v_smfmac_f32_16x16x64_bf16 v[56:59], v[24:27], v[240:247], v112
    v_cvt_pk_bf16_f32 v87, v54, v55
    v_smfmac_f32_16x16x64_bf16 v[56:59], v[28:31], v[248:255], v112
    ds_read_b128 v[44:47], v115 offset:0
    v_mfma_f32_16x16x32_bf16 v[92:95], v[84:87], v[108:111], 0
    ds_read_b128 v[48:51], v115 offset:512
    v_smfmac_f32_16x16x64_bf16 v[32:35], v[100:103], v[60:67], v112
    v_cvt_pk_bf16_f32 v88, v56, v57
    v_cvt_pk_bf16_f32 v89, v58, v59
    s_nop 1
    v_mfma_f32_16x16x16_bf16 v[96:99], v[88:89], v[108:109], 0
    v_cvt_pk_bf16_f32 v104, v92, v93
    v_smfmac_f32_16x16x64_bf16 v[36:39], v[100:103], v[68:75], v112
    v_cvt_pk_bf16_f32 v105, v94, v95
    v_smfmac_f32_16x16x64_bf16 v[40:43], v[100:103], v[76:83], v112
    v_cvt_pk_bf16_f32 v106, v96, v97
    v_cvt_pk_bf16_f32 v107, v98, v99
    s_waitcnt lgkmcnt(0)
    s_nop 0
    v_smfmac_f32_16x16x64_bf16 v[32:35], v[104:107], v[8:15], v112
    v_smfmac_f32_16x16x64_bf16 v[36:39], v[104:107], v[0:7], v112
    v_smfmac_f32_16x16x64_bf16 v[40:43], v[104:107], v[44:51], v112
    v_permlane32_swap_b32 v32, v33
    v_permlane32_swap_b32 v34, v35
    v_add_f32 v32, v32, v33
    v_add_f32 v34, v34, v35
    ds_write2_b32 v116, v32, v34 offset0:0 offset1:104
    v_permlane32_swap_b32 v36, v37
    v_permlane32_swap_b32 v38, v39
    v_add_f32 v36, v36, v37
    v_add_f32 v38, v38, v39
    ds_write2_b32 v116, v36, v38 offset0:16 offset1:120
    s_nop 0
    v_permlane32_swap_b32 v40, v41
    v_permlane32_swap_b32 v42, v43
    v_add_f32 v40, v40, v41
    v_add_f32 v42, v42, v43
    ds_write2_b32 v116, v40, v42 offset0:32 offset1:136
    s_waitcnt lgkmcnt(0)
    s_barrier
    ds_read_b64 v[44:45], v117
    ds_read_b64 v[46:47], v118 offset:1664
    ds_read_b64 v[48:49], v118 offset:3328
    ds_read_b64 v[50:51], v118 offset:4992
    buffer_load_dwordx4 v113, s[4:7], s29 offen offset:0 lds
    buffer_load_dwordx4 v113, s[4:7], s29 offen offset:1024 lds
    s_waitcnt lgkmcnt(2)
    v_add_f32 v44, v44, v46
    v_add_f32 v45, v45, v47
    s_waitcnt lgkmcnt(0)
    v_add_f32 v48, v48, v50
    v_add_f32 v49, v49, v51
    v_add_f32 v48, v44, v48
    v_add_f32 v49, v45, v49
    v_max_f32 v46, |v48|, |v49|
    v_exp_f32 v44, v48
    v_cmp_lt_f32 vcc, s33, v46
    v_exp_f32 v45, v49
    s_and_b64 vcc, vcc, s[56:57]
    s_cbranch_scc1 A_max0
A_sum0:
    v_add_f32 v46, v44, v45
    s_nop 1
    v_add_f32_dpp v46, v46, v46 row_ror:8 row_mask:0xf bank_mask:0xf
    s_nop 1
    v_add_f32_dpp v46, v46, v46 row_ror:4 row_mask:0xf bank_mask:0xf
    s_nop 1
    v_add_f32_dpp v46, v46, v46 row_ror:2 row_mask:0xf bank_mask:0xf
    s_nop 1
    v_add_f32_dpp v46, v46, v46 row_ror:1 row_mask:0xf bank_mask:0xf
    v_mov_b32 v47, v46
    s_nop 1
    v_permlane16_swap_b32 v47, v46
    v_add_f32 v46, v46, v47
    v_rcp_f32 v46, v46
    s_nop 0
    v_mul_f32 v44, v44, v46
    v_mul_f32 v45, v45, v46
    v_cvt_pk_bf16_f32 v44, v44, v45
    v_min_u32 v44, -2, v44
    buffer_store_dword v44, v119, s[4:7], s27 offen
    s_add_u32 s24, s24, 1
    s_add_u32 s26, s26, 7168
    s_add_u32 s27, s27, 10240
    s_add_u32 s28, s28, 32768
    s_cmp_lt_u32 s24, 63
    s_cbranch_scc1 A_top0
    s_endpgm
A_max0:
    v_max_f32 v46, v48, v49
    s_nop 1
    v_max_f32_dpp v46, v46, v46 row_ror:8 row_mask:0xf bank_mask:0xf
    s_nop 1
    v_max_f32_dpp v46, v46, v46 row_ror:4 row_mask:0xf bank_mask:0xf
    s_nop 1
    v_max_f32_dpp v46, v46, v46 row_ror:2 row_mask:0xf bank_mask:0xf
    s_nop 1
    v_max_f32_dpp v46, v46, v46 row_ror:1 row_mask:0xf bank_mask:0xf
    v_mov_b32 v47, v46
    s_nop 1
    v_permlane16_swap_b32 v47, v46
    v_max_f32 v46, v46, v47
    v_sub_f32 v44, v48, v46
    v_sub_f32 v45, v49, v46
    v_exp_f32 v44, v44
    v_exp_f32 v45, v45
    s_nop 0
    s_branch A_sum0
A_w1:
    v_mov_b32 v84, v1
    v_lshlrev_b32 v113, 4, v1
    s_mul_i32 s26, s25, 0x62000
    s_add_u32 s26, s26, 0x18800
    v_and_b32 v85, 7, v1
    v_min_u32 v85, 6, v85
    v_lshlrev_b32 v85, 2, v85
    s_mul_i32 s27, s25, 512
    s_add_u32 s27, s27, 0x3fca080
    v_mov_b32 v86, 0
    v_and_b32 v91, 31, v1
    v_lshlrev_b32 v91, 2, v91
    v_cmp_gt_u32 vcc, 1, v86
    s_cbranch_vccz L_Awok_35
L_Aw_36:
    s_sub_u32 s23, s23, 1
    s_cbranch_scc1 M_exit
    buffer_load_dword v86, v85, s[4:7], s27 offen sc1
    s_waitcnt vmcnt(0)
    v_cmp_gt_u32 vcc, 1, v86
    s_cbranch_vccnz L_Aw_36
L_Awok_35:
    v_cmp_gt_u32 vcc, 2, v86
    s_cbranch_vccz L_Ag_37
    buffer_load_dword v86, v85, s[4:7], s27 offen sc1
L_Ag_37:
    s_add_u32 s63, s26, 0x1000
    buffer_load_dwordx4 a[0:3], v113, s[4:7], s63 offen
    buffer_load_dwordx4 a[4:7], v113, s[4:7], s63 offen offset:1024
    s_add_u32 s63, s26, 0x1800
    buffer_load_dwordx4 a[8:11], v113, s[4:7], s63 offen
    buffer_load_dwordx4 a[12:15], v113, s[4:7], s63 offen offset:1024
    s_add_u32 s63, s26, 0x2000
    buffer_load_dwordx4 a[16:19], v113, s[4:7], s63 offen
    buffer_load_dwordx4 a[20:23], v113, s[4:7], s63 offen offset:1024
    s_add_u32 s63, s26, 0x2800
    buffer_load_dwordx4 a[24:27], v113, s[4:7], s63 offen
    buffer_load_dwordx4 a[28:31], v113, s[4:7], s63 offen offset:1024
    s_add_u32 s63, s26, 0x3000
    buffer_load_dwordx4 a[32:35], v113, s[4:7], s63 offen
    buffer_load_dwordx4 a[36:39], v113, s[4:7], s63 offen offset:1024
    s_add_u32 s63, s26, 0x0
    buffer_load_dwordx4 a[40:43], v113, s[4:7], s63 offen
    buffer_load_dwordx4 a[44:47], v113, s[4:7], s63 offen offset:1024
    s_add_u32 s63, s26, 0x800
    buffer_load_dwordx4 a[48:51], v113, s[4:7], s63 offen
    buffer_load_dwordx4 a[52:55], v113, s[4:7], s63 offen offset:1024
    s_waitcnt vmcnt(42)
    s_cbranch_vccz L_Ag_38
    s_waitcnt vmcnt(14)
L_Ag_38:
    v_cmp_gt_u32 vcc, 2, v86
    s_cbranch_vccz L_Awok_39
L_Aw_40:
    s_sub_u32 s23, s23, 1
    s_cbranch_scc1 M_exit
    buffer_load_dword v86, v85, s[4:7], s27 offen sc1
    s_waitcnt vmcnt(0)
    v_cmp_gt_u32 vcc, 2, v86
    s_cbranch_vccnz L_Aw_40
L_Awok_39:
    v_cmp_gt_u32 vcc, 3, v86
    s_cbranch_vccz L_Ag_41
    buffer_load_dword v86, v85, s[4:7], s27 offen sc1
L_Ag_41:
    s_add_u32 s63, s26, 0x4800
    buffer_load_dwordx4 a[56:59], v113, s[4:7], s63 offen
    buffer_load_dwordx4 a[60:63], v113, s[4:7], s63 offen offset:1024
    s_add_u32 s63, s26, 0x5000
    buffer_load_dwordx4 a[64:67], v113, s[4:7], s63 offen
    buffer_load_dwordx4 a[68:71], v113, s[4:7], s63 offen offset:1024
    s_add_u32 s63, s26, 0x5800
    buffer_load_dwordx4 a[72:75], v113, s[4:7], s63 offen
    buffer_load_dwordx4 a[76:79], v113, s[4:7], s63 offen offset:1024
    s_add_u32 s63, s26, 0x6000
    buffer_load_dwordx4 a[80:83], v113, s[4:7], s63 offen
    buffer_load_dwordx4 a[84:87], v113, s[4:7], s63 offen offset:1024
    s_add_u32 s63, s26, 0x6800
    buffer_load_dwordx4 a[88:91], v113, s[4:7], s63 offen
    buffer_load_dwordx4 a[92:95], v113, s[4:7], s63 offen offset:1024
    s_add_u32 s63, s26, 0x3800
    buffer_load_dwordx4 a[96:99], v113, s[4:7], s63 offen
    buffer_load_dwordx4 a[100:103], v113, s[4:7], s63 offen offset:1024
    s_add_u32 s63, s26, 0x4000
    buffer_load_dwordx4 a[104:107], v113, s[4:7], s63 offen
    buffer_load_dwordx4 a[108:111], v113, s[4:7], s63 offen offset:1024
    s_waitcnt vmcnt(42)
    s_cbranch_vccz L_Ag_42
    s_waitcnt vmcnt(14)
L_Ag_42:
    v_cmp_gt_u32 vcc, 3, v86
    s_cbranch_vccz L_Awok_43
L_Aw_44:
    s_sub_u32 s23, s23, 1
    s_cbranch_scc1 M_exit
    buffer_load_dword v86, v85, s[4:7], s27 offen sc1
    s_waitcnt vmcnt(0)
    v_cmp_gt_u32 vcc, 3, v86
    s_cbranch_vccnz L_Aw_44
L_Awok_43:
    v_cmp_gt_u32 vcc, 4, v86
    s_cbranch_vccz L_Ag_45
    buffer_load_dword v86, v85, s[4:7], s27 offen sc1
L_Ag_45:
    s_add_u32 s63, s26, 0x8000
    buffer_load_dwordx4 a[112:115], v113, s[4:7], s63 offen
    buffer_load_dwordx4 a[116:119], v113, s[4:7], s63 offen offset:1024
    s_add_u32 s63, s26, 0x8800
    buffer_load_dwordx4 a[120:123], v113, s[4:7], s63 offen
    buffer_load_dwordx4 a[124:127], v113, s[4:7], s63 offen offset:1024
    s_add_u32 s63, s26, 0x9000
    buffer_load_dwordx4 a[128:131], v113, s[4:7], s63 offen
    buffer_load_dwordx4 a[132:135], v113, s[4:7], s63 offen offset:1024
    s_add_u32 s63, s26, 0x9800
    buffer_load_dwordx4 a[136:139], v113, s[4:7], s63 offen
    buffer_load_dwordx4 a[140:143], v113, s[4:7], s63 offen offset:1024
    s_add_u32 s63, s26, 0xa000
    buffer_load_dwordx4 a[144:147], v113, s[4:7], s63 offen
    buffer_load_dwordx4 a[148:151], v113, s[4:7], s63 offen offset:1024
    s_add_u32 s63, s26, 0x7000
    buffer_load_dwordx4 a[152:155], v113, s[4:7], s63 offen
    buffer_load_dwordx4 a[156:159], v113, s[4:7], s63 offen offset:1024
    s_add_u32 s63, s26, 0x7800
    buffer_load_dwordx4 a[160:163], v113, s[4:7], s63 offen
    buffer_load_dwordx4 a[164:167], v113, s[4:7], s63 offen offset:1024
    s_waitcnt vmcnt(42)
    s_cbranch_vccz L_Ag_46
    s_waitcnt vmcnt(14)
L_Ag_46:
    v_cmp_gt_u32 vcc, 4, v86
    s_cbranch_vccz L_Awok_47
L_Aw_48:
    s_sub_u32 s23, s23, 1
    s_cbranch_scc1 M_exit
    buffer_load_dword v86, v85, s[4:7], s27 offen sc1
    s_waitcnt vmcnt(0)
    v_cmp_gt_u32 vcc, 4, v86
    s_cbranch_vccnz L_Aw_48
L_Awok_47:
    v_cmp_gt_u32 vcc, 5, v86
    s_cbranch_vccz L_Ag_49
    buffer_load_dword v86, v85, s[4:7], s27 offen sc1
L_Ag_49:
    s_add_u32 s63, s26, 0xb800
    buffer_load_dwordx4 a[168:171], v113, s[4:7], s63 offen
    buffer_load_dwordx4 a[172:175], v113, s[4:7], s63 offen offset:1024
    s_add_u32 s63, s26, 0xc000
    buffer_load_dwordx4 a[176:179], v113, s[4:7], s63 offen
    buffer_load_dwordx4 a[180:183], v113, s[4:7], s63 offen offset:1024
    s_add_u32 s63, s26, 0xc800
    buffer_load_dwordx4 a[184:187], v113, s[4:7], s63 offen
    buffer_load_dwordx4 a[188:191], v113, s[4:7], s63 offen offset:1024
    s_add_u32 s63, s26, 0xd000
    buffer_load_dwordx4 a[192:195], v113, s[4:7], s63 offen
    buffer_load_dwordx4 a[196:199], v113, s[4:7], s63 offen offset:1024
    s_add_u32 s63, s26, 0xd800
    buffer_load_dwordx4 a[200:203], v113, s[4:7], s63 offen
    buffer_load_dwordx4 a[204:207], v113, s[4:7], s63 offen offset:1024
    s_add_u32 s63, s26, 0xa800
    buffer_load_dwordx4 a[208:211], v113, s[4:7], s63 offen
    buffer_load_dwordx4 a[212:215], v113, s[4:7], s63 offen offset:1024
    s_add_u32 s63, s26, 0xb000
    buffer_load_dwordx4 a[216:219], v113, s[4:7], s63 offen
    buffer_load_dwordx4 a[220:223], v113, s[4:7], s63 offen offset:1024
    s_waitcnt vmcnt(42)
    s_cbranch_vccz L_Ag_50
    s_waitcnt vmcnt(14)
L_Ag_50:
    v_cmp_gt_u32 vcc, 5, v86
    s_cbranch_vccz L_Awok_51
L_Aw_52:
    s_sub_u32 s23, s23, 1
    s_cbranch_scc1 M_exit
    buffer_load_dword v86, v85, s[4:7], s27 offen sc1
    s_waitcnt vmcnt(0)
    v_cmp_gt_u32 vcc, 5, v86
    s_cbranch_vccnz L_Aw_52
L_Awok_51:
    s_mov_b32 s63, 0x3fcc000
    buffer_load_dword v88, v91, s[4:7], s63 offen sc1
    v_mov_b32 v89, 1
    v_cmp_gt_u32 vcc, 6, v86
    s_cbranch_vccz L_Ag_53
    buffer_load_dword v86, v85, s[4:7], s27 offen sc1
L_Ag_53:
    s_add_u32 s63, s26, 0xf000
    buffer_load_dwordx4 a[224:227], v113, s[4:7], s63 offen
    buffer_load_dwordx4 a[228:231], v113, s[4:7], s63 offen offset:1024
    s_add_u32 s63, s26, 0xf800
    buffer_load_dwordx4 a[232:235], v113, s[4:7], s63 offen
    buffer_load_dwordx4 a[236:239], v113, s[4:7], s63 offen offset:1024
    s_add_u32 s63, s26, 0x10000
    buffer_load_dwordx4 a[240:243], v113, s[4:7], s63 offen
    buffer_load_dwordx4 a[244:247], v113, s[4:7], s63 offen offset:1024
    s_add_u32 s63, s26, 0x10800
    buffer_load_dwordx4 a[248:251], v113, s[4:7], s63 offen
    buffer_load_dwordx4 a[252:255], v113, s[4:7], s63 offen offset:1024
    s_add_u32 s63, s26, 0x11000
    buffer_load_dwordx4 v[120:123], v113, s[4:7], s63 offen
    buffer_load_dwordx4 v[124:127], v113, s[4:7], s63 offen offset:1024
    s_add_u32 s63, s26, 0xe000
    buffer_load_dwordx4 v[128:131], v113, s[4:7], s63 offen
    buffer_load_dwordx4 v[132:135], v113, s[4:7], s63 offen offset:1024
    s_add_u32 s63, s26, 0xe800
    buffer_load_dwordx4 v[136:139], v113, s[4:7], s63 offen
    buffer_load_dwordx4 v[140:143], v113, s[4:7], s63 offen offset:1024
    s_waitcnt vmcnt(42)
    s_cbranch_vccz L_Ag_54
    s_waitcnt vmcnt(14)
L_Ag_54:
    v_cmp_gt_u32 vcc, 6, v86
    s_cbranch_vccz L_Awok_55
L_Aw_56:
    s_sub_u32 s23, s23, 1
    s_cbranch_scc1 M_exit
    buffer_load_dword v86, v85, s[4:7], s27 offen sc1
    s_waitcnt vmcnt(0)
    v_cmp_gt_u32 vcc, 6, v86
    s_cbranch_vccnz L_Aw_56
L_Awok_55:
    v_cmp_gt_u32 vcc, 7, v86
    s_cbranch_vccz L_Ag_57
    buffer_load_dword v86, v85, s[4:7], s27 offen sc1
L_Ag_57:
    s_add_u32 s63, s26, 0x12800
    buffer_load_dwordx4 v[144:147], v113, s[4:7], s63 offen
    buffer_load_dwordx4 v[148:151], v113, s[4:7], s63 offen offset:1024
    s_add_u32 s63, s26, 0x13000
    buffer_load_dwordx4 v[152:155], v113, s[4:7], s63 offen
    buffer_load_dwordx4 v[156:159], v113, s[4:7], s63 offen offset:1024
    s_add_u32 s63, s26, 0x13800
    buffer_load_dwordx4 v[160:163], v113, s[4:7], s63 offen
    buffer_load_dwordx4 v[164:167], v113, s[4:7], s63 offen offset:1024
    s_add_u32 s63, s26, 0x14000
    buffer_load_dwordx4 v[168:171], v113, s[4:7], s63 offen
    buffer_load_dwordx4 v[172:175], v113, s[4:7], s63 offen offset:1024
    s_add_u32 s63, s26, 0x14800
    buffer_load_dwordx4 v[176:179], v113, s[4:7], s63 offen
    buffer_load_dwordx4 v[180:183], v113, s[4:7], s63 offen offset:1024
    s_add_u32 s63, s26, 0x11800
    buffer_load_dwordx4 v[184:187], v113, s[4:7], s63 offen
    buffer_load_dwordx4 v[188:191], v113, s[4:7], s63 offen offset:1024
    s_add_u32 s63, s26, 0x12000
    buffer_load_dwordx4 v[192:195], v113, s[4:7], s63 offen
    buffer_load_dwordx4 v[196:199], v113, s[4:7], s63 offen offset:1024
    s_waitcnt vmcnt(42)
    s_cbranch_vccz L_Ag_58
    s_waitcnt vmcnt(14)
L_Ag_58:
    v_cmp_gt_u32 vcc, 7, v86
    s_cbranch_vccz L_Awok_59
L_Aw_60:
    s_sub_u32 s23, s23, 1
    s_cbranch_scc1 M_exit
    buffer_load_dword v86, v85, s[4:7], s27 offen sc1
    s_waitcnt vmcnt(0)
    v_cmp_gt_u32 vcc, 7, v86
    s_cbranch_vccnz L_Aw_60
L_Awok_59:
    s_add_u32 s63, s26, 0x16000
    buffer_load_dwordx4 v[200:203], v113, s[4:7], s63 offen
    buffer_load_dwordx4 v[204:207], v113, s[4:7], s63 offen offset:1024
    s_add_u32 s63, s26, 0x16800
    buffer_load_dwordx4 v[208:211], v113, s[4:7], s63 offen
    buffer_load_dwordx4 v[212:215], v113, s[4:7], s63 offen offset:1024
    s_add_u32 s63, s26, 0x17000
    buffer_load_dwordx4 v[216:219], v113, s[4:7], s63 offen
    buffer_load_dwordx4 v[220:223], v113, s[4:7], s63 offen offset:1024
    s_add_u32 s63, s26, 0x17800
    buffer_load_dwordx4 v[224:227], v113, s[4:7], s63 offen
    buffer_load_dwordx4 v[228:231], v113, s[4:7], s63 offen offset:1024
    s_add_u32 s63, s26, 0x18000
    buffer_load_dwordx4 v[232:235], v113, s[4:7], s63 offen
    buffer_load_dwordx4 v[236:239], v113, s[4:7], s63 offen offset:1024
    s_add_u32 s63, s26, 0x15000
    buffer_load_dwordx4 v[240:243], v113, s[4:7], s63 offen
    buffer_load_dwordx4 v[244:247], v113, s[4:7], s63 offen offset:1024
    s_add_u32 s63, s26, 0x15800
    buffer_load_dwordx4 v[248:251], v113, s[4:7], s63 offen
    buffer_load_dwordx4 v[252:255], v113, s[4:7], s63 offen offset:1024
    s_waitcnt vmcnt(42)
    v_min_u32 v88, v88, v89
    v_cmp_eq_u32 vcc, 0, v88
    s_cbranch_vccz L_Aiok_63
    v_and_b32 v91, 31, v84
    v_lshlrev_b32 v91, 2, v91
L_Ai_64:
    s_sub_u32 s23, s23, 1
    s_cbranch_scc1 M_exit
    s_mov_b32 s63, 0x3fcc000
    buffer_load_dword v88, v91, s[4:7], s63 offen sc1
    v_mov_b32 v89, 1
    s_waitcnt vmcnt(0)
    v_min_u32 v88, v88, v89
    v_cmp_eq_u32 vcc, 0, v88
    s_cbranch_vccnz L_Ai_64
L_Aiok_63:
    v_and_b32 v0, 15, v84
    v_lshrrev_b32 v1, 4, v84
    v_and_b32 v2, 7, v84
    v_bfe_u32 v3, v84, 3, 1
    v_mov_b32 v4, 0x4444
    v_mov_b32 v5, 0xeeee
    v_cmp_eq_u32 vcc, 1, v3
    s_nop 1
    v_cndmask_b32 v112, v4, v5, vcc
    v_and_b32 v4, 1, v1
    v_lshlrev_b32 v4, 2, v4
    v_sub_u32 v4, v2, v4
    v_mov_b32 v6, 0
    v_cmp_eq_u32 vcc, 0, v4
    v_mov_b32 v5, 0x3f80
    s_nop 0
    v_cndmask_b32 v6, v6, v5, vcc
    v_cmp_eq_u32 vcc, 1, v4
    v_mov_b32 v5, 0x3f800000
    s_nop 0
    v_cndmask_b32 v6, v6, v5, vcc
    v_cmp_eq_u32 vcc, 0, v3
    s_nop 1
    v_cndmask_b32 v108, 0, v6, vcc
    v_cmp_eq_u32 vcc, 1, v3
    s_nop 1
    v_cndmask_b32 v110, 0, v6, vcc
    v_mov_b32 v6, 0
    v_cmp_eq_u32 vcc, 2, v4
    v_mov_b32 v5, 0x3f80
    s_nop 0
    v_cndmask_b32 v6, v6, v5, vcc
    v_cmp_eq_u32 vcc, 3, v4
    v_mov_b32 v5, 0x3f800000
    s_nop 0
    v_cndmask_b32 v6, v6, v5, vcc
    v_cmp_eq_u32 vcc, 0, v3
    s_nop 1
    v_cndmask_b32 v109, 0, v6, vcc
    v_cmp_eq_u32 vcc, 1, v3
    s_nop 1
    v_cndmask_b32 v111, 0, v6, vcc
    v_lshlrev_b32 v4, 4, v2
    v_lshl_add_u32 v114, v1, 8, v4
    v_lshrrev_b32 v5, 1, v1
    v_lshl_add_u32 v4, v5, 8, v4
    v_and_b32 v6, 1, v1
    v_cmp_eq_u32 vcc, 1, v6
    v_mov_b32 v7, 4224
    v_mov_b32 v8, 6144
    v_cndmask_b32 v7, v7, v8, vcc
    v_add_u32 v115, v4, v7
    v_lshl_add_u32 v4, v6, 2, v5
    v_mul_u32_u24 v4, 208, v4
    v_lshl_add_u32 v4, v0, 2, v4
    v_add_u32 v116, 42624, v4
    v_lshrrev_b32 v4, 5, v84
    v_and_b32 v9, 31, v84
    v_bfe_u32 v12, v9, 2, 1
    v_and_b32 v13, 2, v9
    v_or_b32 v12, v12, v13
    v_bfe_u32 v13, v9, 3, 1
    v_lshl_or_b32 v12, v13, 2, v12
    v_and_b32 v13, 1, v9
    v_lshl_or_b32 v12, v13, 3, v12
    v_bfe_u32 v14, v9, 1, 1
    v_lshl_or_b32 v13, v13, 1, v14
    v_or_b32 v13, 16, v13
    v_cmp_gt_u32 s[28:29], 20, v9
    v_cmp_gt_u32 vcc, 16, v9
    v_add_u32 v10, 2, v4
    v_mul_u32_u24 v11, 208, v10
    v_cndmask_b32 v9, v13, v12, vcc
    v_cndmask_b32 v12, 0, v9, s[28:29]
    v_lshl_add_u32 v11, v12, 3, v11
    v_add_u32 v118, 40960, v11
    v_mov_b32 v12, 47616
    v_cndmask_b32 v117, v12, v118, s[28:29]
    s_and_b32 s27, s25, 1
    s_bfe_u32 s30, s25, 0x10001
    s_lshr_b32 s31, s25, 2
    v_bfe_u32 v12, v9, 2, 1
    v_lshlrev_b32 v12, 8, v12
    v_and_b32 v13, 1, v9
    v_lshl_add_u32 v12, v13, 7, v12
    v_bfe_u32 v14, v9, 1, 1
    v_lshl_add_u32 v12, v14, 3, v12
    v_bfe_u32 v15, v9, 3, 1
    v_lshl_add_u32 v12, v15, 2, v12
    s_lshl_b32 s32, s30, 10
    s_lshl_b32 s33, s27, 9
    s_add_u32 s32, s32, s33
    v_add_u32 v12, s32, v12
    v_lshlrev_b32 v14, 3, v14
    v_lshl_add_u32 v14, v13, 7, v14
    s_lshl_b32 s32, s27, 2
    s_lshl_b32 s33, s30, 8
    s_add_u32 s32, s32, s33
    s_add_u32 s32, s32, 2048
    v_add_u32 v14, s32, v14
    v_cmp_gt_u32 vcc, 16, v9
    s_nop 1
    v_cndmask_b32 v12, v14, v12, vcc
    v_lshl_add_u32 v12, v10, 4, v12
    s_mul_i32 s32, s31, 2560
    v_add_u32 v12, s32, v12
    v_mov_b32 v13, 0x40000000
    v_cndmask_b32 v119, v13, v12, s[28:29]
    s_mov_b64 s[56:57], s[28:29]
    s_mov_b32 s33, 0x42800000
    s_mov_b32 s24, 0
    s_mov_b32 s26, 0xfc0000
    s_mov_b32 s27, 0x10a0000
    s_mov_b32 s28, 0x3dca000
    s_mov_b32 m0, 16384
    s_add_u32 s29, s28, 4096
    buffer_load_dwordx4 v113, s[4:7], s28 offen offset:0 lds
    buffer_load_dwordx4 v113, s[4:7], s28 offen offset:1024 lds
    buffer_load_dwordx4 v113, s[4:7], s28 offen offset:2048 lds
    buffer_load_dwordx4 v113, s[4:7], s28 offen offset:3072 lds
    s_mov_b32 m0, 20480
    s_nop 0
    buffer_load_dwordx4 v113, s[4:7], s29 offen offset:2048 lds
    buffer_load_dwordx4 v113, s[4:7], s29 offen offset:3072 lds
    buffer_load_dwordx4 v113, s[4:7], s29 offen offset:0 lds
    buffer_load_dwordx4 v113, s[4:7], s29 offen offset:1024 lds
    s_add_u32 s28, s28, 32768
A_top1:
    s_waitcnt vmcnt(0)
    ds_read_b128 v[60:63], v113 offset:16384
    ds_read_b128 v[64:67], v113 offset:17408
    ds_read_b128 v[68:71], v113 offset:18432
    ds_read_b128 v[72:75], v113 offset:19456
    v_mov_b64 v[32:33], 0
    v_mov_b64 v[34:35], 0
    v_mov_b64 v[36:37], 0
    v_mov_b64 v[38:39], 0
    v_mov_b64 v[40:41], 0
    v_mov_b64 v[42:43], 0
    v_mov_b64 v[44:45], 0
    v_mov_b64 v[46:47], 0
    v_mov_b64 v[48:49], 0
    v_mov_b64 v[50:51], 0
    v_mov_b64 v[52:53], 0
    v_mov_b64 v[54:55], 0
    v_mov_b64 v[56:57], 0
    v_mov_b64 v[58:59], 0
    s_add_u32 s30, s26, 2048
    s_add_u32 s31, s26, 3072
    s_waitcnt lgkmcnt(0)
    buffer_load_dwordx4 v[0:3], v113, s[4:7], s30 offen sc1
    buffer_load_dwordx4 v[4:7], v113, s[4:7], s31 offen sc1
L_Apoll_65:
    s_sub_u32 s23, s23, 1
    s_cbranch_scc1 M_exit
    buffer_load_dwordx4 v[0:3], v113, s[4:7], s30 offen sc1
    buffer_load_dwordx4 v[4:7], v113, s[4:7], s31 offen sc1
    s_waitcnt vmcnt(2)
    v_max3_u32 v84, v0, v1, v2
    v_max3_u32 v84, v84, v3, v4
    v_max3_u32 v84, v84, v5, v6
    v_max_u32 v84, v84, v7
    v_cmp_eq_u32 vcc, -1, v84
    s_cbranch_vccnz L_Apoll_65
    ds_write_b128 v113, v[0:3] offset:2048
    ds_write_b128 v113, v[4:7] offset:3072
    v_smfmac_f32_16x16x64_bf16 v[32:35], v[0:3], a[0:7], v112
    v_smfmac_f32_16x16x64_bf16 v[36:39], v[0:3], a[56:63], v112
    v_smfmac_f32_16x16x64_bf16 v[40:43], v[0:3], a[112:119], v112
    v_smfmac_f32_16x16x64_bf16 v[44:47], v[0:3], a[168:175], v112
    v_smfmac_f32_16x16x64_bf16 v[48:51], v[0:3], a[224:231], v112
    v_smfmac_f32_16x16x64_bf16 v[52:55], v[0:3], v[144:151], v112
    s_waitcnt lgkmcnt(0)
    s_barrier
    ds_read_b128 v[8:11], v113 offset:4096
    ds_read_b128 v[16:19], v113 offset:5120
    v_smfmac_f32_16x16x64_bf16 v[56:59], v[0:3], v[200:207], v112
    ds_read_b128 v[20:23], v113 offset:6144
    v_smfmac_f32_16x16x64_bf16 v[32:35], v[4:7], a[8:15], v112
    ds_read_b128 v[24:27], v113 offset:0
    v_smfmac_f32_16x16x64_bf16 v[36:39], v[4:7], a[64:71], v112
    ds_read_b128 v[28:31], v113 offset:1024
    v_smfmac_f32_16x16x64_bf16 v[40:43], v[4:7], a[120:127], v112
    ds_read_b128 v[76:79], v114 offset:1024
    v_smfmac_f32_16x16x64_bf16 v[44:47], v[4:7], a[176:183], v112
    ds_read_b128 v[80:83], v114 offset:1152
    v_smfmac_f32_16x16x64_bf16 v[48:51], v[4:7], a[232:239], v112
    v_smfmac_f32_16x16x64_bf16 v[52:55], v[4:7], v[152:159], v112
    v_smfmac_f32_16x16x64_bf16 v[56:59], v[4:7], v[208:215], v112
    s_waitcnt lgkmcnt(6)
    v_smfmac_f32_16x16x64_bf16 v[32:35], v[8:11], a[16:23], v112
    s_waitcnt vmcnt(0)
    ds_read_b128 v[0:3], v113 offset:22528
    v_smfmac_f32_16x16x64_bf16 v[36:39], v[8:11], a[72:79], v112
    ds_read_b128 v[4:7], v113 offset:23552
    v_smfmac_f32_16x16x64_bf16 v[40:43], v[8:11], a[128:135], v112
    v_smfmac_f32_16x16x64_bf16 v[44:47], v[8:11], a[184:191], v112
    s_mov_b32 m0, 16384
    s_add_u32 s29, s28, 4096
    buffer_load_dwordx4 v113, s[4:7], s28 offen offset:0 lds
    v_smfmac_f32_16x16x64_bf16 v[48:51], v[8:11], a[240:247], v112
    v_smfmac_f32_16x16x64_bf16 v[52:55], v[8:11], v[160:167], v112
    buffer_load_dwordx4 v113, s[4:7], s28 offen offset:1024 lds
    v_smfmac_f32_16x16x64_bf16 v[56:59], v[8:11], v[216:223], v112
    s_waitcnt lgkmcnt(4)
    v_smfmac_f32_16x16x64_bf16 v[32:35], v[16:19], a[24:31], v112
    ds_read_b128 v[8:11], v113 offset:20480
    v_smfmac_f32_16x16x64_bf16 v[32:35], v[20:23], a[32:39], v112
    ds_read_b128 v[12:15], v113 offset:21504
    v_smfmac_f32_16x16x64_bf16 v[32:35], v[24:27], a[40:47], v112
    buffer_load_dwordx4 v113, s[4:7], s28 offen offset:2048 lds
    v_smfmac_f32_16x16x64_bf16 v[32:35], v[28:31], a[48:55], v112
    v_smfmac_f32_16x16x64_bf16 v[36:39], v[16:19], a[80:87], v112
    buffer_load_dwordx4 v113, s[4:7], s28 offen offset:3072 lds
    v_smfmac_f32_16x16x64_bf16 v[36:39], v[20:23], a[88:95], v112
    v_cvt_pk_bf16_f32 v84, v32, v33
    v_smfmac_f32_16x16x64_bf16 v[36:39], v[24:27], a[96:103], v112
    v_cvt_pk_bf16_f32 v85, v34, v35
    v_smfmac_f32_16x16x64_bf16 v[36:39], v[28:31], a[104:111], v112
    v_mov_b64 v[32:33], 0
    v_smfmac_f32_16x16x64_bf16 v[40:43], v[16:19], a[136:143], v112
    v_mov_b64 v[34:35], 0
    v_smfmac_f32_16x16x64_bf16 v[40:43], v[20:23], a[144:151], v112
    v_cvt_pk_bf16_f32 v86, v36, v37
    v_smfmac_f32_16x16x64_bf16 v[40:43], v[24:27], a[152:159], v112
    v_cvt_pk_bf16_f32 v87, v38, v39
    v_smfmac_f32_16x16x64_bf16 v[40:43], v[28:31], a[160:167], v112
    v_mov_b64 v[36:37], 0
    v_mfma_f32_16x16x32_bf16 v[92:95], v[84:87], v[108:111], 0
    s_waitcnt lgkmcnt(0)
    s_mov_b32 m0, 20480
    s_nop 0
    buffer_load_dwordx4 v113, s[4:7], s29 offen offset:2048 lds
    v_smfmac_f32_16x16x64_bf16 v[44:47], v[16:19], a[192:199], v112
    v_mov_b64 v[38:39], 0
    v_smfmac_f32_16x16x64_bf16 v[44:47], v[20:23], a[200:207], v112
    v_cvt_pk_bf16_f32 v88, v40, v41
    v_smfmac_f32_16x16x64_bf16 v[44:47], v[24:27], a[208:215], v112
    v_cvt_pk_bf16_f32 v89, v42, v43
    v_smfmac_f32_16x16x64_bf16 v[44:47], v[28:31], a[216:223], v112
    v_cvt_pk_bf16_f32 v100, v92, v93
    v_smfmac_f32_16x16x64_bf16 v[48:51], v[16:19], a[248:255], v112
    v_cvt_pk_bf16_f32 v101, v94, v95
    v_smfmac_f32_16x16x64_bf16 v[48:51], v[20:23], v[120:127], v112
    v_cvt_pk_bf16_f32 v90, v44, v45
    v_smfmac_f32_16x16x64_bf16 v[48:51], v[24:27], v[128:135], v112
    v_cvt_pk_bf16_f32 v91, v46, v47
    v_smfmac_f32_16x16x64_bf16 v[48:51], v[28:31], v[136:143], v112
    v_mov_b64 v[40:41], 0
    v_mfma_f32_16x16x32_bf16 v[96:99], v[88:91], v[108:111], 0
    buffer_load_dwordx4 v113, s[4:7], s29 offen offset:3072 lds
    v_smfmac_f32_16x16x64_bf16 v[52:55], v[16:19], v[168:175], v112
    v_mov_b64 v[42:43], 0
    v_smfmac_f32_16x16x64_bf16 v[52:55], v[20:23], v[176:183], v112
    v_cvt_pk_bf16_f32 v84, v48, v49
    v_smfmac_f32_16x16x64_bf16 v[52:55], v[24:27], v[184:191], v112
    v_cvt_pk_bf16_f32 v85, v50, v51
    v_smfmac_f32_16x16x64_bf16 v[52:55], v[28:31], v[192:199], v112
    v_cvt_pk_bf16_f32 v102, v96, v97
    v_smfmac_f32_16x16x64_bf16 v[56:59], v[16:19], v[224:231], v112
    v_cvt_pk_bf16_f32 v103, v98, v99
    v_smfmac_f32_16x16x64_bf16 v[56:59], v[20:23], v[232:239], v112
    v_cvt_pk_bf16_f32 v86, v52, v53
    v_smfmac_f32_16x16x64_bf16 v[56:59], v[24:27], v[240:247], v112
    v_cvt_pk_bf16_f32 v87, v54, v55
    v_smfmac_f32_16x16x64_bf16 v[56:59], v[28:31], v[248:255], v112
    ds_read_b128 v[44:47], v115 offset:0
    v_mfma_f32_16x16x32_bf16 v[92:95], v[84:87], v[108:111], 0
    ds_read_b128 v[48:51], v115 offset:512
    v_smfmac_f32_16x16x64_bf16 v[32:35], v[100:103], v[60:67], v112
    v_cvt_pk_bf16_f32 v88, v56, v57
    v_cvt_pk_bf16_f32 v89, v58, v59
    s_nop 1
    v_mfma_f32_16x16x16_bf16 v[96:99], v[88:89], v[110:111], 0
    v_cvt_pk_bf16_f32 v104, v92, v93
    v_smfmac_f32_16x16x64_bf16 v[36:39], v[100:103], v[68:75], v112
    v_cvt_pk_bf16_f32 v105, v94, v95
    v_smfmac_f32_16x16x64_bf16 v[40:43], v[100:103], v[76:83], v112
    v_cvt_pk_bf16_f32 v106, v96, v97
    v_cvt_pk_bf16_f32 v107, v98, v99
    s_waitcnt lgkmcnt(0)
    s_nop 0
    v_smfmac_f32_16x16x64_bf16 v[32:35], v[104:107], v[8:15], v112
    v_smfmac_f32_16x16x64_bf16 v[36:39], v[104:107], v[0:7], v112
    v_smfmac_f32_16x16x64_bf16 v[40:43], v[104:107], v[44:51], v112
    v_permlane32_swap_b32 v32, v33
    v_permlane32_swap_b32 v34, v35
    v_add_f32 v32, v32, v33
    v_add_f32 v34, v34, v35
    ds_write2_b32 v116, v32, v34 offset0:0 offset1:104
    v_permlane32_swap_b32 v36, v37
    v_permlane32_swap_b32 v38, v39
    v_add_f32 v36, v36, v37
    v_add_f32 v38, v38, v39
    ds_write2_b32 v116, v36, v38 offset0:16 offset1:120
    s_nop 0
    v_permlane32_swap_b32 v40, v41
    v_permlane32_swap_b32 v42, v43
    v_add_f32 v40, v40, v41
    v_add_f32 v42, v42, v43
    ds_write2_b32 v116, v40, v42 offset0:32 offset1:136
    s_waitcnt lgkmcnt(0)
    s_barrier
    ds_read_b64 v[44:45], v117
    ds_read_b64 v[46:47], v118 offset:1664
    ds_read_b64 v[48:49], v118 offset:3328
    ds_read_b64 v[50:51], v118 offset:4992
    buffer_load_dwordx4 v113, s[4:7], s29 offen offset:0 lds
    buffer_load_dwordx4 v113, s[4:7], s29 offen offset:1024 lds
    s_waitcnt lgkmcnt(2)
    v_add_f32 v44, v44, v46
    v_add_f32 v45, v45, v47
    s_waitcnt lgkmcnt(0)
    v_add_f32 v48, v48, v50
    v_add_f32 v49, v49, v51
    v_add_f32 v48, v44, v48
    v_add_f32 v49, v45, v49
    v_max_f32 v46, |v48|, |v49|
    v_exp_f32 v44, v48
    v_cmp_lt_f32 vcc, s33, v46
    v_exp_f32 v45, v49
    s_and_b64 vcc, vcc, s[56:57]
    s_cbranch_scc1 A_max1
A_sum1:
    v_add_f32 v46, v44, v45
    s_nop 1
    v_add_f32_dpp v46, v46, v46 row_ror:8 row_mask:0xf bank_mask:0xf
    s_nop 1
    v_add_f32_dpp v46, v46, v46 row_ror:4 row_mask:0xf bank_mask:0xf
    s_nop 1
    v_add_f32_dpp v46, v46, v46 row_ror:2 row_mask:0xf bank_mask:0xf
    s_nop 1
    v_add_f32_dpp v46, v46, v46 row_ror:1 row_mask:0xf bank_mask:0xf
    v_mov_b32 v47, v46
    s_nop 1
    v_permlane16_swap_b32 v47, v46
    v_add_f32 v46, v46, v47
    v_rcp_f32 v46, v46
    s_nop 0
    v_mul_f32 v44, v44, v46
    v_mul_f32 v45, v45, v46
    v_cvt_pk_bf16_f32 v44, v44, v45
    v_min_u32 v44, -2, v44
    buffer_store_dword v44, v119, s[4:7], s27 offen
    s_add_u32 s24, s24, 1
    s_add_u32 s26, s26, 7168
    s_add_u32 s27, s27, 10240
    s_add_u32 s28, s28, 32768
    s_cmp_lt_u32 s24, 63
    s_cbranch_scc1 A_top1
    s_endpgm
A_max1:
    v_max_f32 v46, v48, v49
    s_nop 1
    v_max_f32_dpp v46, v46, v46 row_ror:8 row_mask:0xf bank_mask:0xf
    s_nop 1
    v_max_f32_dpp v46, v46, v46 row_ror:4 row_mask:0xf bank_mask:0xf
    s_nop 1
    v_max_f32_dpp v46, v46, v46 row_ror:2 row_mask:0xf bank_mask:0xf
    s_nop 1
    v_max_f32_dpp v46, v46, v46 row_ror:1 row_mask:0xf bank_mask:0xf
    v_mov_b32 v47, v46
    s_nop 1
    v_permlane16_swap_b32 v47, v46
    v_max_f32 v46, v46, v47
    v_sub_f32 v44, v48, v46
    v_sub_f32 v45, v49, v46
    v_exp_f32 v44, v44
    v_exp_f32 v45, v45
    s_nop 0
    s_branch A_sum1
A_w2:
    v_mov_b32 v84, v1
    v_lshlrev_b32 v113, 4, v1
    s_mul_i32 s26, s25, 0x62000
    s_add_u32 s26, s26, 0x31000
    v_and_b32 v85, 7, v1
    v_min_u32 v85, 6, v85
    v_lshlrev_b32 v85, 2, v85
    s_mul_i32 s27, s25, 512
    s_add_u32 s27, s27, 0x3fca100
    v_mov_b32 v86, 0
    v_and_b32 v91, 31, v1
    v_lshlrev_b32 v91, 2, v91
    v_cmp_gt_u32 vcc, 1, v86
    s_cbranch_vccz L_Awok_66
L_Aw_67:
    s_sub_u32 s23, s23, 1
    s_cbranch_scc1 M_exit
    buffer_load_dword v86, v85, s[4:7], s27 offen sc1
    s_waitcnt vmcnt(0)
    v_cmp_gt_u32 vcc, 1, v86
    s_cbranch_vccnz L_Aw_67
L_Awok_66:
    v_cmp_gt_u32 vcc, 2, v86
    s_cbranch_vccz L_Ag_68
    buffer_load_dword v86, v85, s[4:7], s27 offen sc1
L_Ag_68:
    s_add_u32 s63, s26, 0x2000
    buffer_load_dwordx4 a[0:3], v113, s[4:7], s63 offen
    buffer_load_dwordx4 a[4:7], v113, s[4:7], s63 offen offset:1024
    s_add_u32 s63, s26, 0x2800
    buffer_load_dwordx4 a[8:11], v113, s[4:7], s63 offen
    buffer_load_dwordx4 a[12:15], v113, s[4:7], s63 offen offset:1024
    s_add_u32 s63, s26, 0x3000
    buffer_load_dwordx4 a[16:19], v113, s[4:7], s63 offen
    buffer_load_dwordx4 a[20:23], v113, s[4:7], s63 offen offset:1024
    s_add_u32 s63, s26, 0x0
    buffer_load_dwordx4 a[24:27], v113, s[4:7], s63 offen
    buffer_load_dwordx4 a[28:31], v113, s[4:7], s63 offen offset:1024
    s_add_u32 s63, s26, 0x800
    buffer_load_dwordx4 a[32:35], v113, s[4:7], s63 offen
    buffer_load_dwordx4 a[36:39], v113, s[4:7], s63 offen offset:1024
    s_add_u32 s63, s26, 0x1000
    buffer_load_dwordx4 a[40:43], v113, s[4:7], s63 offen
    buffer_load_dwordx4 a[44:47], v113, s[4:7], s63 offen offset:1024
    s_add_u32 s63, s26, 0x1800
    buffer_load_dwordx4 a[48:51], v113, s[4:7], s63 offen
    buffer_load_dwordx4 a[52:55], v113, s[4:7], s63 offen offset:1024
    s_waitcnt vmcnt(42)
    s_cbranch_vccz L_Ag_69
    s_waitcnt vmcnt(14)
L_Ag_69:
    v_cmp_gt_u32 vcc, 2, v86
    s_cbranch_vccz L_Awok_70
L_Aw_71:
    s_sub_u32 s23, s23, 1
    s_cbranch_scc1 M_exit
    buffer_load_dword v86, v85, s[4:7], s27 offen sc1
    s_waitcnt vmcnt(0)
    v_cmp_gt_u32 vcc, 2, v86
    s_cbranch_vccnz L_Aw_71
L_Awok_70:
    v_cmp_gt_u32 vcc, 3, v86
    s_cbranch_vccz L_Ag_72
    buffer_load_dword v86, v85, s[4:7], s27 offen sc1
L_Ag_72:
    s_add_u32 s63, s26, 0x5800
    buffer_load_dwordx4 a[56:59], v113, s[4:7], s63 offen
    buffer_load_dwordx4 a[60:63], v113, s[4:7], s63 offen offset:1024
    s_add_u32 s63, s26, 0x6000
    buffer_load_dwordx4 a[64:67], v113, s[4:7], s63 offen
    buffer_load_dwordx4 a[68:71], v113, s[4:7], s63 offen offset:1024
    s_add_u32 s63, s26, 0x6800
    buffer_load_dwordx4 a[72:75], v113, s[4:7], s63 offen
    buffer_load_dwordx4 a[76:79], v113, s[4:7], s63 offen offset:1024
    s_add_u32 s63, s26, 0x3800
    buffer_load_dwordx4 a[80:83], v113, s[4:7], s63 offen
    buffer_load_dwordx4 a[84:87], v113, s[4:7], s63 offen offset:1024
    s_add_u32 s63, s26, 0x4000
    buffer_load_dwordx4 a[88:91], v113, s[4:7], s63 offen
    buffer_load_dwordx4 a[92:95], v113, s[4:7], s63 offen offset:1024
    s_add_u32 s63, s26, 0x4800
    buffer_load_dwordx4 a[96:99], v113, s[4:7], s63 offen
    buffer_load_dwordx4 a[100:103], v113, s[4:7], s63 offen offset:1024
    s_add_u32 s63, s26, 0x5000
    buffer_load_dwordx4 a[104:107], v113, s[4:7], s63 offen
    buffer_load_dwordx4 a[108:111], v113, s[4:7], s63 offen offset:1024
    s_waitcnt vmcnt(42)
    s_cbranch_vccz L_Ag_73
    s_waitcnt vmcnt(14)
L_Ag_73:
    v_cmp_gt_u32 vcc, 3, v86
    s_cbranch_vccz L_Awok_74
L_Aw_75:
    s_sub_u32 s23, s23, 1
    s_cbranch_scc1 M_exit
    buffer_load_dword v86, v85, s[4:7], s27 offen sc1
    s_waitcnt vmcnt(0)
    v_cmp_gt_u32 vcc, 3, v86
    s_cbranch_vccnz L_Aw_75
L_Awok_74:
    v_cmp_gt_u32 vcc, 4, v86
    s_cbranch_vccz L_Ag_76
    buffer_load_dword v86, v85, s[4:7], s27 offen sc1
L_Ag_76:
    s_add_u32 s63, s26, 0x9000
    buffer_load_dwordx4 a[112:115], v113, s[4:7], s63 offen
    buffer_load_dwordx4 a[116:119], v113, s[4:7], s63 offen offset:1024
    s_add_u32 s63, s26, 0x9800
    buffer_load_dwordx4 a[120:123], v113, s[4:7], s63 offen
    buffer_load_dwordx4 a[124:127], v113, s[4:7], s63 offen offset:1024
    s_add_u32 s63, s26, 0xa000
    buffer_load_dwordx4 a[128:131], v113, s[4:7], s63 offen
    buffer_load_dwordx4 a[132:135], v113, s[4:7], s63 offen offset:1024
    s_add_u32 s63, s26, 0x7000
    buffer_load_dwordx4 a[136:139], v113, s[4:7], s63 offen
    buffer_load_dwordx4 a[140:143], v113, s[4:7], s63 offen offset:1024
    s_add_u32 s63, s26, 0x7800
    buffer_load_dwordx4 a[144:147], v113, s[4:7], s63 offen
    buffer_load_dwordx4 a[148:151], v113, s[4:7], s63 offen offset:1024
    s_add_u32 s63, s26, 0x8000
    buffer_load_dwordx4 a[152:155], v113, s[4:7], s63 offen
    buffer_load_dwordx4 a[156:159], v113, s[4:7], s63 offen offset:1024
    s_add_u32 s63, s26, 0x8800
    buffer_load_dwordx4 a[160:163], v113, s[4:7], s63 offen
    buffer_load_dwordx4 a[164:167], v113, s[4:7], s63 offen offset:1024
    s_waitcnt vmcnt(42)
    s_cbranch_vccz L_Ag_77
    s_waitcnt vmcnt(14)
L_Ag_77:
    v_cmp_gt_u32 vcc, 4, v86
    s_cbranch_vccz L_Awok_78
L_Aw_79:
    s_sub_u32 s23, s23, 1
    s_cbranch_scc1 M_exit
    buffer_load_dword v86, v85, s[4:7], s27 offen sc1
    s_waitcnt vmcnt(0)
    v_cmp_gt_u32 vcc, 4, v86
    s_cbranch_vccnz L_Aw_79
L_Awok_78:
    v_cmp_gt_u32 vcc, 5, v86
    s_cbranch_vccz L_Ag_80
    buffer_load_dword v86, v85, s[4:7], s27 offen sc1
L_Ag_80:
    s_add_u32 s63, s26, 0xc800
    buffer_load_dwordx4 a[168:171], v113, s[4:7], s63 offen
    buffer_load_dwordx4 a[172:175], v113, s[4:7], s63 offen offset:1024
    s_add_u32 s63, s26, 0xd000
    buffer_load_dwordx4 a[176:179], v113, s[4:7], s63 offen
    buffer_load_dwordx4 a[180:183], v113, s[4:7], s63 offen offset:1024
    s_add_u32 s63, s26, 0xd800
    buffer_load_dwordx4 a[184:187], v113, s[4:7], s63 offen
    buffer_load_dwordx4 a[188:191], v113, s[4:7], s63 offen offset:1024
    s_add_u32 s63, s26, 0xa800
    buffer_load_dwordx4 a[192:195], v113, s[4:7], s63 offen
    buffer_load_dwordx4 a[196:199], v113, s[4:7], s63 offen offset:1024
    s_add_u32 s63, s26, 0xb000
    buffer_load_dwordx4 a[200:203], v113, s[4:7], s63 offen
    buffer_load_dwordx4 a[204:207], v113, s[4:7], s63 offen offset:1024
    s_add_u32 s63, s26, 0xb800
    buffer_load_dwordx4 a[208:211], v113, s[4:7], s63 offen
    buffer_load_dwordx4 a[212:215], v113, s[4:7], s63 offen offset:1024
    s_add_u32 s63, s26, 0xc000
    buffer_load_dwordx4 a[216:219], v113, s[4:7], s63 offen
    buffer_load_dwordx4 a[220:223], v113, s[4:7], s63 offen offset:1024
    s_waitcnt vmcnt(42)
    s_cbranch_vccz L_Ag_81
    s_waitcnt vmcnt(14)
L_Ag_81:
    v_cmp_gt_u32 vcc, 5, v86
    s_cbranch_vccz L_Awok_82
L_Aw_83:
    s_sub_u32 s23, s23, 1
    s_cbranch_scc1 M_exit
    buffer_load_dword v86, v85, s[4:7], s27 offen sc1
    s_waitcnt vmcnt(0)
    v_cmp_gt_u32 vcc, 5, v86
    s_cbranch_vccnz L_Aw_83
L_Awok_82:
    s_mov_b32 s63, 0x3fcc000
    buffer_load_dword v88, v91, s[4:7], s63 offen sc1
    v_mov_b32 v89, 1
    v_cmp_gt_u32 vcc, 6, v86
    s_cbranch_vccz L_Ag_84
    buffer_load_dword v86, v85, s[4:7], s27 offen sc1
L_Ag_84:
    s_add_u32 s63, s26, 0x10000
    buffer_load_dwordx4 a[224:227], v113, s[4:7], s63 offen
    buffer_load_dwordx4 a[228:231], v113, s[4:7], s63 offen offset:1024
    s_add_u32 s63, s26, 0x10800
    buffer_load_dwordx4 a[232:235], v113, s[4:7], s63 offen
    buffer_load_dwordx4 a[236:239], v113, s[4:7], s63 offen offset:1024
    s_add_u32 s63, s26, 0x11000
    buffer_load_dwordx4 a[240:243], v113, s[4:7], s63 offen
    buffer_load_dwordx4 a[244:247], v113, s[4:7], s63 offen offset:1024
    s_add_u32 s63, s26, 0xe000
    buffer_load_dwordx4 a[248:251], v113, s[4:7], s63 offen
    buffer_load_dwordx4 a[252:255], v113, s[4:7], s63 offen offset:1024
    s_add_u32 s63, s26, 0xe800
    buffer_load_dwordx4 v[120:123], v113, s[4:7], s63 offen
    buffer_load_dwordx4 v[124:127], v113, s[4:7], s63 offen offset:1024
    s_add_u32 s63, s26, 0xf000
    buffer_load_dwordx4 v[128:131], v113, s[4:7], s63 offen
    buffer_load_dwordx4 v[132:135], v113, s[4:7], s63 offen offset:1024
    s_add_u32 s63, s26, 0xf800
    buffer_load_dwordx4 v[136:139], v113, s[4:7], s63 offen
    buffer_load_dwordx4 v[140:143], v113, s[4:7], s63 offen offset:1024
    s_waitcnt vmcnt(42)
    s_cbranch_vccz L_Ag_85
    s_waitcnt vmcnt(14)
L_Ag_85:
    v_cmp_gt_u32 vcc, 6, v86
    s_cbranch_vccz L_Awok_86
L_Aw_87:
    s_sub_u32 s23, s23, 1
    s_cbranch_scc1 M_exit
    buffer_load_dword v86, v85, s[4:7], s27 offen sc1
    s_waitcnt vmcnt(0)
    v_cmp_gt_u32 vcc, 6, v86
    s_cbranch_vccnz L_Aw_87
L_Awok_86:
    v_cmp_gt_u32 vcc, 7, v86
    s_cbranch_vccz L_Ag_88
    buffer_load_dword v86, v85, s[4:7], s27 offen sc1
L_Ag_88:
    s_add_u32 s63, s26, 0x13800
    buffer_load_dwordx4 v[144:147], v113, s[4:7], s63 offen
    buffer_load_dwordx4 v[148:151], v113, s[4:7], s63 offen offset:1024
    s_add_u32 s63, s26, 0x14000
    buffer_load_dwordx4 v[152:155], v113, s[4:7], s63 offen
    buffer_load_dwordx4 v[156:159], v113, s[4:7], s63 offen offset:1024
    s_add_u32 s63, s26, 0x14800
    buffer_load_dwordx4 v[160:163], v113, s[4:7], s63 offen
    buffer_load_dwordx4 v[164:167], v113, s[4:7], s63 offen offset:1024
    s_add_u32 s63, s26, 0x11800
    buffer_load_dwordx4 v[168:171], v113, s[4:7], s63 offen
    buffer_load_dwordx4 v[172:175], v113, s[4:7], s63 offen offset:1024
    s_add_u32 s63, s26, 0x12000
    buffer_load_dwordx4 v[176:179], v113, s[4:7], s63 offen
    buffer_load_dwordx4 v[180:183], v113, s[4:7], s63 offen offset:1024
    s_add_u32 s63, s26, 0x12800
    buffer_load_dwordx4 v[184:187], v113, s[4:7], s63 offen
    buffer_load_dwordx4 v[188:191], v113, s[4:7], s63 offen offset:1024
    s_add_u32 s63, s26, 0x13000
    buffer_load_dwordx4 v[192:195], v113, s[4:7], s63 offen
    buffer_load_dwordx4 v[196:199], v113, s[4:7], s63 offen offset:1024
    s_waitcnt vmcnt(42)
    s_cbranch_vccz L_Ag_89
    s_waitcnt vmcnt(14)
L_Ag_89:
    v_cmp_gt_u32 vcc, 7, v86
    s_cbranch_vccz L_Awok_90
L_Aw_91:
    s_sub_u32 s23, s23, 1
    s_cbranch_scc1 M_exit
    buffer_load_dword v86, v85, s[4:7], s27 offen sc1
    s_waitcnt vmcnt(0)
    v_cmp_gt_u32 vcc, 7, v86
    s_cbranch_vccnz L_Aw_91
L_Awok_90:
    s_add_u32 s63, s26, 0x17000
    buffer_load_dwordx4 v[200:203], v113, s[4:7], s63 offen
    buffer_load_dwordx4 v[204:207], v113, s[4:7], s63 offen offset:1024
    s_add_u32 s63, s26, 0x17800
    buffer_load_dwordx4 v[208:211], v113, s[4:7], s63 offen
    buffer_load_dwordx4 v[212:215], v113, s[4:7], s63 offen offset:1024
    s_add_u32 s63, s26, 0x18000
    buffer_load_dwordx4 v[216:219], v113, s[4:7], s63 offen
    buffer_load_dwordx4 v[220:223], v113, s[4:7], s63 offen offset:1024
    s_add_u32 s63, s26, 0x15000
    buffer_load_dwordx4 v[224:227], v113, s[4:7], s63 offen
    buffer_load_dwordx4 v[228:231], v113, s[4:7], s63 offen offset:1024
    s_add_u32 s63, s26, 0x15800
    buffer_load_dwordx4 v[232:235], v113, s[4:7], s63 offen
    buffer_load_dwordx4 v[236:239], v113, s[4:7], s63 offen offset:1024
    s_add_u32 s63, s26, 0x16000
    buffer_load_dwordx4 v[240:243], v113, s[4:7], s63 offen
    buffer_load_dwordx4 v[244:247], v113, s[4:7], s63 offen offset:1024
    s_add_u32 s63, s26, 0x16800
    buffer_load_dwordx4 v[248:251], v113, s[4:7], s63 offen
    buffer_load_dwordx4 v[252:255], v113, s[4:7], s63 offen offset:1024
    s_waitcnt vmcnt(42)
    v_min_u32 v88, v88, v89
    v_cmp_eq_u32 vcc, 0, v88
    s_cbranch_vccz L_Aiok_94
    v_and_b32 v91, 31, v84
    v_lshlrev_b32 v91, 2, v91
L_Ai_95:
    s_sub_u32 s23, s23, 1
    s_cbranch_scc1 M_exit
    s_mov_b32 s63, 0x3fcc000
    buffer_load_dword v88, v91, s[4:7], s63 offen sc1
    v_mov_b32 v89, 1
    s_waitcnt vmcnt(0)
    v_min_u32 v88, v88, v89
    v_cmp_eq_u32 vcc, 0, v88
    s_cbranch_vccnz L_Ai_95
L_Aiok_94:
    v_and_b32 v0, 15, v84
    v_lshrrev_b32 v1, 4, v84
    v_and_b32 v2, 7, v84
    v_bfe_u32 v3, v84, 3, 1
    v_mov_b32 v4, 0x4444
    v_mov_b32 v5, 0xeeee
    v_cmp_eq_u32 vcc, 1, v3
    s_nop 1
    v_cndmask_b32 v112, v4, v5, vcc
    v_and_b32 v4, 1, v1
    v_lshlrev_b32 v4, 2, v4
    v_sub_u32 v4, v2, v4
    v_mov_b32 v6, 0
    v_cmp_eq_u32 vcc, 0, v4
    v_mov_b32 v5, 0x3f80
    s_nop 0
    v_cndmask_b32 v6, v6, v5, vcc
    v_cmp_eq_u32 vcc, 1, v4
    v_mov_b32 v5, 0x3f800000
    s_nop 0
    v_cndmask_b32 v6, v6, v5, vcc
    v_cmp_eq_u32 vcc, 0, v3
    s_nop 1
    v_cndmask_b32 v108, 0, v6, vcc
    v_cmp_eq_u32 vcc, 1, v3
    s_nop 1
    v_cndmask_b32 v110, 0, v6, vcc
    v_mov_b32 v6, 0
    v_cmp_eq_u32 vcc, 2, v4
    v_mov_b32 v5, 0x3f80
    s_nop 0
    v_cndmask_b32 v6, v6, v5, vcc
    v_cmp_eq_u32 vcc, 3, v4
    v_mov_b32 v5, 0x3f800000
    s_nop 0
    v_cndmask_b32 v6, v6, v5, vcc
    v_cmp_eq_u32 vcc, 0, v3
    s_nop 1
    v_cndmask_b32 v109, 0, v6, vcc
    v_cmp_eq_u32 vcc, 1, v3
    s_nop 1
    v_cndmask_b32 v111, 0, v6, vcc
    v_lshlrev_b32 v4, 4, v2
    v_lshl_add_u32 v114, v1, 8, v4
    v_lshrrev_b32 v5, 1, v1
    v_lshl_add_u32 v4, v5, 8, v4
    v_and_b32 v6, 1, v1
    v_cmp_eq_u32 vcc, 1, v6
    v_mov_b32 v7, 5120
    v_mov_b32 v8, 6272
    v_cndmask_b32 v7, v7, v8, vcc
    v_add_u32 v115, v4, v7
    v_lshl_add_u32 v4, v6, 2, v5
    v_mul_u32_u24 v4, 208, v4
    v_lshl_add_u32 v4, v0, 2, v4
    v_add_u32 v116, 44288, v4
    v_lshrrev_b32 v4, 5, v84
    v_and_b32 v9, 31, v84
    v_bfe_u32 v12, v9, 2, 1
    v_and_b32 v13, 2, v9
    v_or_b32 v12, v12, v13
    v_bfe_u32 v13, v9, 3, 1
    v_lshl_or_b32 v12, v13, 2, v12
    v_and_b32 v13, 1, v9
    v_lshl_or_b32 v12, v13, 3, v12
    v_bfe_u32 v14, v9, 1, 1
    v_lshl_or_b32 v13, v13, 1, v14
    v_or_b32 v13, 16, v13
    v_cmp_gt_u32 s[28:29], 20, v9
    v_cmp_gt_u32 vcc, 16, v9
    v_add_u32 v10, 4, v4
    v_mul_u32_u24 v11, 208, v10
    v_cndmask_b32 v9, v13, v12, vcc
    v_cndmask_b32 v12, 0, v9, s[28:29]
    v_lshl_add_u32 v11, v12, 3, v11
    v_add_u32 v118, 40960, v11
    v_mov_b32 v12, 47616
    v_cndmask_b32 v117, v12, v118, s[28:29]
    s_and_b32 s27, s25, 1
    s_bfe_u32 s30, s25, 0x10001
    s_lshr_b32 s31, s25, 2
    v_bfe_u32 v12, v9, 2, 1
    v_lshlrev_b32 v12, 8, v12
    v_and_b32 v13, 1, v9
    v_lshl_add_u32 v12, v13, 7, v12
    v_bfe_u32 v14, v9, 1, 1
    v_lshl_add_u32 v12, v14, 3, v12
    v_bfe_u32 v15, v9, 3, 1
    v_lshl_add_u32 v12, v15, 2, v12
    s_lshl_b32 s32, s30, 10
    s_lshl_b32 s33, s27, 9
    s_add_u32 s32, s32, s33
    v_add_u32 v12, s32, v12
    v_lshlrev_b32 v14, 3, v14
    v_lshl_add_u32 v14, v13, 7, v14
    s_lshl_b32 s32, s27, 2
    s_lshl_b32 s33, s30, 8
    s_add_u32 s32, s32, s33
    s_add_u32 s32, s32, 2048
    v_add_u32 v14, s32, v14
    v_cmp_gt_u32 vcc, 16, v9
    s_nop 1
    v_cndmask_b32 v12, v14, v12, vcc
    v_lshl_add_u32 v12, v10, 4, v12
    s_mul_i32 s32, s31, 2560
    v_add_u32 v12, s32, v12
    v_mov_b32 v13, 0x40000000
    v_cndmask_b32 v119, v13, v12, s[28:29]
    s_mov_b64 s[56:57], s[28:29]
    s_mov_b32 s33, 0x42800000
    s_mov_b32 s24, 0
    s_mov_b32 s26, 0xfc0000
    s_mov_b32 s27, 0x10a0000
    s_mov_b32 s28, 0x3dcc000
    s_mov_b32 m0, 24576
    s_add_u32 s29, s28, 4096
    buffer_load_dwordx4 v113, s[4:7], s28 offen offset:0 lds
    buffer_load_dwordx4 v113, s[4:7], s28 offen offset:1024 lds
    buffer_load_dwordx4 v113, s[4:7], s28 offen offset:2048 lds
    buffer_load_dwordx4 v113, s[4:7], s28 offen offset:3072 lds
    s_mov_b32 m0, 28672
    s_nop 0
    buffer_load_dwordx4 v113, s[4:7], s29 offen offset:2048 lds
    buffer_load_dwordx4 v113, s[4:7], s29 offen offset:3072 lds
    buffer_load_dwordx4 v113, s[4:7], s29 offen offset:0 lds
    buffer_load_dwordx4 v113, s[4:7], s29 offen offset:1024 lds
    s_add_u32 s28, s28, 32768
A_top2:
    s_waitcnt vmcnt(0)
    ds_read_b128 v[60:63], v113 offset:24576
    ds_read_b128 v[64:67], v113 offset:25600
    ds_read_b128 v[68:71], v113 offset:26624
    ds_read_b128 v[72:75], v113 offset:27648
    v_mov_b64 v[32:33], 0
    v_mov_b64 v[34:35], 0
    v_mov_b64 v[36:37], 0
    v_mov_b64 v[38:39], 0
    v_mov_b64 v[40:41], 0
    v_mov_b64 v[42:43], 0
    v_mov_b64 v[44:45], 0
    v_mov_b64 v[46:47], 0
    v_mov_b64 v[48:49], 0
    v_mov_b64 v[50:51], 0
    v_mov_b64 v[52:53], 0
    v_mov_b64 v[54:55], 0
    v_mov_b64 v[56:57], 0
    v_mov_b64 v[58:59], 0
    s_add_u32 s30, s26, 4096
    s_add_u32 s31, s26, 5120
    s_waitcnt lgkmcnt(0)
    buffer_load_dwordx4 v[0:3], v113, s[4:7], s30 offen sc1
    buffer_load_dwordx4 v[4:7], v113, s[4:7], s31 offen sc1
L_Apoll_96:
    s_sub_u32 s23, s23, 1
    s_cbranch_scc1 M_exit
    buffer_load_dwordx4 v[0:3], v113, s[4:7], s30 offen sc1
    buffer_load_dwordx4 v[4:7], v113, s[4:7], s31 offen sc1
    s_waitcnt vmcnt(2)
    v_max3_u32 v84, v0, v1, v2
    v_max3_u32 v84, v84, v3, v4
    v_max3_u32 v84, v84, v5, v6
    v_max_u32 v84, v84, v7
    v_cmp_eq_u32 vcc, -1, v84
    s_cbranch_vccnz L_Apoll_96
    ds_write_b128 v113, v[0:3] offset:4096
    ds_write_b128 v113, v[4:7] offset:5120
    v_smfmac_f32_16x16x64_bf16 v[32:35], v[0:3], a[0:7], v112
    v_smfmac_f32_16x16x64_bf16 v[36:39], v[0:3], a[56:63], v112
    v_smfmac_f32_16x16x64_bf16 v[40:43], v[0:3], a[112:119], v112
    v_smfmac_f32_16x16x64_bf16 v[44:47], v[0:3], a[168:175], v112
    v_smfmac_f32_16x16x64_bf16 v[48:51], v[0:3], a[224:231], v112
    v_smfmac_f32_16x16x64_bf16 v[52:55], v[0:3], v[144:151], v112
    s_waitcnt lgkmcnt(0)
    s_barrier
    ds_read_b128 v[8:11], v113 offset:6144
    ds_read_b128 v[16:19], v113 offset:0
    v_smfmac_f32_16x16x64_bf16 v[56:59], v[0:3], v[200:207], v112
    ds_read_b128 v[20:23], v113 offset:1024
    v_smfmac_f32_16x16x64_bf16 v[32:35], v[4:7], a[8:15], v112
    ds_read_b128 v[24:27], v113 offset:2048
    v_smfmac_f32_16x16x64_bf16 v[36:39], v[4:7], a[64:71], v112
    ds_read_b128 v[28:31], v113 offset:3072
    v_smfmac_f32_16x16x64_bf16 v[40:43], v[4:7], a[120:127], v112
    ds_read_b128 v[76:79], v114 offset:2048
    v_smfmac_f32_16x16x64_bf16 v[44:47], v[4:7], a[176:183], v112
    ds_read_b128 v[80:83], v114 offset:2176
    v_smfmac_f32_16x16x64_bf16 v[48:51], v[4:7], a[232:239], v112
    v_smfmac_f32_16x16x64_bf16 v[52:55], v[4:7], v[152:159], v112
    v_smfmac_f32_16x16x64_bf16 v[56:59], v[4:7], v[208:215], v112
    s_waitcnt lgkmcnt(6)
    v_smfmac_f32_16x16x64_bf16 v[32:35], v[8:11], a[16:23], v112
    s_waitcnt vmcnt(0)
    ds_read_b128 v[0:3], v113 offset:30720
    v_smfmac_f32_16x16x64_bf16 v[36:39], v[8:11], a[72:79], v112
    ds_read_b128 v[4:7], v113 offset:31744
    v_smfmac_f32_16x16x64_bf16 v[40:43], v[8:11], a[128:135], v112
    v_smfmac_f32_16x16x64_bf16 v[44:47], v[8:11], a[184:191], v112
    s_mov_b32 m0, 24576
    s_add_u32 s29, s28, 4096
    buffer_load_dwordx4 v113, s[4:7], s28 offen offset:0 lds
    v_smfmac_f32_16x16x64_bf16 v[48:51], v[8:11], a[240:247], v112
    v_smfmac_f32_16x16x64_bf16 v[52:55], v[8:11], v[160:167], v112
    buffer_load_dwordx4 v113, s[4:7], s28 offen offset:1024 lds
    v_smfmac_f32_16x16x64_bf16 v[56:59], v[8:11], v[216:223], v112
    s_waitcnt lgkmcnt(4)
    v_smfmac_f32_16x16x64_bf16 v[32:35], v[16:19], a[24:31], v112
    ds_read_b128 v[8:11], v113 offset:28672
    v_smfmac_f32_16x16x64_bf16 v[32:35], v[20:23], a[32:39], v112
    ds_read_b128 v[12:15], v113 offset:29696
    v_smfmac_f32_16x16x64_bf16 v[32:35], v[24:27], a[40:47], v112
    buffer_load_dwordx4 v113, s[4:7], s28 offen offset:2048 lds
    v_smfmac_f32_16x16x64_bf16 v[32:35], v[28:31], a[48:55], v112
    v_smfmac_f32_16x16x64_bf16 v[36:39], v[16:19], a[80:87], v112
    buffer_load_dwordx4 v113, s[4:7], s28 offen offset:3072 lds
    v_smfmac_f32_16x16x64_bf16 v[36:39], v[20:23], a[88:95], v112
    v_cvt_pk_bf16_f32 v84, v32, v33
    v_smfmac_f32_16x16x64_bf16 v[36:39], v[24:27], a[96:103], v112
    v_cvt_pk_bf16_f32 v85, v34, v35
    v_smfmac_f32_16x16x64_bf16 v[36:39], v[28:31], a[104:111], v112
    v_mov_b64 v[32:33], 0
    v_smfmac_f32_16x16x64_bf16 v[40:43], v[16:19], a[136:143], v112
    v_mov_b64 v[34:35], 0
    v_smfmac_f32_16x16x64_bf16 v[40:43], v[20:23], a[144:151], v112
    v_cvt_pk_bf16_f32 v86, v36, v37
    v_smfmac_f32_16x16x64_bf16 v[40:43], v[24:27], a[152:159], v112
    v_cvt_pk_bf16_f32 v87, v38, v39
    v_smfmac_f32_16x16x64_bf16 v[40:43], v[28:31], a[160:167], v112
    v_mov_b64 v[36:37], 0
    v_mfma_f32_16x16x32_bf16 v[92:95], v[84:87], v[108:111], 0
    s_waitcnt lgkmcnt(0)
    s_mov_b32 m0, 28672
    s_nop 0
    buffer_load_dwordx4 v113, s[4:7], s29 offen offset:2048 lds
    v_smfmac_f32_16x16x64_bf16 v[44:47], v[16:19], a[192:199], v112
    v_mov_b64 v[38:39], 0
    v_smfmac_f32_16x16x64_bf16 v[44:47], v[20:23], a[200:207], v112
    v_cvt_pk_bf16_f32 v88, v40, v41
    v_smfmac_f32_16x16x64_bf16 v[44:47], v[24:27], a[208:215], v112
    v_cvt_pk_bf16_f32 v89, v42, v43
    v_smfmac_f32_16x16x64_bf16 v[44:47], v[28:31], a[216:223], v112
    v_cvt_pk_bf16_f32 v100, v92, v93
    v_smfmac_f32_16x16x64_bf16 v[48:51], v[16:19], a[248:255], v112
    v_cvt_pk_bf16_f32 v101, v94, v95
    v_smfmac_f32_16x16x64_bf16 v[48:51], v[20:23], v[120:127], v112
    v_cvt_pk_bf16_f32 v90, v44, v45
    v_smfmac_f32_16x16x64_bf16 v[48:51], v[24:27], v[128:135], v112
    v_cvt_pk_bf16_f32 v91, v46, v47
    v_smfmac_f32_16x16x64_bf16 v[48:51], v[28:31], v[136:143], v112
    v_mov_b64 v[40:41], 0
    v_mfma_f32_16x16x32_bf16 v[96:99], v[88:91], v[108:111], 0
    buffer_load_dwordx4 v113, s[4:7], s29 offen offset:3072 lds
    v_smfmac_f32_16x16x64_bf16 v[52:55], v[16:19], v[168:175], v112
    v_mov_b64 v[42:43], 0
    v_smfmac_f32_16x16x64_bf16 v[52:55], v[20:23], v[176:183], v112
    v_cvt_pk_bf16_f32 v84, v48, v49
    v_smfmac_f32_16x16x64_bf16 v[52:55], v[24:27], v[184:191], v112
    v_cvt_pk_bf16_f32 v85, v50, v51
    v_smfmac_f32_16x16x64_bf16 v[52:55], v[28:31], v[192:199], v112
    v_cvt_pk_bf16_f32 v102, v96, v97
    v_smfmac_f32_16x16x64_bf16 v[56:59], v[16:19], v[224:231], v112
    v_cvt_pk_bf16_f32 v103, v98, v99
    v_smfmac_f32_16x16x64_bf16 v[56:59], v[20:23], v[232:239], v112
    v_cvt_pk_bf16_f32 v86, v52, v53
    v_smfmac_f32_16x16x64_bf16 v[56:59], v[24:27], v[240:247], v112
    v_cvt_pk_bf16_f32 v87, v54, v55
    v_smfmac_f32_16x16x64_bf16 v[56:59], v[28:31], v[248:255], v112
    ds_read_b128 v[44:47], v115 offset:0
    v_mfma_f32_16x16x32_bf16 v[92:95], v[84:87], v[108:111], 0
    ds_read_b128 v[48:51], v115 offset:512
    v_smfmac_f32_16x16x64_bf16 v[32:35], v[100:103], v[60:67], v112
    v_cvt_pk_bf16_f32 v88, v56, v57
    v_cvt_pk_bf16_f32 v89, v58, v59
    s_nop 1
    v_mfma_f32_16x16x16_bf16 v[96:99], v[88:89], v[108:109], 0
    v_cvt_pk_bf16_f32 v104, v92, v93
    v_smfmac_f32_16x16x64_bf16 v[36:39], v[100:103], v[68:75], v112
    v_cvt_pk_bf16_f32 v105, v94, v95
    v_smfmac_f32_16x16x64_bf16 v[40:43], v[100:103], v[76:83], v112
    v_cvt_pk_bf16_f32 v106, v96, v97
    v_cvt_pk_bf16_f32 v107, v98, v99
    s_waitcnt lgkmcnt(0)
    s_nop 0
    v_smfmac_f32_16x16x64_bf16 v[32:35], v[104:107], v[8:15], v112
    v_smfmac_f32_16x16x64_bf16 v[36:39], v[104:107], v[0:7], v112
    v_smfmac_f32_16x16x64_bf16 v[40:43], v[104:107], v[44:51], v112
    v_permlane32_swap_b32 v32, v33
    v_permlane32_swap_b32 v34, v35
    v_add_f32 v32, v32, v33
    v_add_f32 v34, v34, v35
    ds_write2_b32 v116, v32, v34 offset0:0 offset1:104
    v_permlane32_swap_b32 v36, v37
    v_permlane32_swap_b32 v38, v39
    v_add_f32 v36, v36, v37
    v_add_f32 v38, v38, v39
    ds_write2_b32 v116, v36, v38 offset0:16 offset1:120
    s_nop 0
    v_permlane32_swap_b32 v40, v41
    v_permlane32_swap_b32 v42, v43
    v_add_f32 v40, v40, v41
    v_add_f32 v42, v42, v43
    ds_write2_b32 v116, v40, v42 offset0:32 offset1:136
    s_waitcnt lgkmcnt(0)
    s_barrier
    ds_read_b64 v[44:45], v117
    ds_read_b64 v[46:47], v118 offset:1664
    ds_read_b64 v[48:49], v118 offset:3328
    ds_read_b64 v[50:51], v118 offset:4992
    buffer_load_dwordx4 v113, s[4:7], s29 offen offset:0 lds
    buffer_load_dwordx4 v113, s[4:7], s29 offen offset:1024 lds
    s_waitcnt lgkmcnt(2)
    v_add_f32 v44, v44, v46
    v_add_f32 v45, v45, v47
    s_waitcnt lgkmcnt(0)
    v_add_f32 v48, v48, v50
    v_add_f32 v49, v49, v51
    v_add_f32 v48, v44, v48
    v_add_f32 v49, v45, v49
    v_max_f32 v46, |v48|, |v49|
    v_exp_f32 v44, v48
    v_cmp_lt_f32 vcc, s33, v46
    v_exp_f32 v45, v49
    s_and_b64 vcc, vcc, s[56:57]
    s_cbranch_scc1 A_max2
A_sum2:
    v_add_f32 v46, v44, v45
    s_nop 1
    v_add_f32_dpp v46, v46, v46 row_ror:8 row_mask:0xf bank_mask:0xf
    s_nop 1
    v_add_f32_dpp v46, v46, v46 row_ror:4 row_mask:0xf bank_mask:0xf
    s_nop 1
    v_add_f32_dpp v46, v46, v46 row_ror:2 row_mask:0xf bank_mask:0xf
    s_nop 1
    v_add_f32_dpp v46, v46, v46 row_ror:1 row_mask:0xf bank_mask:0xf
    v_mov_b32 v47, v46
    s_nop 1
    v_permlane16_swap_b32 v47, v46
    v_add_f32 v46, v46, v47
    v_rcp_f32 v46, v46
    s_nop 0
    v_mul_f32 v44, v44, v46
    v_mul_f32 v45, v45, v46
    v_cvt_pk_bf16_f32 v44, v44, v45
    v_min_u32 v44, -2, v44
    buffer_store_dword v44, v119, s[4:7], s27 offen
    s_add_u32 s24, s24, 1
    s_add_u32 s26, s26, 7168
    s_add_u32 s27, s27, 10240
    s_add_u32 s28, s28, 32768
    s_cmp_lt_u32 s24, 63
    s_cbranch_scc1 A_top2
    s_endpgm
A_max2:
    v_max_f32 v46, v48, v49
    s_nop 1
    v_max_f32_dpp v46, v46, v46 row_ror:8 row_mask:0xf bank_mask:0xf
    s_nop 1
    v_max_f32_dpp v46, v46, v46 row_ror:4 row_mask:0xf bank_mask:0xf
    s_nop 1
    v_max_f32_dpp v46, v46, v46 row_ror:2 row_mask:0xf bank_mask:0xf
    s_nop 1
    v_max_f32_dpp v46, v46, v46 row_ror:1 row_mask:0xf bank_mask:0xf
    v_mov_b32 v47, v46
    s_nop 1
    v_permlane16_swap_b32 v47, v46
    v_max_f32 v46, v46, v47
    v_sub_f32 v44, v48, v46
    v_sub_f32 v45, v49, v46
    v_exp_f32 v44, v44
    v_exp_f32 v45, v45
    s_nop 0
    s_branch A_sum2
A_w3:
    v_mov_b32 v84, v1
    v_lshlrev_b32 v113, 4, v1
    s_mul_i32 s26, s25, 0x62000
    s_add_u32 s26, s26, 0x49800
    v_and_b32 v85, 7, v1
    v_min_u32 v85, 6, v85
    v_lshlrev_b32 v85, 2, v85
    s_mul_i32 s27, s25, 512
    s_add_u32 s27, s27, 0x3fca180
    v_mov_b32 v86, 0
    v_and_b32 v91, 31, v1
    v_lshlrev_b32 v91, 2, v91
    v_cmp_gt_u32 vcc, 1, v86
    s_cbranch_vccz L_Awok_97
L_Aw_98:
    s_sub_u32 s23, s23, 1
    s_cbranch_scc1 M_exit
    buffer_load_dword v86, v85, s[4:7], s27 offen sc1
    s_waitcnt vmcnt(0)
    v_cmp_gt_u32 vcc, 1, v86
    s_cbranch_vccnz L_Aw_98
L_Awok_97:
    v_cmp_gt_u32 vcc, 2, v86
    s_cbranch_vccz L_Ag_99
    buffer_load_dword v86, v85, s[4:7], s27 offen sc1
L_Ag_99:
    s_add_u32 s63, s26, 0x3000
    buffer_load_dwordx4 a[0:3], v113, s[4:7], s63 offen
    buffer_load_dwordx4 a[4:7], v113, s[4:7], s63 offen offset:1024
    s_add_u32 s63, s26, 0x0
    buffer_load_dwordx4 a[8:11], v113, s[4:7], s63 offen
    buffer_load_dwordx4 a[12:15], v113, s[4:7], s63 offen offset:1024
    s_add_u32 s63, s26, 0x800
    buffer_load_dwordx4 a[16:19], v113, s[4:7], s63 offen
    buffer_load_dwordx4 a[20:23], v113, s[4:7], s63 offen offset:1024
    s_add_u32 s63, s26, 0x1000
    buffer_load_dwordx4 a[24:27], v113, s[4:7], s63 offen
    buffer_load_dwordx4 a[28:31], v113, s[4:7], s63 offen offset:1024
    s_add_u32 s63, s26, 0x1800
    buffer_load_dwordx4 a[32:35], v113, s[4:7], s63 offen
    buffer_load_dwordx4 a[36:39], v113, s[4:7], s63 offen offset:1024
    s_add_u32 s63, s26, 0x2000
    buffer_load_dwordx4 a[40:43], v113, s[4:7], s63 offen
    buffer_load_dwordx4 a[44:47], v113, s[4:7], s63 offen offset:1024
    s_add_u32 s63, s26, 0x2800
    buffer_load_dwordx4 a[48:51], v113, s[4:7], s63 offen
    buffer_load_dwordx4 a[52:55], v113, s[4:7], s63 offen offset:1024
    s_waitcnt vmcnt(42)
    s_cbranch_vccz L_Ag_100
    s_waitcnt vmcnt(14)
L_Ag_100:
    v_cmp_gt_u32 vcc, 2, v86
    s_cbranch_vccz L_Awok_101
L_Aw_102:
    s_sub_u32 s23, s23, 1
    s_cbranch_scc1 M_exit
    buffer_load_dword v86, v85, s[4:7], s27 offen sc1
    s_waitcnt vmcnt(0)
    v_cmp_gt_u32 vcc, 2, v86
    s_cbranch_vccnz L_Aw_102
L_Awok_101:
    v_cmp_gt_u32 vcc, 3, v86
    s_cbranch_vccz L_Ag_103
    buffer_load_dword v86, v85, s[4:7], s27 offen sc1
L_Ag_103:
    s_add_u32 s63, s26, 0x6800
    buffer_load_dwordx4 a[56:59], v113, s[4:7], s63 offen
    buffer_load_dwordx4 a[60:63], v113, s[4:7], s63 offen offset:1024
    s_add_u32 s63, s26, 0x3800
    buffer_load_dwordx4 a[64:67], v113, s[4:7], s63 offen
    buffer_load_dwordx4 a[68:71], v113, s[4:7], s63 offen offset:1024
    s_add_u32 s63, s26, 0x4000
    buffer_load_dwordx4 a[72:75], v113, s[4:7], s63 offen
    buffer_load_dwordx4 a[76:79], v113, s[4:7], s63 offen offset:1024
    s_add_u32 s63, s26, 0x4800
    buffer_load_dwordx4 a[80:83], v113, s[4:7], s63 offen
    buffer_load_dwordx4 a[84:87], v113, s[4:7], s63 offen offset:1024
    s_add_u32 s63, s26, 0x5000
    buffer_load_dwordx4 a[88:91], v113, s[4:7], s63 offen
    buffer_load_dwordx4 a[92:95], v113, s[4:7], s63 offen offset:1024
    s_add_u32 s63, s26, 0x5800
    buffer_load_dwordx4 a[96:99], v113, s[4:7], s63 offen
    buffer_load_dwordx4 a[100:103], v113, s[4:7], s63 offen offset:1024
    s_add_u32 s63, s26, 0x6000
    buffer_load_dwordx4 a[104:107], v113, s[4:7], s63 offen
    buffer_load_dwordx4 a[108:111], v113, s[4:7], s63 offen offset:1024
    s_waitcnt vmcnt(42)
    s_cbranch_vccz L_Ag_104
    s_waitcnt vmcnt(14)
L_Ag_104:
    v_cmp_gt_u32 vcc, 3, v86
    s_cbranch_vccz L_Awok_105
L_Aw_106:
    s_sub_u32 s23, s23, 1
    s_cbranch_scc1 M_exit
    buffer_load_dword v86, v85, s[4:7], s27 offen sc1
    s_waitcnt vmcnt(0)
    v_cmp_gt_u32 vcc, 3, v86
    s_cbranch_vccnz L_Aw_106
L_Awok_105:
    v_cmp_gt_u32 vcc, 4, v86
    s_cbranch_vccz L_Ag_107
    buffer_load_dword v86, v85, s[4:7], s27 offen sc1
L_Ag_107:
    s_add_u32 s63, s26, 0xa000
    buffer_load_dwordx4 a[112:115], v113, s[4:7], s63 offen
    buffer_load_dwordx4 a[116:119], v113, s[4:7], s63 offen offset:1024
    s_add_u32 s63, s26, 0x7000
    buffer_load_dwordx4 a[120:123], v113, s[4:7], s63 offen
    buffer_load_dwordx4 a[124:127], v113, s[4:7], s63 offen offset:1024
    s_add_u32 s63, s26, 0x7800
    buffer_load_dwordx4 a[128:131], v113, s[4:7], s63 offen
    buffer_load_dwordx4 a[132:135], v113, s[4:7], s63 offen offset:1024
    s_add_u32 s63, s26, 0x8000
    buffer_load_dwordx4 a[136:139], v113, s[4:7], s63 offen
    buffer_load_dwordx4 a[140:143], v113, s[4:7], s63 offen offset:1024
    s_add_u32 s63, s26, 0x8800
    buffer_load_dwordx4 a[144:147], v113, s[4:7], s63 offen
    buffer_load_dwordx4 a[148:151], v113, s[4:7], s63 offen offset:1024
    s_add_u32 s63, s26, 0x9000
    buffer_load_dwordx4 a[152:155], v113, s[4:7], s63 offen
    buffer_load_dwordx4 a[156:159], v113, s[4:7], s63 offen offset:1024
    s_add_u32 s63, s26, 0x9800
    buffer_load_dwordx4 a[160:163], v113, s[4:7], s63 offen
    buffer_load_dwordx4 a[164:167], v113, s[4:7], s63 offen offset:1024
    s_waitcnt vmcnt(42)
    s_cbranch_vccz L_Ag_108
    s_waitcnt vmcnt(14)
L_Ag_108:
    v_cmp_gt_u32 vcc, 4, v86
    s_cbranch_vccz L_Awok_109
L_Aw_110:
    s_sub_u32 s23, s23, 1
    s_cbranch_scc1 M_exit
    buffer_load_dword v86, v85, s[4:7], s27 offen sc1
    s_waitcnt vmcnt(0)
    v_cmp_gt_u32 vcc, 4, v86
    s_cbranch_vccnz L_Aw_110
L_Awok_109:
    v_cmp_gt_u32 vcc, 5, v86
    s_cbranch_vccz L_Ag_111
    buffer_load_dword v86, v85, s[4:7], s27 offen sc1
L_Ag_111:
    s_add_u32 s63, s26, 0xd800
    buffer_load_dwordx4 a[168:171], v113, s[4:7], s63 offen
    buffer_load_dwordx4 a[172:175], v113, s[4:7], s63 offen offset:1024
    s_add_u32 s63, s26, 0xa800
    buffer_load_dwordx4 a[176:179], v113, s[4:7], s63 offen
    buffer_load_dwordx4 a[180:183], v113, s[4:7], s63 offen offset:1024
    s_add_u32 s63, s26, 0xb000
    buffer_load_dwordx4 a[184:187], v113, s[4:7], s63 offen
    buffer_load_dwordx4 a[188:191], v113, s[4:7], s63 offen offset:1024
    s_add_u32 s63, s26, 0xb800
    buffer_load_dwordx4 a[192:195], v113, s[4:7], s63 offen
    buffer_load_dwordx4 a[196:199], v113, s[4:7], s63 offen offset:1024
    s_add_u32 s63, s26, 0xc000
    buffer_load_dwordx4 a[200:203], v113, s[4:7], s63 offen
    buffer_load_dwordx4 a[204:207], v113, s[4:7], s63 offen offset:1024
    s_add_u32 s63, s26, 0xc800
    buffer_load_dwordx4 a[208:211], v113, s[4:7], s63 offen
    buffer_load_dwordx4 a[212:215], v113, s[4:7], s63 offen offset:1024
    s_add_u32 s63, s26, 0xd000
    buffer_load_dwordx4 a[216:219], v113, s[4:7], s63 offen
    buffer_load_dwordx4 a[220:223], v113, s[4:7], s63 offen offset:1024
    s_waitcnt vmcnt(42)
    s_cbranch_vccz L_Ag_112
    s_waitcnt vmcnt(14)
L_Ag_112:
    v_cmp_gt_u32 vcc, 5, v86
    s_cbranch_vccz L_Awok_113
L_Aw_114:
    s_sub_u32 s23, s23, 1
    s_cbranch_scc1 M_exit
    buffer_load_dword v86, v85, s[4:7], s27 offen sc1
    s_waitcnt vmcnt(0)
    v_cmp_gt_u32 vcc, 5, v86
    s_cbranch_vccnz L_Aw_114
L_Awok_113:
    s_mov_b32 s63, 0x3fcc000
    buffer_load_dword v88, v91, s[4:7], s63 offen sc1
    v_mov_b32 v89, 1
    v_cmp_gt_u32 vcc, 6, v86
    s_cbranch_vccz L_Ag_115
    buffer_load_dword v86, v85, s[4:7], s27 offen sc1
L_Ag_115:
    s_add_u32 s63, s26, 0x11000
    buffer_load_dwordx4 a[224:227], v113, s[4:7], s63 offen
    buffer_load_dwordx4 a[228:231], v113, s[4:7], s63 offen offset:1024
    s_add_u32 s63, s26, 0xe000
    buffer_load_dwordx4 a[232:235], v113, s[4:7], s63 offen
    buffer_load_dwordx4 a[236:239], v113, s[4:7], s63 offen offset:1024
    s_add_u32 s63, s26, 0xe800
    buffer_load_dwordx4 a[240:243], v113, s[4:7], s63 offen
    buffer_load_dwordx4 a[244:247], v113, s[4:7], s63 offen offset:1024
    s_add_u32 s63, s26, 0xf000
    buffer_load_dwordx4 a[248:251], v113, s[4:7], s63 offen
    buffer_load_dwordx4 a[252:255], v113, s[4:7], s63 offen offset:1024
    s_add_u32 s63, s26, 0xf800
    buffer_load_dwordx4 v[120:123], v113, s[4:7], s63 offen
    buffer_load_dwordx4 v[124:127], v113, s[4:7], s63 offen offset:1024
    s_add_u32 s63, s26, 0x10000
    buffer_load_dwordx4 v[128:131], v113, s[4:7], s63 offen
    buffer_load_dwordx4 v[132:135], v113, s[4:7], s63 offen offset:1024
    s_add_u32 s63, s26, 0x10800
    buffer_load_dwordx4 v[136:139], v113, s[4:7], s63 offen
    buffer_load_dwordx4 v[140:143], v113, s[4:7], s63 offen offset:1024
    s_waitcnt vmcnt(42)
    s_cbranch_vccz L_Ag_116
    s_waitcnt vmcnt(14)
L_Ag_116:
    v_cmp_gt_u32 vcc, 6, v86
    s_cbranch_vccz L_Awok_117
L_Aw_118:
    s_sub_u32 s23, s23, 1
    s_cbranch_scc1 M_exit
    buffer_load_dword v86, v85, s[4:7], s27 offen sc1
    s_waitcnt vmcnt(0)
    v_cmp_gt_u32 vcc, 6, v86
    s_cbranch_vccnz L_Aw_118
L_Awok_117:
    v_cmp_gt_u32 vcc, 7, v86
    s_cbranch_vccz L_Ag_119
    buffer_load_dword v86, v85, s[4:7], s27 offen sc1
L_Ag_119:
    s_add_u32 s63, s26, 0x14800
    buffer_load_dwordx4 v[144:147], v113, s[4:7], s63 offen
    buffer_load_dwordx4 v[148:151], v113, s[4:7], s63 offen offset:1024
    s_add_u32 s63, s26, 0x11800
    buffer_load_dwordx4 v[152:155], v113, s[4:7], s63 offen
    buffer_load_dwordx4 v[156:159], v113, s[4:7], s63 offen offset:1024
    s_add_u32 s63, s26, 0x12000
    buffer_load_dwordx4 v[160:163], v113, s[4:7], s63 offen
    buffer_load_dwordx4 v[164:167], v113, s[4:7], s63 offen offset:1024
    s_add_u32 s63, s26, 0x12800
    buffer_load_dwordx4 v[168:171], v113, s[4:7], s63 offen
    buffer_load_dwordx4 v[172:175], v113, s[4:7], s63 offen offset:1024
    s_add_u32 s63, s26, 0x13000
    buffer_load_dwordx4 v[176:179], v113, s[4:7], s63 offen
    buffer_load_dwordx4 v[180:183], v113, s[4:7], s63 offen offset:1024
    s_add_u32 s63, s26, 0x13800
    buffer_load_dwordx4 v[184:187], v113, s[4:7], s63 offen
    buffer_load_dwordx4 v[188:191], v113, s[4:7], s63 offen offset:1024
    s_add_u32 s63, s26, 0x14000
    buffer_load_dwordx4 v[192:195], v113, s[4:7], s63 offen
    buffer_load_dwordx4 v[196:199], v113, s[4:7], s63 offen offset:1024
    s_waitcnt vmcnt(42)
    s_cbranch_vccz L_Ag_120
    s_waitcnt vmcnt(14)
L_Ag_120:
    v_cmp_gt_u32 vcc, 7, v86
    s_cbranch_vccz L_Awok_121
L_Aw_122:
    s_sub_u32 s23, s23, 1
    s_cbranch_scc1 M_exit
    buffer_load_dword v86, v85, s[4:7], s27 offen sc1
    s_waitcnt vmcnt(0)
    v_cmp_gt_u32 vcc, 7, v86
    s_cbranch_vccnz L_Aw_122
L_Awok_121:
    s_add_u32 s63, s26, 0x18000
    buffer_load_dwordx4 v[200:203], v113, s[4:7], s63 offen
    buffer_load_dwordx4 v[204:207], v113, s[4:7], s63 offen offset:1024
    s_add_u32 s63, s26, 0x15000
    buffer_load_dwordx4 v[208:211], v113, s[4:7], s63 offen
    buffer_load_dwordx4 v[212:215], v113, s[4:7], s63 offen offset:1024
    s_add_u32 s63, s26, 0x15800
    buffer_load_dwordx4 v[216:219], v113, s[4:7], s63 offen
    buffer_load_dwordx4 v[220:223], v113, s[4:7], s63 offen offset:1024
    s_add_u32 s63, s26, 0x16000
    buffer_load_dwordx4 v[224:227], v113, s[4:7], s63 offen
    buffer_load_dwordx4 v[228:231], v113, s[4:7], s63 offen offset:1024
    s_add_u32 s63, s26, 0x16800
    buffer_load_dwordx4 v[232:235], v113, s[4:7], s63 offen
    buffer_load_dwordx4 v[236:239], v113, s[4:7], s63 offen offset:1024
    s_add_u32 s63, s26, 0x17000
    buffer_load_dwordx4 v[240:243], v113, s[4:7], s63 offen
    buffer_load_dwordx4 v[244:247], v113, s[4:7], s63 offen offset:1024
    s_add_u32 s63, s26, 0x17800
    buffer_load_dwordx4 v[248:251], v113, s[4:7], s63 offen
    buffer_load_dwordx4 v[252:255], v113, s[4:7], s63 offen offset:1024
    s_waitcnt vmcnt(42)
    v_min_u32 v88, v88, v89
    v_cmp_eq_u32 vcc, 0, v88
    s_cbranch_vccz L_Aiok_125
    v_and_b32 v91, 31, v84
    v_lshlrev_b32 v91, 2, v91
L_Ai_126:
    s_sub_u32 s23, s23, 1
    s_cbranch_scc1 M_exit
    s_mov_b32 s63, 0x3fcc000
    buffer_load_dword v88, v91, s[4:7], s63 offen sc1
    v_mov_b32 v89, 1
    s_waitcnt vmcnt(0)
    v_min_u32 v88, v88, v89
    v_cmp_eq_u32 vcc, 0, v88
    s_cbranch_vccnz L_Ai_126
L_Aiok_125:
    v_and_b32 v0, 15, v84
    v_lshrrev_b32 v1, 4, v84
    v_and_b32 v2, 7, v84
    v_bfe_u32 v3, v84, 3, 1
    v_mov_b32 v4, 0x4444
    v_mov_b32 v5, 0xeeee
    v_cmp_eq_u32 vcc, 1, v3
    s_nop 1
    v_cndmask_b32 v112, v4, v5, vcc
    v_and_b32 v4, 1, v1
    v_lshlrev_b32 v4, 2, v4
    v_sub_u32 v4, v2, v4
    v_mov_b32 v6, 0
    v_cmp_eq_u32 vcc, 0, v4
    v_mov_b32 v5, 0x3f80
    s_nop 0
    v_cndmask_b32 v6, v6, v5, vcc
    v_cmp_eq_u32 vcc, 1, v4
    v_mov_b32 v5, 0x3f800000
    s_nop 0
    v_cndmask_b32 v6, v6, v5, vcc
    v_cmp_eq_u32 vcc, 0, v3
    s_nop 1
    v_cndmask_b32 v108, 0, v6, vcc
    v_cmp_eq_u32 vcc, 1, v3
    s_nop 1
    v_cndmask_b32 v110, 0, v6, vcc
    v_mov_b32 v6, 0
    v_cmp_eq_u32 vcc, 2, v4
    v_mov_b32 v5, 0x3f80
    s_nop 0
    v_cndmask_b32 v6, v6, v5, vcc
    v_cmp_eq_u32 vcc, 3, v4
    v_mov_b32 v5, 0x3f800000
    s_nop 0
    v_cndmask_b32 v6, v6, v5, vcc
    v_cmp_eq_u32 vcc, 0, v3
    s_nop 1
    v_cndmask_b32 v109, 0, v6, vcc
    v_cmp_eq_u32 vcc, 1, v3
    s_nop 1
    v_cndmask_b32 v111, 0, v6, vcc
    v_lshlrev_b32 v4, 4, v2
    v_lshl_add_u32 v114, v1, 8, v4
    v_lshrrev_b32 v5, 1, v1
    v_lshl_add_u32 v4, v5, 8, v4
    v_and_b32 v6, 1, v1
    v_cmp_eq_u32 vcc, 1, v6
    v_mov_b32 v7, 5248
    v_mov_b32 v8, 6272
    v_cndmask_b32 v7, v7, v8, vcc
    v_add_u32 v115, v4, v7
    v_lshl_add_u32 v4, v6, 2, v5
    v_mul_u32_u24 v4, 208, v4
    v_lshl_add_u32 v4, v0, 2, v4
    v_add_u32 v116, 45952, v4
    v_lshrrev_b32 v4, 5, v84
    v_and_b32 v9, 31, v84
    v_bfe_u32 v12, v9, 2, 1
    v_and_b32 v13, 2, v9
    v_or_b32 v12, v12, v13
    v_bfe_u32 v13, v9, 3, 1
    v_lshl_or_b32 v12, v13, 2, v12
    v_and_b32 v13, 1, v9
    v_lshl_or_b32 v12, v13, 3, v12
    v_bfe_u32 v14, v9, 1, 1
    v_lshl_or_b32 v13, v13, 1, v14
    v_or_b32 v13, 16, v13
    v_cmp_gt_u32 s[28:29], 20, v9
    v_cmp_gt_u32 vcc, 16, v9
    v_add_u32 v10, 6, v4
    v_mul_u32_u24 v11, 208, v10
    v_cndmask_b32 v9, v13, v12, vcc
    v_cndmask_b32 v12, 0, v9, s[28:29]
    v_lshl_add_u32 v11, v12, 3, v11
    v_add_u32 v118, 40960, v11
    v_mov_b32 v12, 47616
    v_cndmask_b32 v117, v12, v118, s[28:29]
    s_and_b32 s27, s25, 1
    s_bfe_u32 s30, s25, 0x10001
    s_lshr_b32 s31, s25, 2
    v_bfe_u32 v12, v9, 2, 1
    v_lshlrev_b32 v12, 8, v12
    v_and_b32 v13, 1, v9
    v_lshl_add_u32 v12, v13, 7, v12
    v_bfe_u32 v14, v9, 1, 1
    v_lshl_add_u32 v12, v14, 3, v12
    v_bfe_u32 v15, v9, 3, 1
    v_lshl_add_u32 v12, v15, 2, v12
    s_lshl_b32 s32, s30, 10
    s_lshl_b32 s33, s27, 9
    s_add_u32 s32, s32, s33
    v_add_u32 v12, s32, v12
    v_lshlrev_b32 v14, 3, v14
    v_lshl_add_u32 v14, v13, 7, v14
    s_lshl_b32 s32, s27, 2
    s_lshl_b32 s33, s30, 8
    s_add_u32 s32, s32, s33
    s_add_u32 s32, s32, 2048
    v_add_u32 v14, s32, v14
    v_cmp_gt_u32 vcc, 16, v9
    s_nop 1
    v_cndmask_b32 v12, v14, v12, vcc
    v_lshl_add_u32 v12, v10, 4, v12
    s_mul_i32 s32, s31, 2560
    v_add_u32 v12, s32, v12
    v_mov_b32 v13, 0x40000000
    v_cndmask_b32 v119, v13, v12, s[28:29]
    s_mov_b64 s[56:57], s[28:29]
    s_mov_b32 s33, 0x42800000
    s_mov_b32 s24, 0
    s_mov_b32 s26, 0xfc0000
    s_mov_b32 s27, 0x10a0000
    s_mov_b32 s28, 0x3dce000
    s_mov_b32 m0, 32768
    s_add_u32 s29, s28, 4096
    buffer_load_dwordx4 v113, s[4:7], s28 offen offset:0 lds
    buffer_load_dwordx4 v113, s[4:7], s28 offen offset:1024 lds
    buffer_load_dwordx4 v113, s[4:7], s28 offen offset:2048 lds
    buffer_load_dwordx4 v113, s[4:7], s28 offen offset:3072 lds
    s_mov_b32 m0, 36864
    s_nop 0
    buffer_load_dwordx4 v113, s[4:7], s29 offen offset:2048 lds
    buffer_load_dwordx4 v113, s[4:7], s29 offen offset:3072 lds
    buffer_load_dwordx4 v113, s[4:7], s29 offen offset:0 lds
    buffer_load_dwordx4 v113, s[4:7], s29 offen offset:1024 lds
    s_add_u32 s28, s28, 32768
A_top3:
    s_waitcnt vmcnt(0)
    ds_read_b128 v[60:63], v113 offset:32768
    ds_read_b128 v[64:67], v113 offset:33792
    ds_read_b128 v[68:71], v113 offset:34816
    ds_read_b128 v[72:75], v113 offset:35840
    v_mov_b64 v[32:33], 0
    v_mov_b64 v[34:35], 0
    v_mov_b64 v[36:37], 0
    v_mov_b64 v[38:39], 0
    v_mov_b64 v[40:41], 0
    v_mov_b64 v[42:43], 0
    v_mov_b64 v[44:45], 0
    v_mov_b64 v[46:47], 0
    v_mov_b64 v[48:49], 0
    v_mov_b64 v[50:51], 0
    v_mov_b64 v[52:53], 0
    v_mov_b64 v[54:55], 0
    v_mov_b64 v[56:57], 0
    v_mov_b64 v[58:59], 0
    s_add_u32 s30, s26, 6144
    s_add_u32 s31, s26, 0
    s_waitcnt lgkmcnt(0)
    buffer_load_dwordx4 v[0:3], v113, s[4:7], s30 offen sc1
    buffer_load_dwordx4 v[4:7], v113, s[4:7], s31 offen sc1
L_Apoll_127:
    s_sub_u32 s23, s23, 1
    s_cbranch_scc1 M_exit
    buffer_load_dwordx4 v[0:3], v113, s[4:7], s30 offen sc1
    buffer_load_dwordx4 v[4:7], v113, s[4:7], s31 offen sc1
    s_waitcnt vmcnt(2)
    v_max3_u32 v84, v0, v1, v2
    v_max3_u32 v84, v84, v3, v4
    v_max3_u32 v84, v84, v5, v6
    v_max_u32 v84, v84, v7
    v_cmp_eq_u32 vcc, -1, v84
    s_cbranch_vccnz L_Apoll_127
    ds_write_b128 v113, v[0:3] offset:6144
    v_smfmac_f32_16x16x64_bf16 v[32:35], v[0:3], a[0:7], v112
    v_smfmac_f32_16x16x64_bf16 v[36:39], v[0:3], a[56:63], v112
    v_smfmac_f32_16x16x64_bf16 v[40:43], v[0:3], a[112:119], v112
    v_smfmac_f32_16x16x64_bf16 v[44:47], v[0:3], a[168:175], v112
    v_smfmac_f32_16x16x64_bf16 v[48:51], v[0:3], a[224:231], v112
    v_smfmac_f32_16x16x64_bf16 v[52:55], v[0:3], v[144:151], v112
    s_waitcnt lgkmcnt(0)
    s_barrier
    ds_read_b128 v[8:11], v113 offset:1024
    ds_read_b128 v[16:19], v113 offset:2048
    v_smfmac_f32_16x16x64_bf16 v[56:59], v[0:3], v[200:207], v112
    ds_read_b128 v[20:23], v113 offset:3072
    v_smfmac_f32_16x16x64_bf16 v[32:35], v[4:7], a[8:15], v112
    ds_read_b128 v[24:27], v113 offset:4096
    v_smfmac_f32_16x16x64_bf16 v[36:39], v[4:7], a[64:71], v112
    ds_read_b128 v[28:31], v113 offset:5120
    v_smfmac_f32_16x16x64_bf16 v[40:43], v[4:7], a[120:127], v112
    ds_read_b128 v[76:79], v114 offset:3072
    v_smfmac_f32_16x16x64_bf16 v[44:47], v[4:7], a[176:183], v112
    ds_read_b128 v[80:83], v114 offset:3200
    v_smfmac_f32_16x16x64_bf16 v[48:51], v[4:7], a[232:239], v112
    v_smfmac_f32_16x16x64_bf16 v[52:55], v[4:7], v[152:159], v112
    v_smfmac_f32_16x16x64_bf16 v[56:59], v[4:7], v[208:215], v112
    s_waitcnt lgkmcnt(6)
    v_smfmac_f32_16x16x64_bf16 v[32:35], v[8:11], a[16:23], v112
    s_waitcnt vmcnt(0)
    ds_read_b128 v[0:3], v113 offset:38912
    v_smfmac_f32_16x16x64_bf16 v[36:39], v[8:11], a[72:79], v112
    ds_read_b128 v[4:7], v113 offset:39936
    v_smfmac_f32_16x16x64_bf16 v[40:43], v[8:11], a[128:135], v112
    v_smfmac_f32_16x16x64_bf16 v[44:47], v[8:11], a[184:191], v112
    s_mov_b32 m0, 32768
    s_add_u32 s29, s28, 4096
    buffer_load_dwordx4 v113, s[4:7], s28 offen offset:0 lds
    v_smfmac_f32_16x16x64_bf16 v[48:51], v[8:11], a[240:247], v112
    v_smfmac_f32_16x16x64_bf16 v[52:55], v[8:11], v[160:167], v112
    buffer_load_dwordx4 v113, s[4:7], s28 offen offset:1024 lds
    v_smfmac_f32_16x16x64_bf16 v[56:59], v[8:11], v[216:223], v112
    s_waitcnt lgkmcnt(4)
    v_smfmac_f32_16x16x64_bf16 v[32:35], v[16:19], a[24:31], v112
    ds_read_b128 v[8:11], v113 offset:36864
    v_smfmac_f32_16x16x64_bf16 v[32:35], v[20:23], a[32:39], v112
    ds_read_b128 v[12:15], v113 offset:37888
    v_smfmac_f32_16x16x64_bf16 v[32:35], v[24:27], a[40:47], v112
    buffer_load_dwordx4 v113, s[4:7], s28 offen offset:2048 lds
    v_smfmac_f32_16x16x64_bf16 v[32:35], v[28:31], a[48:55], v112
    v_smfmac_f32_16x16x64_bf16 v[36:39], v[16:19], a[80:87], v112
    buffer_load_dwordx4 v113, s[4:7], s28 offen offset:3072 lds
    v_smfmac_f32_16x16x64_bf16 v[36:39], v[20:23], a[88:95], v112
    v_cvt_pk_bf16_f32 v84, v32, v33
    v_smfmac_f32_16x16x64_bf16 v[36:39], v[24:27], a[96:103], v112
    v_cvt_pk_bf16_f32 v85, v34, v35
    v_smfmac_f32_16x16x64_bf16 v[36:39], v[28:31], a[104:111], v112
    v_mov_b64 v[32:33], 0
    v_smfmac_f32_16x16x64_bf16 v[40:43], v[16:19], a[136:143], v112
    v_mov_b64 v[34:35], 0
    v_smfmac_f32_16x16x64_bf16 v[40:43], v[20:23], a[144:151], v112
    v_cvt_pk_bf16_f32 v86, v36, v37
    v_smfmac_f32_16x16x64_bf16 v[40:43], v[24:27], a[152:159], v112
    v_cvt_pk_bf16_f32 v87, v38, v39
    v_smfmac_f32_16x16x64_bf16 v[40:43], v[28:31], a[160:167], v112
    v_mov_b64 v[36:37], 0
    v_mfma_f32_16x16x32_bf16 v[92:95], v[84:87], v[108:111], 0
    s_waitcnt lgkmcnt(0)
    s_mov_b32 m0, 36864
    s_nop 0
    buffer_load_dwordx4 v113, s[4:7], s29 offen offset:2048 lds
    v_smfmac_f32_16x16x64_bf16 v[44:47], v[16:19], a[192:199], v112
    v_mov_b64 v[38:39], 0
    v_smfmac_f32_16x16x64_bf16 v[44:47], v[20:23], a[200:207], v112
    v_cvt_pk_bf16_f32 v88, v40, v41
    v_smfmac_f32_16x16x64_bf16 v[44:47], v[24:27], a[208:215], v112
    v_cvt_pk_bf16_f32 v89, v42, v43
    v_smfmac_f32_16x16x64_bf16 v[44:47], v[28:31], a[216:223], v112
    v_cvt_pk_bf16_f32 v100, v92, v93
    v_smfmac_f32_16x16x64_bf16 v[48:51], v[16:19], a[248:255], v112
    v_cvt_pk_bf16_f32 v101, v94, v95
    v_smfmac_f32_16x16x64_bf16 v[48:51], v[20:23], v[120:127], v112
    v_cvt_pk_bf16_f32 v90, v44, v45
    v_smfmac_f32_16x16x64_bf16 v[48:51], v[24:27], v[128:135], v112
    v_cvt_pk_bf16_f32 v91, v46, v47
    v_smfmac_f32_16x16x64_bf16 v[48:51], v[28:31], v[136:143], v112
    v_mov_b64 v[40:41], 0
    v_mfma_f32_16x16x32_bf16 v[96:99], v[88:91], v[108:111], 0
    buffer_load_dwordx4 v113, s[4:7], s29 offen offset:3072 lds
    v_smfmac_f32_16x16x64_bf16 v[52:55], v[16:19], v[168:175], v112
    v_mov_b64 v[42:43], 0
    v_smfmac_f32_16x16x64_bf16 v[52:55], v[20:23], v[176:183], v112
    v_cvt_pk_bf16_f32 v84, v48, v49
    v_smfmac_f32_16x16x64_bf16 v[52:55], v[24:27], v[184:191], v112
    v_cvt_pk_bf16_f32 v85, v50, v51
    v_smfmac_f32_16x16x64_bf16 v[52:55], v[28:31], v[192:199], v112
    v_cvt_pk_bf16_f32 v102, v96, v97
    v_smfmac_f32_16x16x64_bf16 v[56:59], v[16:19], v[224:231], v112
    v_cvt_pk_bf16_f32 v103, v98, v99
    v_smfmac_f32_16x16x64_bf16 v[56:59], v[20:23], v[232:239], v112
    v_cvt_pk_bf16_f32 v86, v52, v53
    v_smfmac_f32_16x16x64_bf16 v[56:59], v[24:27], v[240:247], v112
    v_cvt_pk_bf16_f32 v87, v54, v55
    v_smfmac_f32_16x16x64_bf16 v[56:59], v[28:31], v[248:255], v112
    ds_read_b128 v[44:47], v115 offset:0
    v_mfma_f32_16x16x32_bf16 v[92:95], v[84:87], v[108:111], 0
    ds_read_b128 v[48:51], v115 offset:512
    v_smfmac_f32_16x16x64_bf16 v[32:35], v[100:103], v[60:67], v112
    v_cvt_pk_bf16_f32 v88, v56, v57
    v_cvt_pk_bf16_f32 v89, v58, v59
    s_nop 1
    v_mfma_f32_16x16x16_bf16 v[96:99], v[88:89], v[110:111], 0
    v_cvt_pk_bf16_f32 v104, v92, v93
    v_smfmac_f32_16x16x64_bf16 v[36:39], v[100:103], v[68:75], v112
    v_cvt_pk_bf16_f32 v105, v94, v95
    v_smfmac_f32_16x16x64_bf16 v[40:43], v[100:103], v[76:83], v112
    v_cvt_pk_bf16_f32 v106, v96, v97
    v_cvt_pk_bf16_f32 v107, v98, v99
    s_waitcnt lgkmcnt(0)
    s_nop 0
    v_smfmac_f32_16x16x64_bf16 v[32:35], v[104:107], v[8:15], v112
    v_smfmac_f32_16x16x64_bf16 v[36:39], v[104:107], v[0:7], v112
    v_smfmac_f32_16x16x64_bf16 v[40:43], v[104:107], v[44:51], v112
    v_permlane32_swap_b32 v32, v33
    v_permlane32_swap_b32 v34, v35
    v_add_f32 v32, v32, v33
    v_add_f32 v34, v34, v35
    ds_write2_b32 v116, v32, v34 offset0:0 offset1:104
    v_permlane32_swap_b32 v36, v37
    v_permlane32_swap_b32 v38, v39
    v_add_f32 v36, v36, v37
    v_add_f32 v38, v38, v39
    ds_write2_b32 v116, v36, v38 offset0:16 offset1:120
    s_nop 0
    v_permlane32_swap_b32 v40, v41
    v_permlane32_swap_b32 v42, v43
    v_add_f32 v40, v40, v41
    v_add_f32 v42, v42, v43
    ds_write2_b32 v116, v40, v42 offset0:32 offset1:136
    s_waitcnt lgkmcnt(0)
    s_barrier
    ds_read_b64 v[44:45], v117
    ds_read_b64 v[46:47], v118 offset:1664
    ds_read_b64 v[48:49], v118 offset:3328
    ds_read_b64 v[50:51], v118 offset:4992
    buffer_load_dwordx4 v113, s[4:7], s29 offen offset:0 lds
    buffer_load_dwordx4 v113, s[4:7], s29 offen offset:1024 lds
    s_waitcnt lgkmcnt(2)
    v_add_f32 v44, v44, v46
    v_add_f32 v45, v45, v47
    s_waitcnt lgkmcnt(0)
    v_add_f32 v48, v48, v50
    v_add_f32 v49, v49, v51
    v_add_f32 v48, v44, v48
    v_add_f32 v49, v45, v49
    v_max_f32 v46, |v48|, |v49|
    v_exp_f32 v44, v48
    v_cmp_lt_f32 vcc, s33, v46
    v_exp_f32 v45, v49
    s_and_b64 vcc, vcc, s[56:57]
    s_cbranch_scc1 A_max3
A_sum3:
    v_add_f32 v46, v44, v45
    s_nop 1
    v_add_f32_dpp v46, v46, v46 row_ror:8 row_mask:0xf bank_mask:0xf
    s_nop 1
    v_add_f32_dpp v46, v46, v46 row_ror:4 row_mask:0xf bank_mask:0xf
    s_nop 1
    v_add_f32_dpp v46, v46, v46 row_ror:2 row_mask:0xf bank_mask:0xf
    s_nop 1
    v_add_f32_dpp v46, v46, v46 row_ror:1 row_mask:0xf bank_mask:0xf
    v_mov_b32 v47, v46
    s_nop 1
    v_permlane16_swap_b32 v47, v46
    v_add_f32 v46, v46, v47
    v_rcp_f32 v46, v46
    s_nop 0
    v_mul_f32 v44, v44, v46
    v_mul_f32 v45, v45, v46
    v_cvt_pk_bf16_f32 v44, v44, v45
    v_min_u32 v44, -2, v44
    buffer_store_dword v44, v119, s[4:7], s27 offen
    s_add_u32 s24, s24, 1
    s_add_u32 s26, s26, 7168
    s_add_u32 s27, s27, 10240
    s_add_u32 s28, s28, 32768
    s_cmp_lt_u32 s24, 63
    s_cbranch_scc1 A_top3
    s_endpgm
A_max3:
    v_max_f32 v46, v48, v49
    s_nop 1
    v_max_f32_dpp v46, v46, v46 row_ror:8 row_mask:0xf bank_mask:0xf
    s_nop 1
    v_max_f32_dpp v46, v46, v46 row_ror:4 row_mask:0xf bank_mask:0xf
    s_nop 1
    v_max_f32_dpp v46, v46, v46 row_ror:2 row_mask:0xf bank_mask:0xf
    s_nop 1
    v_max_f32_dpp v46, v46, v46 row_ror:1 row_mask:0xf bank_mask:0xf
    v_mov_b32 v47, v46
    s_nop 1
    v_permlane16_swap_b32 v47, v46
    v_max_f32 v46, v46, v47
    v_sub_f32 v44, v48, v46
    v_sub_f32 v45, v49, v46
    v_exp_f32 v44, v44
    v_exp_f32 v45, v45
    s_nop 0
    s_branch A_sum3
M_exit:
M_end:
    s_endpgm
B_role:
    v_mov_b32 v110, v1
    v_lshlrev_b32 v101, 4, v1
    s_mul_i32 s26, s20, 0x188000
    s_mul_i32 s27, s25, 28672
    s_add_u32 s26, s26, s27
    s_add_u32 s26, s26, 0x620000
    v_and_b32 v85, 7, v1
    v_min_u32 v85, 6, v85
    v_bfe_u32 v86, v1, 3, 1
    v_mul_u32_u24 v86, 32, v86
    v_add_u32 v85, v85, v86
    v_lshrrev_b32 v86, 4, v1
    v_mul_u32_u24 v86, 512, v86
    v_lshl_add_u32 v85, v85, 2, v86
    s_mul_i32 s27, s20, 2048
    s_and_b32 s28, s25, 1
    s_mul_i32 s28, s28, 256
    s_add_u32 s27, s27, s28
    s_add_u32 s27, s27, 0x3fc8000
    s_lshr_b32 s28, s25, 1
    s_lshl_b32 s29, s20, 1
    s_sub_u32 s28, s28, s29
    s_cselect_b32 s29, 8, 1
    s_add_u32 s28, s28, s29
    v_mov_b32 v86, 0
    v_cmp_gt_u32 vcc, s28, v86
    s_cbranch_vccz L_Bwok_128
L_Bw_129:
    s_sub_u32 s23, s23, 1
    s_cbranch_scc1 M_exit
    buffer_load_dword v86, v85, s[4:7], s27 offen sc1
    s_waitcnt vmcnt(0)
    v_cmp_gt_u32 vcc, s28, v86
    s_cbranch_vccnz L_Bw_129
L_Bwok_128:
    v_and_b32 v91, 31, v1
    v_lshlrev_b32 v91, 2, v91
    s_mul_i32 s34, s20, 14336
    s_add_u32 s34, s34, 16384
    s_add_u32 m0, s34, 0
    s_add_u32 s63, s26, 0x129800
    buffer_load_dwordx4 v101, s[4:7], s63 offen lds
    s_add_u32 m0, s34, 1024
    s_add_u32 s63, s26, 0x129c00
    buffer_load_dwordx4 v101, s[4:7], s63 offen lds
    s_add_u32 m0, s34, 2048
    s_add_u32 s63, s26, 0x12a000
    buffer_load_dwordx4 v101, s[4:7], s63 offen lds
    s_add_u32 m0, s34, 3072
    s_add_u32 s63, s26, 0x12a400
    buffer_load_dwordx4 v101, s[4:7], s63 offen lds
    s_add_u32 m0, s34, 4096
    s_add_u32 s63, s26, 0x12a800
    buffer_load_dwordx4 v101, s[4:7], s63 offen lds
    s_add_u32 m0, s34, 5120
    s_add_u32 s63, s26, 0x12ac00
    buffer_load_dwordx4 v101, s[4:7], s63 offen lds
    s_add_u32 m0, s34, 6144
    s_add_u32 s63, s26, 0x12b000
    buffer_load_dwordx4 v101, s[4:7], s63 offen lds
    s_add_u32 m0, s34, 7168
    s_add_u32 s63, s26, 0x12b400
    buffer_load_dwordx4 v101, s[4:7], s63 offen lds
    s_add_u32 m0, s34, 8192
    s_add_u32 s63, s26, 0x12b800
    buffer_load_dwordx4 v101, s[4:7], s63 offen lds
    s_add_u32 m0, s34, 9216
    s_add_u32 s63, s26, 0x12bc00
    buffer_load_dwordx4 v101, s[4:7], s63 offen lds
    s_add_u32 m0, s34, 10240
    s_add_u32 s63, s26, 0x12c000
    buffer_load_dwordx4 v101, s[4:7], s63 offen lds
    s_add_u32 m0, s34, 11264
    s_add_u32 s63, s26, 0x12c400
    buffer_load_dwordx4 v101, s[4:7], s63 offen lds
    s_add_u32 m0, s34, 12288
    s_add_u32 s63, s26, 0x12c800
    buffer_load_dwordx4 v101, s[4:7], s63 offen lds
    s_add_u32 m0, s34, 13312
    s_add_u32 s63, s26, 0x12cc00
    buffer_load_dwordx4 v101, s[4:7], s63 offen lds
    s_add_u32 s63, s26, 0x0
    buffer_load_dwordx4 a[0:3], v101, s[4:7], s63 offen
    buffer_load_dwordx4 a[4:7], v101, s[4:7], s63 offen offset:1024
    s_add_u32 s63, s26, 0x800
    buffer_load_dwordx4 a[8:11], v101, s[4:7], s63 offen
    buffer_load_dwordx4 a[12:15], v101, s[4:7], s63 offen offset:1024
    s_add_u32 s63, s26, 0x1000
    buffer_load_dwordx4 a[16:19], v101, s[4:7], s63 offen
    buffer_load_dwordx4 a[20:23], v101, s[4:7], s63 offen offset:1024
    s_add_u32 s63, s26, 0x1800
    buffer_load_dwordx4 a[24:27], v101, s[4:7], s63 offen
    buffer_load_dwordx4 a[28:31], v101, s[4:7], s63 offen offset:1024
    s_add_u32 s63, s26, 0x2000
    buffer_load_dwordx4 a[32:35], v101, s[4:7], s63 offen
    buffer_load_dwordx4 a[36:39], v101, s[4:7], s63 offen offset:1024
    s_add_u32 s63, s26, 0x2800
    buffer_load_dwordx4 a[40:43], v101, s[4:7], s63 offen
    buffer_load_dwordx4 a[44:47], v101, s[4:7], s63 offen offset:1024
    s_add_u32 s63, s26, 0x3000
    buffer_load_dwordx4 a[48:51], v101, s[4:7], s63 offen
    buffer_load_dwordx4 a[52:55], v101, s[4:7], s63 offen offset:1024
    s_add_u32 s63, s26, 0x62000
    buffer_load_dwordx4 a[56:59], v101, s[4:7], s63 offen
    buffer_load_dwordx4 a[60:63], v101, s[4:7], s63 offen offset:1024
    s_add_u32 s63, s26, 0x62800
    buffer_load_dwordx4 a[64:67], v101, s[4:7], s63 offen
    buffer_load_dwordx4 a[68:71], v101, s[4:7], s63 offen offset:1024
    s_add_u32 s63, s26, 0x63000
    buffer_load_dwordx4 a[72:75], v101, s[4:7], s63 offen
    buffer_load_dwordx4 a[76:79], v101, s[4:7], s63 offen offset:1024
    s_add_u32 s63, s26, 0x63800
    buffer_load_dwordx4 a[80:83], v101, s[4:7], s63 offen
    buffer_load_dwordx4 a[84:87], v101, s[4:7], s63 offen offset:1024
    s_add_u32 s63, s26, 0x64000
    buffer_load_dwordx4 a[88:91], v101, s[4:7], s63 offen
    buffer_load_dwordx4 a[92:95], v101, s[4:7], s63 offen offset:1024
    s_add_u32 s63, s26, 0x64800
    buffer_load_dwordx4 a[96:99], v101, s[4:7], s63 offen
    buffer_load_dwordx4 a[100:103], v101, s[4:7], s63 offen offset:1024
    s_add_u32 s63, s26, 0x65000
    buffer_load_dwordx4 a[104:107], v101, s[4:7], s63 offen
    buffer_load_dwordx4 a[108:111], v101, s[4:7], s63 offen offset:1024
    s_add_u32 s63, s26, 0x3800
    buffer_load_dwordx4 a[112:115], v101, s[4:7], s63 offen
    buffer_load_dwordx4 a[116:119], v101, s[4:7], s63 offen offset:1024
    s_add_u32 s63, s26, 0x4000
    buffer_load_dwordx4 a[120:123], v101, s[4:7], s63 offen
    buffer_load_dwordx4 a[124:127], v101, s[4:7], s63 offen offset:1024
    s_add_u32 s63, s26, 0x4800
    buffer_load_dwordx4 a[128:131], v101, s[4:7], s63 offen
    buffer_load_dwordx4 a[132:135], v101, s[4:7], s63 offen offset:1024
    s_add_u32 s63, s26, 0x5000
    buffer_load_dwordx4 a[136:139], v101, s[4:7], s63 offen
    buffer_load_dwordx4 a[140:143], v101, s[4:7], s63 offen offset:1024
    s_add_u32 s63, s26, 0x5800
    buffer_load_dwordx4 a[144:147], v101, s[4:7], s63 offen
    buffer_load_dwordx4 a[148:151], v101, s[4:7], s63 offen offset:1024
    s_add_u32 s63, s26, 0x6000
    buffer_load_dwordx4 a[152:155], v101, s[4:7], s63 offen
    buffer_load_dwordx4 a[156:159], v101, s[4:7], s63 offen offset:1024
    s_mov_b32 s63, 0x3fcc000
    buffer_load_dword v88, v91, s[4:7], s63 offen sc1
    v_mov_b32 v89, 1
    s_add_u32 s63, s26, 0x6800
    buffer_load_dwordx4 a[160:163], v101, s[4:7], s63 offen
    buffer_load_dwordx4 a[164:167], v101, s[4:7], s63 offen offset:1024
    s_add_u32 s63, s26, 0x65800
    buffer_load_dwordx4 a[168:171], v101, s[4:7], s63 offen
    buffer_load_dwordx4 a[172:175], v101, s[4:7], s63 offen offset:1024
    s_add_u32 s63, s26, 0x66000
    buffer_load_dwordx4 a[176:179], v101, s[4:7], s63 offen
    buffer_load_dwordx4 a[180:183], v101, s[4:7], s63 offen offset:1024
    s_add_u32 s63, s26, 0x66800
    buffer_load_dwordx4 a[184:187], v101, s[4:7], s63 offen
    buffer_load_dwordx4 a[188:191], v101, s[4:7], s63 offen offset:1024
    s_add_u32 s63, s26, 0x67000
    buffer_load_dwordx4 a[192:195], v101, s[4:7], s63 offen
    buffer_load_dwordx4 a[196:199], v101, s[4:7], s63 offen offset:1024
    s_add_u32 s63, s26, 0x67800
    buffer_load_dwordx4 a[200:203], v101, s[4:7], s63 offen
    buffer_load_dwordx4 a[204:207], v101, s[4:7], s63 offen offset:1024
    s_add_u32 s63, s26, 0x68000
    buffer_load_dwordx4 a[208:211], v101, s[4:7], s63 offen
    buffer_load_dwordx4 a[212:215], v101, s[4:7], s63 offen offset:1024
    s_add_u32 s63, s26, 0x68800
    buffer_load_dwordx4 a[216:219], v101, s[4:7], s63 offen
    buffer_load_dwordx4 a[220:223], v101, s[4:7], s63 offen offset:1024
    s_waitcnt vmcnt(48)
    s_add_u32 s63, s26, 0xc4000
    buffer_load_dwordx4 a[224:227], v101, s[4:7], s63 offen
    buffer_load_dwordx4 a[228:231], v101, s[4:7], s63 offen offset:1024
    s_add_u32 s63, s26, 0xc4800
    buffer_load_dwordx4 a[232:235], v101, s[4:7], s63 offen
    buffer_load_dwordx4 a[236:239], v101, s[4:7], s63 offen offset:1024
    s_add_u32 s63, s26, 0xc5000
    buffer_load_dwordx4 a[240:243], v101, s[4:7], s63 offen
    buffer_load_dwordx4 a[244:247], v101, s[4:7], s63 offen offset:1024
    s_add_u32 s63, s26, 0xc5800
    buffer_load_dwordx4 a[248:251], v101, s[4:7], s63 offen
    buffer_load_dwordx4 a[252:255], v101, s[4:7], s63 offen offset:1024
    s_waitcnt vmcnt(48)
    s_add_u32 s63, s26, 0xc6000
    buffer_load_dwordx4 v[120:123], v101, s[4:7], s63 offen
    buffer_load_dwordx4 v[124:127], v101, s[4:7], s63 offen offset:1024
    s_add_u32 s63, s26, 0xc6800
    buffer_load_dwordx4 v[128:131], v101, s[4:7], s63 offen
    buffer_load_dwordx4 v[132:135], v101, s[4:7], s63 offen offset:1024
    s_add_u32 s63, s26, 0xc7000
    buffer_load_dwordx4 v[136:139], v101, s[4:7], s63 offen
    buffer_load_dwordx4 v[140:143], v101, s[4:7], s63 offen offset:1024
    s_add_u32 s63, s26, 0x126000
    buffer_load_dwordx4 v[144:147], v101, s[4:7], s63 offen
    buffer_load_dwordx4 v[148:151], v101, s[4:7], s63 offen offset:1024
    s_waitcnt vmcnt(48)
    s_add_u32 s63, s26, 0x126800
    buffer_load_dwordx4 v[152:155], v101, s[4:7], s63 offen
    buffer_load_dwordx4 v[156:159], v101, s[4:7], s63 offen offset:1024
    s_add_u32 s63, s26, 0x127000
    buffer_load_dwordx4 v[160:163], v101, s[4:7], s63 offen
    buffer_load_dwordx4 v[164:167], v101, s[4:7], s63 offen offset:1024
    s_add_u32 s63, s26, 0x127800
    buffer_load_dwordx4 v[168:171], v101, s[4:7], s63 offen
    buffer_load_dwordx4 v[172:175], v101, s[4:7], s63 offen offset:1024
    s_add_u32 s63, s26, 0x128000
    buffer_load_dwordx4 v[176:179], v101, s[4:7], s63 offen
    buffer_load_dwordx4 v[180:183], v101, s[4:7], s63 offen offset:1024
    s_waitcnt vmcnt(48)
    s_add_u32 s63, s26, 0x128800
    buffer_load_dwordx4 v[184:187], v101, s[4:7], s63 offen
    buffer_load_dwordx4 v[188:191], v101, s[4:7], s63 offen offset:1024
    s_add_u32 s63, s26, 0x129000
    buffer_load_dwordx4 v[192:195], v101, s[4:7], s63 offen
    buffer_load_dwordx4 v[196:199], v101, s[4:7], s63 offen offset:1024
    s_add_u32 s63, s26, 0xc7800
    buffer_load_dwordx4 v[200:203], v101, s[4:7], s63 offen
    buffer_load_dwordx4 v[204:207], v101, s[4:7], s63 offen offset:1024
    s_add_u32 s63, s26, 0xc8000
    buffer_load_dwordx4 v[208:211], v101, s[4:7], s63 offen
    buffer_load_dwordx4 v[212:215], v101, s[4:7], s63 offen offset:1024
    s_waitcnt vmcnt(48)
    s_add_u32 s63, s26, 0xc8800
    buffer_load_dwordx4 v[216:219], v101, s[4:7], s63 offen
    buffer_load_dwordx4 v[220:223], v101, s[4:7], s63 offen offset:1024
    s_add_u32 s63, s26, 0xc9000
    buffer_load_dwordx4 v[224:227], v101, s[4:7], s63 offen
    buffer_load_dwordx4 v[228:231], v101, s[4:7], s63 offen offset:1024
    s_add_u32 s63, s26, 0xc9800
    buffer_load_dwordx4 v[232:235], v101, s[4:7], s63 offen
    buffer_load_dwordx4 v[236:239], v101, s[4:7], s63 offen offset:1024
    s_add_u32 s63, s26, 0xca000
    buffer_load_dwordx4 v[240:243], v101, s[4:7], s63 offen
    buffer_load_dwordx4 v[244:247], v101, s[4:7], s63 offen offset:1024
    s_waitcnt vmcnt(48)
    s_add_u32 s63, s26, 0xca800
    buffer_load_dwordx4 v[248:251], v101, s[4:7], s63 offen
    buffer_load_dwordx4 v[252:255], v101, s[4:7], s63 offen offset:1024
    v_min_u32 v88, v88, v89
    v_cmp_eq_u32 vcc, 0, v88
    s_cbranch_vccz L_Biok_130
    v_and_b32 v91, 31, v110
    v_lshlrev_b32 v91, 2, v91
L_Bi_131:
    s_sub_u32 s23, s23, 1
    s_cbranch_scc1 M_exit
    s_mov_b32 s63, 0x3fcc000
    buffer_load_dword v88, v91, s[4:7], s63 offen sc1
    v_mov_b32 v89, 1
    s_waitcnt vmcnt(0)
    v_min_u32 v88, v88, v89
    v_cmp_eq_u32 vcc, 0, v88
    s_cbranch_vccnz L_Bi_131
L_Biok_130:
    v_and_b32 v0, 15, v110
    v_lshrrev_b32 v1, 4, v110
    v_and_b32 v2, 7, v110
    v_bfe_u32 v3, v110, 3, 1
    v_mov_b32 v4, 0x4444
    v_mov_b32 v5, 0xeeee
    v_cmp_eq_u32 vcc, 1, v3
    s_nop 1
    v_cndmask_b32 v100, v4, v5, vcc
    v_lshrrev_b32 v4, 1, v1
    v_lshlrev_b32 v4, 8, v4
    v_lshl_add_u32 v4, v0, 4, v4
    v_add_u32 v104, 2048, v4
    s_lshl_b32 s27, s20, 11
    s_add_u32 s28, s27, 1024
    s_min_u32 s28, s28, 6144
    v_add_u32 v102, s27, v101
    v_add_u32 v103, s28, v101
    v_and_b32 v6, 1, v1
    v_lshrrev_b32 v5, 1, v1
    v_lshl_add_u32 v4, v6, 2, v5
    v_mul_u32_u24 v4, 144, v4
    v_lshl_add_u32 v4, v0, 2, v4
    s_mul_i32 s27, s20, 1152
    s_add_u32 s27, s27, 8192
    v_add_u32 v105, s27, v4
    v_bfe_u32 v4, v110, 2, 3
    v_and_b32 v5, 3, v110
    v_mul_u32_u24 v6, 144, v4
    v_lshl_add_u32 v6, v5, 3, v6
    s_lshl_b32 s27, s20, 5
    s_add_u32 s27, s27, 8192
    v_add_u32 v106, s27, v6
    s_lshr_b32 s27, s25, 1
    s_lshl_b32 s27, s27, 10
    s_and_b32 s28, s25, 1
    s_lshl_b32 s28, s28, 7
    s_add_u32 s27, s27, s28
    s_lshl_b32 s28, s20, 8
    s_add_u32 s27, s27, s28
    v_lshlrev_b32 v6, 2, v110
    v_add_u32 v6, s27, v6
    v_mov_b32 v7, 0x40000000
    v_cmp_gt_u32 vcc, 32, v110
    s_nop 1
    v_cndmask_b32 v107, v7, v6, vcc
    s_lshl_b32 s27, s20, 2
    v_lshlrev_b32 v6, 4, v110
    v_add_u32 v108, s27, v6
    s_mov_b32 s33, 0x1010101
    v_add_u32 v110, s34, v101
    s_mov_b32 s24, 0
    s_mov_b32 s26, 0xfc0000
    s_mov_b64 s[60:61], 0
    s_mul_i32 s27, s20, 2560
    s_add_u32 s27, s27, 0x10a0000
    s_mul_i32 s28, s20, 114688
    s_lshl_b32 s29, s25, 11
    s_add_u32 s28, s28, s29
    s_add_u32 s28, s28, 0x1148000
    s_mov_b32 s35, 0x1140000
    buffer_load_dword v111, v108, s[4:7], s35 offen sc1
    s_waitcnt vmcnt(0)
    v_cmp_eq_u32 s[60:61], s33, v111
B_top:
L_Bpoll_132:
    s_sub_u32 s23, s23, 1
    s_cbranch_scc1 M_exit
    buffer_load_dwordx4 v[84:87], v102, s[4:7], s26 offen sc1
    buffer_load_dwordx4 v[88:91], v103, s[4:7], s26 offen sc1
    s_waitcnt vmcnt(0)
    v_max3_u32 v109, v84, v85, v86
    v_max3_u32 v109, v109, v87, v88
    v_max3_u32 v109, v109, v89, v90
    v_max_u32 v109, v109, v91
    v_cmp_eq_u32 vcc, -1, v109
    s_cbranch_vccnz L_Bpoll_132
    ds_write_b128 v102, v[84:87]
    ds_write_b128 v103, v[88:91]
    s_bitcmp1_b64 s[60:61], s24
    s_cbranch_scc1 B_uok
L_Bufl_133:
    s_sub_u32 s23, s23, 1
    s_cbranch_scc1 M_exit
    buffer_load_dword v111, v108, s[4:7], s35 offen sc1
    s_waitcnt vmcnt(0)
    v_cmp_eq_u32 s[60:61], s33, v111
    s_nop 1
    s_bitcmp0_b64 s[60:61], s24
    s_cbranch_scc1 L_Bufl_133
B_uok:
    s_add_u32 s31, s28, 0
    buffer_load_dwordx4 v[28:31], v101, s[4:7], s31 offen offset:0 sc1
    s_add_u32 s31, s28, 0
    buffer_load_dwordx4 v[36:39], v101, s[4:7], s31 offen offset:1024 sc1
    v_mov_b64 v[60:61], 0
    v_mov_b64 v[62:63], 0
    v_mov_b64 v[64:65], 0
    v_mov_b64 v[66:67], 0
    s_waitcnt lgkmcnt(0)
    s_barrier
    ds_read_b128 v[0:3], v101 offset:0
    ds_read_b128 v[4:7], v101 offset:1024
    ds_read_b128 v[8:11], v101 offset:2048
    ds_read_b128 v[12:15], v101 offset:3072
    ds_read_b128 v[16:19], v101 offset:4096
    ds_read_b128 v[20:23], v101 offset:5120
    ds_read_b128 v[24:27], v101 offset:6144
    s_waitcnt lgkmcnt(6)
    v_smfmac_f32_16x16x64_bf16 v[60:63], v[0:3], a[0:7], v100
    v_mov_b64 v[116:117], 0
    v_smfmac_f32_16x16x64_bf16 v[64:67], v[0:3], a[56:63], v100
    v_mov_b64 v[118:119], 0
    s_waitcnt lgkmcnt(5)
    v_smfmac_f32_16x16x64_bf16 v[60:63], v[4:7], a[8:15], v100
    s_add_u32 s31, s28, 28672
    buffer_load_dwordx4 v[32:35], v101, s[4:7], s31 offen offset:0 sc1
    v_smfmac_f32_16x16x64_bf16 v[64:67], v[4:7], a[64:71], v100
    s_add_u32 s31, s28, 28672
    buffer_load_dwordx4 v[40:43], v101, s[4:7], s31 offen offset:1024 sc1
    s_waitcnt lgkmcnt(4)
    v_smfmac_f32_16x16x64_bf16 v[60:63], v[8:11], a[16:23], v100
    s_add_u32 s31, s28, 57344
    buffer_load_dwordx4 v[44:47], v101, s[4:7], s31 offen offset:0 sc1
    v_smfmac_f32_16x16x64_bf16 v[64:67], v[8:11], a[72:79], v100
    s_add_u32 s31, s28, 57344
    buffer_load_dwordx4 v[52:55], v101, s[4:7], s31 offen offset:1024 sc1
    s_waitcnt lgkmcnt(3)
    v_smfmac_f32_16x16x64_bf16 v[60:63], v[12:15], a[24:31], v100
    s_add_u32 s31, s28, 86016
    buffer_load_dwordx4 v[48:51], v101, s[4:7], s31 offen offset:0 sc1
    v_smfmac_f32_16x16x64_bf16 v[64:67], v[12:15], a[80:87], v100
    s_add_u32 s31, s28, 86016
    buffer_load_dwordx4 v[56:59], v101, s[4:7], s31 offen offset:1024 sc1
    s_waitcnt lgkmcnt(2)
    v_smfmac_f32_16x16x64_bf16 v[60:63], v[16:19], a[32:39], v100
    ds_read_b128 v[84:87], v110 offset:0
    v_smfmac_f32_16x16x64_bf16 v[64:67], v[16:19], a[88:95], v100
    ds_read_b128 v[88:91], v110 offset:1024
    s_waitcnt lgkmcnt(3)
    v_smfmac_f32_16x16x64_bf16 v[60:63], v[20:23], a[40:47], v100
    ds_read_b128 v[92:95], v110 offset:2048
    v_smfmac_f32_16x16x64_bf16 v[64:67], v[20:23], a[96:103], v100
    ds_read_b128 v[96:99], v110 offset:3072
    s_waitcnt lgkmcnt(4)
    v_smfmac_f32_16x16x64_bf16 v[60:63], v[24:27], a[48:55], v100
    v_mov_b64 v[112:113], 0
    v_smfmac_f32_16x16x64_bf16 v[64:67], v[24:27], a[104:111], v100
    v_mov_b64 v[114:115], 0
    v_smfmac_f32_16x16x64_bf16 v[116:119], v[0:3], a[112:119], v100
    v_cvt_pk_bf16_f32 v68, v60, v61
    s_waitcnt lgkmcnt(2)
    v_smfmac_f32_16x16x64_bf16 v[112:115], v[0:3], v[84:91], v100
    ds_read_b128 v[84:87], v110 offset:4096
    v_smfmac_f32_16x16x64_bf16 v[116:119], v[4:7], a[120:127], v100
    ds_read_b128 v[88:91], v110 offset:5120
    v_smfmac_f32_16x16x64_bf16 v[116:119], v[8:11], a[128:135], v100
    v_cvt_pk_bf16_f32 v69, v62, v63
    v_smfmac_f32_16x16x64_bf16 v[116:119], v[12:15], a[136:143], v100
    v_mov_b64 v[60:61], 0
    v_smfmac_f32_16x16x64_bf16 v[116:119], v[16:19], a[144:151], v100
    v_mov_b64 v[62:63], 0
    v_smfmac_f32_16x16x64_bf16 v[116:119], v[20:23], a[152:159], v100
    v_cvt_pk_bf16_f32 v70, v64, v65
    s_waitcnt lgkmcnt(2)
    v_smfmac_f32_16x16x64_bf16 v[112:115], v[4:7], v[92:99], v100
    ds_read_b128 v[92:95], v110 offset:6144
    v_smfmac_f32_16x16x64_bf16 v[116:119], v[24:27], a[160:167], v100
    ds_read_b128 v[96:99], v110 offset:7168
    v_smfmac_f32_16x16x64_bf16 v[60:63], v[0:3], a[168:175], v100
    v_cvt_pk_bf16_f32 v71, v66, v67
    v_smfmac_f32_16x16x64_bf16 v[60:63], v[4:7], a[176:183], v100
    v_mov_b64 v[64:65], 0
    v_smfmac_f32_16x16x64_bf16 v[60:63], v[8:11], a[184:191], v100
    v_mov_b64 v[66:67], 0
    v_smfmac_f32_16x16x64_bf16 v[60:63], v[12:15], a[192:199], v100
    v_cvt_pk_bf16_f32 v76, v116, v117
    s_waitcnt lgkmcnt(2)
    v_smfmac_f32_16x16x64_bf16 v[112:115], v[8:11], v[84:91], v100
    ds_read_b128 v[84:87], v110 offset:8192
    v_smfmac_f32_16x16x64_bf16 v[60:63], v[16:19], a[200:207], v100
    ds_read_b128 v[88:91], v110 offset:9216
    v_smfmac_f32_16x16x64_bf16 v[60:63], v[20:23], a[208:215], v100
    v_cvt_pk_bf16_f32 v77, v118, v119
    v_smfmac_f32_16x16x64_bf16 v[60:63], v[24:27], a[216:223], v100
    v_mov_b64 v[116:117], 0
    v_smfmac_f32_16x16x64_bf16 v[64:67], v[0:3], a[224:231], v100
    v_mov_b64 v[118:119], 0
    v_smfmac_f32_16x16x64_bf16 v[64:67], v[4:7], a[232:239], v100
    v_cvt_pk_bf16_f32 v78, v60, v61
    s_waitcnt lgkmcnt(2)
    v_smfmac_f32_16x16x64_bf16 v[112:115], v[12:15], v[92:99], v100
    ds_read_b128 v[92:95], v110 offset:10240
    v_smfmac_f32_16x16x64_bf16 v[64:67], v[8:11], a[240:247], v100
    ds_read_b128 v[96:99], v110 offset:11264
    v_smfmac_f32_16x16x64_bf16 v[64:67], v[12:15], a[248:255], v100
    v_cvt_pk_bf16_f32 v79, v62, v63
    v_smfmac_f32_16x16x64_bf16 v[64:67], v[16:19], v[120:127], v100
    v_mov_b64 v[60:61], 0
    v_smfmac_f32_16x16x64_bf16 v[64:67], v[20:23], v[128:135], v100
    v_mov_b64 v[62:63], 0
    v_smfmac_f32_16x16x64_bf16 v[64:67], v[24:27], v[136:143], v100
    s_add_u32 s32, s24, 1
    s_min_u32 s32, s32, 63
    s_bitcmp1_b64 s[60:61], s32
    s_cbranch_scc1 B_nuf
    buffer_load_dword v111, v108, s[4:7], s35 offen sc1
B_nuf:
    s_waitcnt lgkmcnt(2)
    v_smfmac_f32_16x16x64_bf16 v[112:115], v[16:19], v[84:91], v100
    ds_read_b128 v[84:87], v110 offset:12288
    v_smfmac_f32_16x16x64_bf16 v[116:119], v[0:3], v[144:151], v100
    ds_read_b128 v[88:91], v110 offset:13312
    v_smfmac_f32_16x16x64_bf16 v[116:119], v[4:7], v[152:159], v100
    v_cvt_pk_bf16_f32 v72, v64, v65
    v_smfmac_f32_16x16x64_bf16 v[116:119], v[8:11], v[160:167], v100
    v_cvt_pk_bf16_f32 v73, v66, v67
    v_smfmac_f32_16x16x64_bf16 v[116:119], v[12:15], v[168:175], v100
    v_smfmac_f32_16x16x64_bf16 v[116:119], v[16:19], v[176:183], v100
    s_waitcnt lgkmcnt(2)
    v_smfmac_f32_16x16x64_bf16 v[112:115], v[20:23], v[92:99], v100
    v_smfmac_f32_16x16x64_bf16 v[116:119], v[20:23], v[184:191], v100
    v_smfmac_f32_16x16x64_bf16 v[116:119], v[24:27], v[192:199], v100
    v_smfmac_f32_16x16x64_bf16 v[60:63], v[0:3], v[200:207], v100
    v_smfmac_f32_16x16x64_bf16 v[60:63], v[4:7], v[208:215], v100
    v_cvt_pk_bf16_f32 v74, v116, v117
    v_smfmac_f32_16x16x64_bf16 v[60:63], v[8:11], v[216:223], v100
    v_cvt_pk_bf16_f32 v75, v118, v119
    s_waitcnt lgkmcnt(0)
    v_smfmac_f32_16x16x64_bf16 v[112:115], v[24:27], v[84:91], v100
    v_smfmac_f32_16x16x64_bf16 v[60:63], v[12:15], v[224:231], v100
    v_smfmac_f32_16x16x64_bf16 v[60:63], v[16:19], v[232:239], v100
    v_cvt_pk_bf16_f32 v82, v112, v113
    v_smfmac_f32_16x16x64_bf16 v[60:63], v[20:23], v[240:247], v100
    v_cvt_pk_bf16_f32 v83, v114, v115
    v_smfmac_f32_16x16x64_bf16 v[60:63], v[24:27], v[248:255], v100
    v_mov_b64 v[64:65], 0
    v_mov_b64 v[66:67], 0
    v_mov_b64 v[116:117], 0
    v_mov_b64 v[118:119], 0
    s_nop 5
    v_cvt_pk_bf16_f32 v80, v60, v61
    v_cvt_pk_bf16_f32 v81, v62, v63
    buffer_load_dwordx4 v[8:11], v104, s[4:7], s27 offen sc1
    buffer_load_dwordx4 v[0:3], v101, s[4:7], s27 offen sc1
    buffer_load_dwordx4 v[4:7], v101, s[4:7], s27 offen offset:1024 sc1
L_BpollP_134:
    s_sub_u32 s23, s23, 1
    s_cbranch_scc1 M_exit
    buffer_load_dwordx4 v[8:11], v104, s[4:7], s27 offen sc1
    buffer_load_dwordx4 v[0:3], v101, s[4:7], s27 offen sc1
    buffer_load_dwordx4 v[4:7], v101, s[4:7], s27 offen offset:1024 sc1
    s_waitcnt vmcnt(3)
    v_max3_u32 v109, v0, v1, v2
    v_max3_u32 v109, v109, v3, v4
    v_max3_u32 v109, v109, v5, v6
    v_max3_u32 v109, v109, v7, v8
    v_max3_u32 v109, v109, v9, v10
    v_max_u32 v109, v109, v11
    v_cmp_eq_u32 vcc, -1, v109
    s_cbranch_vccnz L_BpollP_134
    v_smfmac_f32_16x16x64_bf16 v[64:67], v[8:11], v[68:75], v100
    v_smfmac_f32_16x16x64_bf16 v[64:67], v[0:3], v[28:35], v100
    v_smfmac_f32_16x16x64_bf16 v[64:67], v[4:7], v[44:51], v100
    v_smfmac_f32_16x16x64_bf16 v[116:119], v[8:11], v[76:83], v100
    v_smfmac_f32_16x16x64_bf16 v[116:119], v[0:3], v[36:43], v100
    v_smfmac_f32_16x16x64_bf16 v[116:119], v[4:7], v[52:59], v100
    v_permlane32_swap_b32 v64, v65
    v_permlane32_swap_b32 v66, v67
    v_add_f32 v64, v64, v65
    v_add_f32 v66, v66, v67
    ds_write2_b32 v105, v64, v66 offset0:0 offset1:72
    s_nop 2
    v_permlane32_swap_b32 v116, v117
    v_permlane32_swap_b32 v118, v119
    v_add_f32 v116, v116, v117
    v_add_f32 v118, v118, v119
    ds_write2_b32 v105, v116, v118 offset0:16 offset1:88
    s_add_u32 s26, s26, 7168
    s_waitcnt lgkmcnt(0)
    s_barrier
    ds_read_b64 v[12:13], v106 offset:0
    ds_read_b64 v[14:15], v106 offset:1152
    ds_read_b64 v[16:17], v106 offset:2304
    ds_read_b64 v[18:19], v106 offset:3456
    s_waitcnt lgkmcnt(2)
    v_add_f32 v12, v12, v14
    v_add_f32 v13, v13, v15
    s_waitcnt lgkmcnt(0)
    v_add_f32 v16, v16, v18
    v_add_f32 v17, v17, v19
    v_add_f32 v12, v12, v16
    v_add_f32 v13, v13, v17
    v_cvt_pk_bf16_f32 v12, v12, v13
    v_min_u32 v12, -2, v12
    buffer_store_dword v12, v107, s[4:7], s26 offen
    v_cmp_eq_u32 s[60:61], s33, v111
    s_add_u32 s24, s24, 1
    s_add_u32 s27, s27, 10240
    s_add_u32 s28, s28, 0x70000
    s_cmp_lt_u32 s24, 63
    s_cbranch_scc1 B_top
    s_mov_b32 s26, 0x109e400
    buffer_store_dword v12, v107, s[4:7], s26 offen sc1
    s_endpgm
R_role:
    s_cmp_ge_u32 s20, 2
    s_cbranch_scc1 M_exit
    v_and_b32 v7, 31, v1
    v_lshlrev_b32 v7, 2, v7
L_Ri_135:
    s_sub_u32 s23, s23, 1
    s_cbranch_scc1 M_exit
    s_mov_b32 s63, 0x3fcc000
    buffer_load_dword v4, v7, s[4:7], s63 offen sc1
    v_mov_b32 v5, 1
    s_waitcnt vmcnt(0)
    v_min_u32 v4, v4, v5
    v_cmp_eq_u32 vcc, 0, v4
    s_cbranch_vccnz L_Ri_135
    s_cmp_ge_u32 s20, 2
    s_cbranch_scc1 M_exit
    v_lshlrev_b32 v2, 4, v1
    s_add_u32 s24, s20, 1
    s_mul_i32 s26, s24, 7168
    s_add_u32 s27, s26, 0x1030000
    s_add_u32 s26, s26, 0xfc0000
R_top:
    s_add_u32 s28, s26, 4096
    s_add_u32 s29, s27, 4096
L_Rp0_136:
    s_sub_u32 s23, s23, 1
    s_cbranch_scc1 M_exit
    buffer_load_dword v3, off, s[4:7], s26 sc1
    s_waitcnt vmcnt(0)
    v_cmp_eq_u32 vcc, -1, v3
    s_cbranch_vccnz L_Rp0_136
L_Rpoll_137:
    s_sub_u32 s23, s23, 1
    s_cbranch_scc1 M_exit
    buffer_load_dwordx4 v[4:7], v2, s[4:7], s26 offen offset:0 sc1
    buffer_load_dwordx4 v[8:11], v2, s[4:7], s26 offen offset:1024 sc1
    buffer_load_dwordx4 v[12:15], v2, s[4:7], s26 offen offset:2048 sc1
    buffer_load_dwordx4 v[16:19], v2, s[4:7], s26 offen offset:3072 sc1
    buffer_load_dwordx4 v[20:23], v2, s[4:7], s28 offen offset:0 sc1
    buffer_load_dwordx4 v[24:27], v2, s[4:7], s28 offen offset:1024 sc1
    buffer_load_dwordx4 v[28:31], v2, s[4:7], s28 offen offset:2048 sc1
    s_waitcnt vmcnt(0)
    v_max3_u32 v3, v4, v5, v6
    v_max3_u32 v3, v3, v7, v8
    v_max3_u32 v3, v3, v9, v10
    v_max3_u32 v3, v3, v11, v12
    v_max3_u32 v3, v3, v13, v14
    v_max3_u32 v3, v3, v15, v16
    v_max3_u32 v3, v3, v17, v18
    v_max3_u32 v3, v3, v19, v20
    v_max3_u32 v3, v3, v21, v22
    v_max3_u32 v3, v3, v23, v24
    v_max3_u32 v3, v3, v25, v26
    v_max3_u32 v3, v3, v27, v28
    v_max3_u32 v3, v3, v29, v30
    v_max_u32 v3, v3, v31
    v_cmp_eq_u32 vcc, -1, v3
    s_cbranch_vccnz L_Rpoll_137
    buffer_store_dwordx4 v[4:7], v2, s[4:7], s27 offen offset:0 sc1
    buffer_store_dwordx4 v[8:11], v2, s[4:7], s27 offen offset:1024 sc1
    buffer_store_dwordx4 v[12:15], v2, s[4:7], s27 offen offset:2048 sc1
    buffer_store_dwordx4 v[16:19], v2, s[4:7], s27 offen offset:3072 sc1
    buffer_store_dwordx4 v[20:23], v2, s[4:7], s29 offen offset:0 sc1
    buffer_store_dwordx4 v[24:27], v2, s[4:7], s29 offen offset:1024 sc1
    buffer_store_dwordx4 v[28:31], v2, s[4:7], s29 offen offset:2048 sc1
    s_add_u32 s24, s24, 2
    s_add_u32 s26, s26, 14336
    s_add_u32 s27, s27, 14336
    s_waitcnt vmcnt(0)
    s_cmp_lt_u32 s24, 63
    s_cbranch_scc1 R_top
    s_endpgm
F_role:
    s_cmp_lg_u32 s20, 0
    s_cbranch_scc1 L_one_138
    v_and_b32 v7, 31, v1
    v_lshlrev_b32 v7, 2, v7
L_Fi_139:
    s_sub_u32 s23, s23, 1
    s_cbranch_scc1 M_exit
    s_mov_b32 s63, 0x3fcc000
    buffer_load_dword v4, v7, s[4:7], s63 offen sc1
    v_mov_b32 v5, 1
    s_waitcnt vmcnt(0)
    v_min_u32 v4, v4, v5
    v_cmp_eq_u32 vcc, 0, v4
    s_cbranch_vccnz L_Fi_139
L_one_138:
    s_barrier
    v_lshlrev_b32 v2, 4, v1
    s_lshl_b32 s27, s20, 13
    s_add_u32 s27, s27, 0x3dd0000
    s_mov_b32 s24, 0
    s_mov_b32 s26, 0xfc0000
    s_and_b32 s29, s20, 1
    s_lshl_b32 s29, s29, 13
    v_lshl_add_u32 v40, v1, 7, s29
    s_movk_i32 s30, 7168
    s_mov_b32 s31, 0xfc1c00
    s_cmp_lt_u32 s20, 2
    s_cselect_b32 s30, 10240, s30
    s_cselect_b32 s31, 0x10a0000, s31
    s_sub_u32 s29, s30, 128
    v_min_u32 v40, s29, v40
F_top:
    buffer_load_dword v41, v40, s[4:7], s31 offen sc1
    s_add_u32 s31, s31, s30
    s_add_u32 s28, s27, 4096
    buffer_load_dwordx4 v[4:7], v2, s[4:7], s27 offen offset:0
    buffer_load_dwordx4 v[8:11], v2, s[4:7], s27 offen offset:1024
    buffer_load_dwordx4 v[12:15], v2, s[4:7], s27 offen offset:2048
    buffer_load_dwordx4 v[16:19], v2, s[4:7], s27 offen offset:3072
    buffer_load_dwordx4 v[20:23], v2, s[4:7], s28 offen offset:0
    buffer_load_dwordx4 v[24:27], v2, s[4:7], s28 offen offset:1024
    buffer_load_dwordx4 v[28:31], v2, s[4:7], s28 offen offset:2048
    buffer_load_dwordx4 v[32:35], v2, s[4:7], s28 offen offset:3072
L_Fpoll_140:
    s_sub_u32 s23, s23, 1
    s_cbranch_scc1 M_exit
    buffer_load_dword v3, off, s[4:7], s26 sc1
    s_waitcnt vmcnt(0)
    v_cmp_eq_u32 vcc, -1, v3
    s_cbranch_vccnz L_Fpoll_140
    s_add_u32 s24, s24, 1
    s_add_u32 s26, s26, 7168
    s_add_u32 s27, s27, 32768
    s_cmp_lt_u32 s24, 63
    s_cbranch_scc1 F_top
    s_endpgm
W_roles:
    s_sub_u32 s25, s21, 1
    s_lshl_b32 s25, s25, 5
    s_add_u32 s22, s22, s25
    v_lshlrev_b32 v104, 4, v1
    s_cmp_ge_u32 s22, 160
    s_cbranch_scc1 W3_role
    s_cmp_ge_u32 s22, 128
    s_cbranch_scc1 RH_role
    s_cmp_ge_u32 s22, 64
    s_cbranch_scc1 RT_role
RU_role:
    s_lshr_b32 s25, s22, 2
    s_and_b32 s24, s22, 3
    s_mov_b32 s26, s25
    s_mul_i32 s26, s26, 512
    s_add_u32 s26, s26, 0x3fc8000
    s_cmp_lg_u32 s20, 0
    s_cbranch_scc1 L_one_141
    v_and_b32 v3, 7, v1
    v_min_u32 v3, 6, v3
    v_bfe_u32 v4, v1, 3, 2
    v_mul_u32_u24 v4, 128, v4
    v_lshl_add_u32 v3, v3, 2, v4
L_Uw_142:
    s_sub_u32 s23, s23, 1
    s_cbranch_scc1 M_exit
    buffer_load_dword v4, v3, s[4:7], s26 offen sc1
    s_waitcnt vmcnt(0)
    v_cmp_gt_u32 vcc, 7, v4
    s_cbranch_vccnz L_Uw_142
L_one_141:
    s_barrier
    s_add_u32 s33, s25, 0x1140000
    s_mul_i32 s26, s25, 0x62000
    s_mul_i32 s29, s20, 100352
    s_add_u32 s26, s26, s29
    s_add_u32 s26, s26, 0x620000
    v_and_b32 v7, 31, v1
    v_lshlrev_b32 v7, 2, v7
    s_mov_b32 s63, 0x3fcc000
    buffer_load_dword v4, v7, s[4:7], s63 offen sc1
    v_mov_b32 v5, 1
    s_add_u32 s63, s26, 0x0
    buffer_load_dwordx4 a[0:3], v104, s[4:7], s63 offen
    buffer_load_dwordx4 a[4:7], v104, s[4:7], s63 offen offset:1024
    s_add_u32 s63, s26, 0x3800
    buffer_load_dwordx4 a[56:59], v104, s[4:7], s63 offen
    buffer_load_dwordx4 a[60:63], v104, s[4:7], s63 offen offset:1024
    s_add_u32 s63, s26, 0x7000
    buffer_load_dwordx4 a[112:115], v104, s[4:7], s63 offen
    buffer_load_dwordx4 a[116:119], v104, s[4:7], s63 offen offset:1024
    s_add_u32 s63, s26, 0xa800
    buffer_load_dwordx4 a[168:171], v104, s[4:7], s63 offen
    buffer_load_dwordx4 a[172:175], v104, s[4:7], s63 offen offset:1024
    s_add_u32 s63, s26, 0xe000
    buffer_load_dwordx4 a[224:227], v104, s[4:7], s63 offen
    buffer_load_dwordx4 a[228:231], v104, s[4:7], s63 offen offset:1024
    s_add_u32 s63, s26, 0x11800
    buffer_load_dwordx4 v[144:147], v104, s[4:7], s63 offen
    buffer_load_dwordx4 v[148:151], v104, s[4:7], s63 offen offset:1024
    s_add_u32 s63, s26, 0x15000
    buffer_load_dwordx4 v[200:203], v104, s[4:7], s63 offen
    buffer_load_dwordx4 v[204:207], v104, s[4:7], s63 offen offset:1024
    s_add_u32 s63, s26, 0x800
    buffer_load_dwordx4 a[8:11], v104, s[4:7], s63 offen
    buffer_load_dwordx4 a[12:15], v104, s[4:7], s63 offen offset:1024
    s_add_u32 s63, s26, 0x4000
    buffer_load_dwordx4 a[64:67], v104, s[4:7], s63 offen
    buffer_load_dwordx4 a[68:71], v104, s[4:7], s63 offen offset:1024
    s_add_u32 s63, s26, 0x7800
    buffer_load_dwordx4 a[120:123], v104, s[4:7], s63 offen
    buffer_load_dwordx4 a[124:127], v104, s[4:7], s63 offen offset:1024
    s_add_u32 s63, s26, 0xb000
    buffer_load_dwordx4 a[176:179], v104, s[4:7], s63 offen
    buffer_load_dwordx4 a[180:183], v104, s[4:7], s63 offen offset:1024
    s_add_u32 s63, s26, 0xe800
    buffer_load_dwordx4 a[232:235], v104, s[4:7], s63 offen
    buffer_load_dwordx4 a[236:239], v104, s[4:7], s63 offen offset:1024
    s_add_u32 s63, s26, 0x12000
    buffer_load_dwordx4 v[152:155], v104, s[4:7], s63 offen
    buffer_load_dwordx4 v[156:159], v104, s[4:7], s63 offen offset:1024
    s_add_u32 s63, s26, 0x15800
    buffer_load_dwordx4 v[208:211], v104, s[4:7], s63 offen
    buffer_load_dwordx4 v[212:215], v104, s[4:7], s63 offen offset:1024
    s_add_u32 s63, s26, 0x1000
    buffer_load_dwordx4 a[16:19], v104, s[4:7], s63 offen
    buffer_load_dwordx4 a[20:23], v104, s[4:7], s63 offen offset:1024
    s_add_u32 s63, s26, 0x4800
    buffer_load_dwordx4 a[72:75], v104, s[4:7], s63 offen
    buffer_load_dwordx4 a[76:79], v104, s[4:7], s63 offen offset:1024
    s_add_u32 s63, s26, 0x8000
    buffer_load_dwordx4 a[128:131], v104, s[4:7], s63 offen
    buffer_load_dwordx4 a[132:135], v104, s[4:7], s63 offen offset:1024
    s_add_u32 s63, s26, 0xb800
    buffer_load_dwordx4 a[184:187], v104, s[4:7], s63 offen
    buffer_load_dwordx4 a[188:191], v104, s[4:7], s63 offen offset:1024
    s_add_u32 s63, s26, 0xf000
    buffer_load_dwordx4 a[240:243], v104, s[4:7], s63 offen
    buffer_load_dwordx4 a[244:247], v104, s[4:7], s63 offen offset:1024
    s_add_u32 s63, s26, 0x12800
    buffer_load_dwordx4 v[160:163], v104, s[4:7], s63 offen
    buffer_load_dwordx4 v[164:167], v104, s[4:7], s63 offen offset:1024
    s_waitcnt vmcnt(40)
    v_min_u32 v4, v4, v5
    v_cmp_eq_u32 vcc, 0, v4
    s_cbranch_vccz L_Ulok_143
    v_and_b32 v7, 31, v1
    v_lshlrev_b32 v7, 2, v7
L_Ul_144:
    s_sub_u32 s23, s23, 1
    s_cbranch_scc1 M_exit
    s_mov_b32 s63, 0x3fcc000
    buffer_load_dword v4, v7, s[4:7], s63 offen sc1
    v_mov_b32 v5, 1
    s_waitcnt vmcnt(0)
    v_min_u32 v4, v4, v5
    v_cmp_eq_u32 vcc, 0, v4
    s_cbranch_vccnz L_Ul_144
L_Ulok_143:
    s_mul_i32 s27, s24, 28672
    s_mul_i32 s28, s20, 7168
    s_add_u32 s27, s27, s28
    s_add_u32 s27, s27, 0xe00000
    s_mov_b32 m0, s28
    s_add_u32 s63, s27, 4096
    buffer_load_dwordx4 v104, s[4:7], s27 offen offset:0 lds
    buffer_load_dwordx4 v104, s[4:7], s27 offen offset:1024 lds
    buffer_load_dwordx4 v104, s[4:7], s27 offen offset:2048 lds
    buffer_load_dwordx4 v104, s[4:7], s27 offen offset:3072 lds
    s_add_u32 m0, s28, 4096
    s_nop 0
    buffer_load_dwordx4 v104, s[4:7], s63 offen offset:0 lds
    buffer_load_dwordx4 v104, s[4:7], s63 offen offset:1024 lds
    buffer_load_dwordx4 v104, s[4:7], s63 offen offset:2048 lds
    v_mov_b32 v105, v104
    s_lshl_b32 s30, s24, 4
    s_add_u32 s30, s30, s33
    s_mov_b32 s31, 0x1145000
    s_add_u32 s63, s26, 0x16000
    buffer_load_dwordx4 v[216:219], v104, s[4:7], s63 offen
    buffer_load_dwordx4 v[220:223], v104, s[4:7], s63 offen offset:1024
    s_add_u32 s63, s26, 0x1800
    buffer_load_dwordx4 a[24:27], v104, s[4:7], s63 offen
    buffer_load_dwordx4 a[28:31], v104, s[4:7], s63 offen offset:1024
    s_add_u32 s63, s26, 0x5000
    buffer_load_dwordx4 a[80:83], v104, s[4:7], s63 offen
    buffer_load_dwordx4 a[84:87], v104, s[4:7], s63 offen offset:1024
    s_add_u32 s63, s26, 0x8800
    buffer_load_dwordx4 a[136:139], v104, s[4:7], s63 offen
    buffer_load_dwordx4 a[140:143], v104, s[4:7], s63 offen offset:1024
    s_add_u32 s63, s26, 0xc000
    buffer_load_dwordx4 a[192:195], v104, s[4:7], s63 offen
    buffer_load_dwordx4 a[196:199], v104, s[4:7], s63 offen offset:1024
    s_add_u32 s63, s26, 0xf800
    buffer_load_dwordx4 a[248:251], v104, s[4:7], s63 offen
    buffer_load_dwordx4 a[252:255], v104, s[4:7], s63 offen offset:1024
    s_add_u32 s63, s26, 0x13000
    buffer_load_dwordx4 v[168:171], v104, s[4:7], s63 offen
    buffer_load_dwordx4 v[172:175], v104, s[4:7], s63 offen offset:1024
    s_add_u32 s63, s26, 0x16800
    buffer_load_dwordx4 v[224:227], v104, s[4:7], s63 offen
    buffer_load_dwordx4 v[228:231], v104, s[4:7], s63 offen offset:1024
    s_waitcnt vmcnt(48)
    s_add_u32 s63, s26, 0x2000
    buffer_load_dwordx4 a[32:35], v104, s[4:7], s63 offen
    buffer_load_dwordx4 a[36:39], v104, s[4:7], s63 offen offset:1024
    s_add_u32 s63, s26, 0x5800
    buffer_load_dwordx4 a[88:91], v104, s[4:7], s63 offen
    buffer_load_dwordx4 a[92:95], v104, s[4:7], s63 offen offset:1024
    s_add_u32 s63, s26, 0x9000
    buffer_load_dwordx4 a[144:147], v104, s[4:7], s63 offen
    buffer_load_dwordx4 a[148:151], v104, s[4:7], s63 offen offset:1024
    s_add_u32 s63, s26, 0xc800
    buffer_load_dwordx4 a[200:203], v104, s[4:7], s63 offen
    buffer_load_dwordx4 a[204:207], v104, s[4:7], s63 offen offset:1024
    s_waitcnt vmcnt(48)
    s_add_u32 s63, s26, 0x10000
    buffer_load_dwordx4 v[120:123], v104, s[4:7], s63 offen
    buffer_load_dwordx4 v[124:127], v104, s[4:7], s63 offen offset:1024
    s_add_u32 s63, s26, 0x13800
    buffer_load_dwordx4 v[176:179], v104, s[4:7], s63 offen
    buffer_load_dwordx4 v[180:183], v104, s[4:7], s63 offen offset:1024
    s_add_u32 s63, s26, 0x17000
    buffer_load_dwordx4 v[232:235], v104, s[4:7], s63 offen
    buffer_load_dwordx4 v[236:239], v104, s[4:7], s63 offen offset:1024
    s_add_u32 s63, s26, 0x2800
    buffer_load_dwordx4 a[40:43], v104, s[4:7], s63 offen
    buffer_load_dwordx4 a[44:47], v104, s[4:7], s63 offen offset:1024
    s_waitcnt vmcnt(48)
    s_add_u32 s63, s26, 0x6000
    buffer_load_dwordx4 a[96:99], v104, s[4:7], s63 offen
    buffer_load_dwordx4 a[100:103], v104, s[4:7], s63 offen offset:1024
    s_add_u32 s63, s26, 0x9800
    buffer_load_dwordx4 a[152:155], v104, s[4:7], s63 offen
    buffer_load_dwordx4 a[156:159], v104, s[4:7], s63 offen offset:1024
    s_add_u32 s63, s26, 0xd000
    buffer_load_dwordx4 a[208:211], v104, s[4:7], s63 offen
    buffer_load_dwordx4 a[212:215], v104, s[4:7], s63 offen offset:1024
    s_add_u32 s63, s26, 0x10800
    buffer_load_dwordx4 v[128:131], v104, s[4:7], s63 offen
    buffer_load_dwordx4 v[132:135], v104, s[4:7], s63 offen offset:1024
    s_waitcnt vmcnt(48)
    s_add_u32 s63, s26, 0x14000
    buffer_load_dwordx4 v[184:187], v104, s[4:7], s63 offen
    buffer_load_dwordx4 v[188:191], v104, s[4:7], s63 offen offset:1024
    s_add_u32 s63, s26, 0x17800
    buffer_load_dwordx4 v[240:243], v104, s[4:7], s63 offen
    buffer_load_dwordx4 v[244:247], v104, s[4:7], s63 offen offset:1024
    s_add_u32 s63, s26, 0x3000
    buffer_load_dwordx4 a[48:51], v104, s[4:7], s63 offen
    buffer_load_dwordx4 a[52:55], v104, s[4:7], s63 offen offset:1024
    s_add_u32 s63, s26, 0x6800
    buffer_load_dwordx4 a[104:107], v104, s[4:7], s63 offen
    buffer_load_dwordx4 a[108:111], v104, s[4:7], s63 offen offset:1024
    s_waitcnt vmcnt(48)
    s_add_u32 s63, s26, 0xa000
    buffer_load_dwordx4 a[160:163], v104, s[4:7], s63 offen
    buffer_load_dwordx4 a[164:167], v104, s[4:7], s63 offen offset:1024
    s_add_u32 s63, s26, 0xd800
    buffer_load_dwordx4 a[216:219], v104, s[4:7], s63 offen
    buffer_load_dwordx4 a[220:223], v104, s[4:7], s63 offen offset:1024
    s_add_u32 s63, s26, 0x11000
    buffer_load_dwordx4 v[136:139], v104, s[4:7], s63 offen
    buffer_load_dwordx4 v[140:143], v104, s[4:7], s63 offen offset:1024
    s_add_u32 s63, s26, 0x14800
    buffer_load_dwordx4 v[192:195], v104, s[4:7], s63 offen
    buffer_load_dwordx4 v[196:199], v104, s[4:7], s63 offen offset:1024
    s_waitcnt vmcnt(48)
    s_add_u32 s63, s26, 0x18000
    buffer_load_dwordx4 v[248:251], v104, s[4:7], s63 offen
    buffer_load_dwordx4 v[252:255], v104, s[4:7], s63 offen offset:1024
    s_mul_i32 s29, s24, 0x70000
    s_mul_i32 s32, s25, 28672
    s_add_u32 s29, s29, s32
    s_mul_i32 s32, s20, 7168
    s_add_u32 s29, s29, s32
    s_add_u32 s29, s29, 0x1148000
    v_bfe_u32 v3, v1, 3, 1
    v_mov_b32 v4, 0x4444
    v_mov_b32 v5, 0xeeee
    v_cmp_eq_u32 vcc, 1, v3
    s_nop 1
    v_cndmask_b32 v106, v4, v5, vcc
    s_and_b32 s32, s25, 1
    s_lshl_b32 s32, s32, 9
    s_bfe_u32 s33, s25, 0x10001
    s_lshl_b32 s33, s33, 3
    s_add_u32 s32, s32, s33
    v_and_b32 v2, 31, v1
    v_lshl_add_u32 v2, v2, 4, s32
    v_add_u32 v3, 1024, v2
    v_mov_b32 v4, 0x40000000
    v_cmp_gt_u32 vcc, 32, v1
    s_nop 1
    v_cndmask_b32 v107, v3, v2, vcc
    v_cndmask_b32 v108, v4, v2, vcc
    s_mov_b32 s52, s24
    s_mul_i32 s50, s24, 7168
    s_add_u32 s50, s50, 0x1030000
    s_mul_i32 s53, s24, 0x1c000
    s_lshr_b32 s32, s25, 2
    s_mul_i32 s32, s32, 28672
    s_add_u32 s53, s53, s32
    s_mul_i32 s32, s20, 7168
    s_add_u32 s53, s53, s32
    s_add_u32 s53, s53, 0x2d48000
    s_lshl_b32 s55, s24, 6
    s_lshl_b32 s32, s25, 2
    s_add_u32 s55, s55, s32
    s_add_u32 s55, s55, 0x1143000
    s_add_u32 s27, s27, 114688
    s_xor_b32 s28, s28, 32768
    s_barrier
    ds_read_b128 v[56:59], v105 offset:0
    ds_read_b128 v[60:63], v105 offset:14336
    ds_read_b128 v[64:67], v105 offset:1024
    ds_read_b128 v[68:71], v105 offset:15360
    s_waitcnt lgkmcnt(2)
    v_mfma_f32_16x16x32_bf16 v[0:3], v[56:59], a[0:3], 0
    v_mfma_f32_16x16x32_bf16 v[4:7], v[60:63], a[0:3], 0
    v_mfma_f32_16x16x32_bf16 v[8:11], v[56:59], a[56:59], 0
    v_mfma_f32_16x16x32_bf16 v[12:15], v[60:63], a[56:59], 0
    v_mfma_f32_16x16x32_bf16 v[16:19], v[56:59], a[112:115], 0
    v_mfma_f32_16x16x32_bf16 v[20:23], v[60:63], a[112:115], 0
    v_mfma_f32_16x16x32_bf16 v[24:27], v[56:59], a[168:171], 0
    v_mfma_f32_16x16x32_bf16 v[28:31], v[60:63], a[168:171], 0
    v_mfma_f32_16x16x32_bf16 v[32:35], v[56:59], a[224:227], 0
    v_mfma_f32_16x16x32_bf16 v[36:39], v[60:63], a[224:227], 0
    v_mfma_f32_16x16x32_bf16 v[40:43], v[56:59], v[144:147], 0
    v_mfma_f32_16x16x32_bf16 v[44:47], v[60:63], v[144:147], 0
    v_mfma_f32_16x16x32_bf16 v[48:51], v[56:59], v[200:203], 0
    v_mfma_f32_16x16x32_bf16 v[52:55], v[60:63], v[200:203], 0
    ds_read_b128 v[56:59], v105 offset:2048
    ds_read_b128 v[60:63], v105 offset:16384
    s_waitcnt lgkmcnt(2)
    v_mfma_f32_16x16x32_bf16 v[0:3], v[64:67], a[4:7], v[0:3]
    v_mfma_f32_16x16x32_bf16 v[4:7], v[68:71], a[4:7], v[4:7]
    v_mfma_f32_16x16x32_bf16 v[8:11], v[64:67], a[60:63], v[8:11]
    v_mfma_f32_16x16x32_bf16 v[12:15], v[68:71], a[60:63], v[12:15]
    v_mfma_f32_16x16x32_bf16 v[16:19], v[64:67], a[116:119], v[16:19]
    v_mfma_f32_16x16x32_bf16 v[20:23], v[68:71], a[116:119], v[20:23]
    v_mfma_f32_16x16x32_bf16 v[24:27], v[64:67], a[172:175], v[24:27]
    v_mfma_f32_16x16x32_bf16 v[28:31], v[68:71], a[172:175], v[28:31]
    v_mfma_f32_16x16x32_bf16 v[32:35], v[64:67], a[228:231], v[32:35]
    v_mfma_f32_16x16x32_bf16 v[36:39], v[68:71], a[228:231], v[36:39]
    v_mfma_f32_16x16x32_bf16 v[40:43], v[64:67], v[148:151], v[40:43]
    v_mfma_f32_16x16x32_bf16 v[44:47], v[68:71], v[148:151], v[44:47]
    v_mfma_f32_16x16x32_bf16 v[48:51], v[64:67], v[204:207], v[48:51]
    v_mfma_f32_16x16x32_bf16 v[52:55], v[68:71], v[204:207], v[52:55]
    ds_read_b128 v[64:67], v105 offset:3072
    ds_read_b128 v[68:71], v105 offset:17408
    s_waitcnt lgkmcnt(2)
    v_mfma_f32_16x16x32_bf16 v[0:3], v[56:59], a[8:11], v[0:3]
    v_mfma_f32_16x16x32_bf16 v[4:7], v[60:63], a[8:11], v[4:7]
    v_mfma_f32_16x16x32_bf16 v[8:11], v[56:59], a[64:67], v[8:11]
    v_mfma_f32_16x16x32_bf16 v[12:15], v[60:63], a[64:67], v[12:15]
    v_mfma_f32_16x16x32_bf16 v[16:19], v[56:59], a[120:123], v[16:19]
    v_mfma_f32_16x16x32_bf16 v[20:23], v[60:63], a[120:123], v[20:23]
    v_mfma_f32_16x16x32_bf16 v[24:27], v[56:59], a[176:179], v[24:27]
    v_mfma_f32_16x16x32_bf16 v[28:31], v[60:63], a[176:179], v[28:31]
    v_mfma_f32_16x16x32_bf16 v[32:35], v[56:59], a[232:235], v[32:35]
    v_mfma_f32_16x16x32_bf16 v[36:39], v[60:63], a[232:235], v[36:39]
    v_mfma_f32_16x16x32_bf16 v[40:43], v[56:59], v[152:155], v[40:43]
    v_mfma_f32_16x16x32_bf16 v[44:47], v[60:63], v[152:155], v[44:47]
    v_mfma_f32_16x16x32_bf16 v[48:51], v[56:59], v[208:211], v[48:51]
    v_mfma_f32_16x16x32_bf16 v[52:55], v[60:63], v[208:211], v[52:55]
    ds_read_b128 v[56:59], v105 offset:4096
    ds_read_b128 v[60:63], v105 offset:18432
    s_waitcnt lgkmcnt(2)
    v_mfma_f32_16x16x32_bf16 v[0:3], v[64:67], a[12:15], v[0:3]
    v_mfma_f32_16x16x32_bf16 v[4:7], v[68:71], a[12:15], v[4:7]
    v_mfma_f32_16x16x32_bf16 v[8:11], v[64:67], a[68:71], v[8:11]
    v_mfma_f32_16x16x32_bf16 v[12:15], v[68:71], a[68:71], v[12:15]
    v_mfma_f32_16x16x32_bf16 v[16:19], v[64:67], a[124:127], v[16:19]
    v_mfma_f32_16x16x32_bf16 v[20:23], v[68:71], a[124:127], v[20:23]
    v_mfma_f32_16x16x32_bf16 v[24:27], v[64:67], a[180:183], v[24:27]
    v_mfma_f32_16x16x32_bf16 v[28:31], v[68:71], a[180:183], v[28:31]
    v_mfma_f32_16x16x32_bf16 v[32:35], v[64:67], a[236:239], v[32:35]
    v_mfma_f32_16x16x32_bf16 v[36:39], v[68:71], a[236:239], v[36:39]
    v_mfma_f32_16x16x32_bf16 v[40:43], v[64:67], v[156:159], v[40:43]
    v_mfma_f32_16x16x32_bf16 v[44:47], v[68:71], v[156:159], v[44:47]
    v_mfma_f32_16x16x32_bf16 v[48:51], v[64:67], v[212:215], v[48:51]
    v_mfma_f32_16x16x32_bf16 v[52:55], v[68:71], v[212:215], v[52:55]
    ds_read_b128 v[64:67], v105 offset:5120
    ds_read_b128 v[68:71], v105 offset:19456
    s_waitcnt lgkmcnt(2)
    v_mfma_f32_16x16x32_bf16 v[0:3], v[56:59], a[16:19], v[0:3]
    v_mfma_f32_16x16x32_bf16 v[4:7], v[60:63], a[16:19], v[4:7]
    v_mfma_f32_16x16x32_bf16 v[8:11], v[56:59], a[72:75], v[8:11]
    v_mfma_f32_16x16x32_bf16 v[12:15], v[60:63], a[72:75], v[12:15]
    v_mfma_f32_16x16x32_bf16 v[16:19], v[56:59], a[128:131], v[16:19]
    v_mfma_f32_16x16x32_bf16 v[20:23], v[60:63], a[128:131], v[20:23]
    v_mfma_f32_16x16x32_bf16 v[24:27], v[56:59], a[184:187], v[24:27]
    v_mfma_f32_16x16x32_bf16 v[28:31], v[60:63], a[184:187], v[28:31]
    v_mfma_f32_16x16x32_bf16 v[32:35], v[56:59], a[240:243], v[32:35]
    v_mfma_f32_16x16x32_bf16 v[36:39], v[60:63], a[240:243], v[36:39]
    v_mfma_f32_16x16x32_bf16 v[40:43], v[56:59], v[160:163], v[40:43]
    v_mfma_f32_16x16x32_bf16 v[44:47], v[60:63], v[160:163], v[44:47]
    v_mfma_f32_16x16x32_bf16 v[48:51], v[56:59], v[216:219], v[48:51]
    v_mfma_f32_16x16x32_bf16 v[52:55], v[60:63], v[216:219], v[52:55]
    ds_read_b128 v[56:59], v105 offset:6144
    ds_read_b128 v[60:63], v105 offset:20480
    s_waitcnt lgkmcnt(2)
    v_mfma_f32_16x16x32_bf16 v[0:3], v[64:67], a[20:23], v[0:3]
    v_mfma_f32_16x16x32_bf16 v[4:7], v[68:71], a[20:23], v[4:7]
    v_mfma_f32_16x16x32_bf16 v[8:11], v[64:67], a[76:79], v[8:11]
    v_mfma_f32_16x16x32_bf16 v[12:15], v[68:71], a[76:79], v[12:15]
    v_mfma_f32_16x16x32_bf16 v[16:19], v[64:67], a[132:135], v[16:19]
    v_mfma_f32_16x16x32_bf16 v[20:23], v[68:71], a[132:135], v[20:23]
    v_mfma_f32_16x16x32_bf16 v[24:27], v[64:67], a[188:191], v[24:27]
    v_mfma_f32_16x16x32_bf16 v[28:31], v[68:71], a[188:191], v[28:31]
    v_mfma_f32_16x16x32_bf16 v[32:35], v[64:67], a[244:247], v[32:35]
    v_mfma_f32_16x16x32_bf16 v[36:39], v[68:71], a[244:247], v[36:39]
    v_mfma_f32_16x16x32_bf16 v[40:43], v[64:67], v[164:167], v[40:43]
    v_mfma_f32_16x16x32_bf16 v[44:47], v[68:71], v[164:167], v[44:47]
    v_mfma_f32_16x16x32_bf16 v[48:51], v[64:67], v[220:223], v[48:51]
    v_mfma_f32_16x16x32_bf16 v[52:55], v[68:71], v[220:223], v[52:55]
    ds_read_b128 v[64:67], v105 offset:7168
    ds_read_b128 v[68:71], v105 offset:21504
    s_waitcnt lgkmcnt(2)
    s_waitcnt vmcnt(42)
    v_mfma_f32_16x16x32_bf16 v[0:3], v[56:59], a[24:27], v[0:3]
    v_mfma_f32_16x16x32_bf16 v[4:7], v[60:63], a[24:27], v[4:7]
    v_mfma_f32_16x16x32_bf16 v[8:11], v[56:59], a[80:83], v[8:11]
    v_mfma_f32_16x16x32_bf16 v[12:15], v[60:63], a[80:83], v[12:15]
    v_mfma_f32_16x16x32_bf16 v[16:19], v[56:59], a[136:139], v[16:19]
    v_mfma_f32_16x16x32_bf16 v[20:23], v[60:63], a[136:139], v[20:23]
    v_mfma_f32_16x16x32_bf16 v[24:27], v[56:59], a[192:195], v[24:27]
    v_mfma_f32_16x16x32_bf16 v[28:31], v[60:63], a[192:195], v[28:31]
    v_mfma_f32_16x16x32_bf16 v[32:35], v[56:59], a[248:251], v[32:35]
    v_mfma_f32_16x16x32_bf16 v[36:39], v[60:63], a[248:251], v[36:39]
    v_mfma_f32_16x16x32_bf16 v[40:43], v[56:59], v[168:171], v[40:43]
    v_mfma_f32_16x16x32_bf16 v[44:47], v[60:63], v[168:171], v[44:47]
    v_mfma_f32_16x16x32_bf16 v[48:51], v[56:59], v[224:227], v[48:51]
    v_mfma_f32_16x16x32_bf16 v[52:55], v[60:63], v[224:227], v[52:55]
    ds_read_b128 v[56:59], v105 offset:8192
    ds_read_b128 v[60:63], v105 offset:22528
    s_waitcnt lgkmcnt(2)
    v_mfma_f32_16x16x32_bf16 v[0:3], v[64:67], a[28:31], v[0:3]
    v_mfma_f32_16x16x32_bf16 v[4:7], v[68:71], a[28:31], v[4:7]
    v_mfma_f32_16x16x32_bf16 v[8:11], v[64:67], a[84:87], v[8:11]
    v_mfma_f32_16x16x32_bf16 v[12:15], v[68:71], a[84:87], v[12:15]
    v_mfma_f32_16x16x32_bf16 v[16:19], v[64:67], a[140:143], v[16:19]
    v_mfma_f32_16x16x32_bf16 v[20:23], v[68:71], a[140:143], v[20:23]
    v_mfma_f32_16x16x32_bf16 v[24:27], v[64:67], a[196:199], v[24:27]
    v_mfma_f32_16x16x32_bf16 v[28:31], v[68:71], a[196:199], v[28:31]
    v_mfma_f32_16x16x32_bf16 v[32:35], v[64:67], a[252:255], v[32:35]
    v_mfma_f32_16x16x32_bf16 v[36:39], v[68:71], a[252:255], v[36:39]
    v_mfma_f32_16x16x32_bf16 v[40:43], v[64:67], v[172:175], v[40:43]
    v_mfma_f32_16x16x32_bf16 v[44:47], v[68:71], v[172:175], v[44:47]
    v_mfma_f32_16x16x32_bf16 v[48:51], v[64:67], v[228:231], v[48:51]
    v_mfma_f32_16x16x32_bf16 v[52:55], v[68:71], v[228:231], v[52:55]
    ds_read_b128 v[64:67], v105 offset:9216
    ds_read_b128 v[68:71], v105 offset:23552
    s_waitcnt lgkmcnt(2)
    s_waitcnt vmcnt(28)
    v_mfma_f32_16x16x32_bf16 v[0:3], v[56:59], a[32:35], v[0:3]
    v_mfma_f32_16x16x32_bf16 v[4:7], v[60:63], a[32:35], v[4:7]
    v_mfma_f32_16x16x32_bf16 v[8:11], v[56:59], a[88:91], v[8:11]
    v_mfma_f32_16x16x32_bf16 v[12:15], v[60:63], a[88:91], v[12:15]
    v_mfma_f32_16x16x32_bf16 v[16:19], v[56:59], a[144:147], v[16:19]
    v_mfma_f32_16x16x32_bf16 v[20:23], v[60:63], a[144:147], v[20:23]
    v_mfma_f32_16x16x32_bf16 v[24:27], v[56:59], a[200:203], v[24:27]
    v_mfma_f32_16x16x32_bf16 v[28:31], v[60:63], a[200:203], v[28:31]
    v_mfma_f32_16x16x32_bf16 v[32:35], v[56:59], v[120:123], v[32:35]
    v_mfma_f32_16x16x32_bf16 v[36:39], v[60:63], v[120:123], v[36:39]
    v_mfma_f32_16x16x32_bf16 v[40:43], v[56:59], v[176:179], v[40:43]
    v_mfma_f32_16x16x32_bf16 v[44:47], v[60:63], v[176:179], v[44:47]
    v_mfma_f32_16x16x32_bf16 v[48:51], v[56:59], v[232:235], v[48:51]
    v_mfma_f32_16x16x32_bf16 v[52:55], v[60:63], v[232:235], v[52:55]
    ds_read_b128 v[56:59], v105 offset:10240
    ds_read_b128 v[60:63], v105 offset:24576
    s_waitcnt lgkmcnt(2)
    v_mfma_f32_16x16x32_bf16 v[0:3], v[64:67], a[36:39], v[0:3]
    v_mfma_f32_16x16x32_bf16 v[4:7], v[68:71], a[36:39], v[4:7]
    v_mfma_f32_16x16x32_bf16 v[8:11], v[64:67], a[92:95], v[8:11]
    v_mfma_f32_16x16x32_bf16 v[12:15], v[68:71], a[92:95], v[12:15]
    v_mfma_f32_16x16x32_bf16 v[16:19], v[64:67], a[148:151], v[16:19]
    v_mfma_f32_16x16x32_bf16 v[20:23], v[68:71], a[148:151], v[20:23]
    v_mfma_f32_16x16x32_bf16 v[24:27], v[64:67], a[204:207], v[24:27]
    v_mfma_f32_16x16x32_bf16 v[28:31], v[68:71], a[204:207], v[28:31]
    v_mfma_f32_16x16x32_bf16 v[32:35], v[64:67], v[124:127], v[32:35]
    v_mfma_f32_16x16x32_bf16 v[36:39], v[68:71], v[124:127], v[36:39]
    v_mfma_f32_16x16x32_bf16 v[40:43], v[64:67], v[180:183], v[40:43]
    v_mfma_f32_16x16x32_bf16 v[44:47], v[68:71], v[180:183], v[44:47]
    v_mfma_f32_16x16x32_bf16 v[48:51], v[64:67], v[236:239], v[48:51]
    v_mfma_f32_16x16x32_bf16 v[52:55], v[68:71], v[236:239], v[52:55]
    ds_read_b128 v[64:67], v105 offset:11264
    ds_read_b128 v[68:71], v105 offset:25600
    s_waitcnt lgkmcnt(2)
    s_waitcnt vmcnt(14)
    v_mfma_f32_16x16x32_bf16 v[0:3], v[56:59], a[40:43], v[0:3]
    v_mfma_f32_16x16x32_bf16 v[4:7], v[60:63], a[40:43], v[4:7]
    v_mfma_f32_16x16x32_bf16 v[8:11], v[56:59], a[96:99], v[8:11]
    v_mfma_f32_16x16x32_bf16 v[12:15], v[60:63], a[96:99], v[12:15]
    v_mfma_f32_16x16x32_bf16 v[16:19], v[56:59], a[152:155], v[16:19]
    v_mfma_f32_16x16x32_bf16 v[20:23], v[60:63], a[152:155], v[20:23]
    v_mfma_f32_16x16x32_bf16 v[24:27], v[56:59], a[208:211], v[24:27]
    v_mfma_f32_16x16x32_bf16 v[28:31], v[60:63], a[208:211], v[28:31]
    v_mfma_f32_16x16x32_bf16 v[32:35], v[56:59], v[128:131], v[32:35]
    v_mfma_f32_16x16x32_bf16 v[36:39], v[60:63], v[128:131], v[36:39]
    v_mfma_f32_16x16x32_bf16 v[40:43], v[56:59], v[184:187], v[40:43]
    v_mfma_f32_16x16x32_bf16 v[44:47], v[60:63], v[184:187], v[44:47]
    v_mfma_f32_16x16x32_bf16 v[48:51], v[56:59], v[240:243], v[48:51]
    v_mfma_f32_16x16x32_bf16 v[52:55], v[60:63], v[240:243], v[52:55]
    ds_read_b128 v[56:59], v105 offset:12288
    ds_read_b128 v[60:63], v105 offset:26624
    s_waitcnt lgkmcnt(2)
    v_mfma_f32_16x16x32_bf16 v[0:3], v[64:67], a[44:47], v[0:3]
    v_mfma_f32_16x16x32_bf16 v[4:7], v[68:71], a[44:47], v[4:7]
    v_mfma_f32_16x16x32_bf16 v[8:11], v[64:67], a[100:103], v[8:11]
    v_mfma_f32_16x16x32_bf16 v[12:15], v[68:71], a[100:103], v[12:15]
    v_mfma_f32_16x16x32_bf16 v[16:19], v[64:67], a[156:159], v[16:19]
    v_mfma_f32_16x16x32_bf16 v[20:23], v[68:71], a[156:159], v[20:23]
    v_mfma_f32_16x16x32_bf16 v[24:27], v[64:67], a[212:215], v[24:27]
    v_mfma_f32_16x16x32_bf16 v[28:31], v[68:71], a[212:215], v[28:31]
    v_mfma_f32_16x16x32_bf16 v[32:35], v[64:67], v[132:135], v[32:35]
    v_mfma_f32_16x16x32_bf16 v[36:39], v[68:71], v[132:135], v[36:39]
    v_mfma_f32_16x16x32_bf16 v[40:43], v[64:67], v[188:191], v[40:43]
    v_mfma_f32_16x16x32_bf16 v[44:47], v[68:71], v[188:191], v[44:47]
    v_mfma_f32_16x16x32_bf16 v[48:51], v[64:67], v[244:247], v[48:51]
    v_mfma_f32_16x16x32_bf16 v[52:55], v[68:71], v[244:247], v[52:55]
    ds_read_b128 v[64:67], v105 offset:13312
    ds_read_b128 v[68:71], v105 offset:27648
    s_waitcnt lgkmcnt(2)
    s_waitcnt vmcnt(0)
    v_mfma_f32_16x16x32_bf16 v[0:3], v[56:59], a[48:51], v[0:3]
    v_mfma_f32_16x16x32_bf16 v[4:7], v[60:63], a[48:51], v[4:7]
    v_mfma_f32_16x16x32_bf16 v[8:11], v[56:59], a[104:107], v[8:11]
    v_mfma_f32_16x16x32_bf16 v[12:15], v[60:63], a[104:107], v[12:15]
    v_mfma_f32_16x16x32_bf16 v[16:19], v[56:59], a[160:163], v[16:19]
    v_mfma_f32_16x16x32_bf16 v[20:23], v[60:63], a[160:163], v[20:23]
    v_mfma_f32_16x16x32_bf16 v[24:27], v[56:59], a[216:219], v[24:27]
    v_mfma_f32_16x16x32_bf16 v[28:31], v[60:63], a[216:219], v[28:31]
    v_mfma_f32_16x16x32_bf16 v[32:35], v[56:59], v[136:139], v[32:35]
    v_mfma_f32_16x16x32_bf16 v[36:39], v[60:63], v[136:139], v[36:39]
    v_mfma_f32_16x16x32_bf16 v[40:43], v[56:59], v[192:195], v[40:43]
    v_mfma_f32_16x16x32_bf16 v[44:47], v[60:63], v[192:195], v[44:47]
    v_mfma_f32_16x16x32_bf16 v[48:51], v[56:59], v[248:251], v[48:51]
    v_mfma_f32_16x16x32_bf16 v[52:55], v[60:63], v[248:251], v[52:55]
    s_waitcnt lgkmcnt(0)
    v_mfma_f32_16x16x32_bf16 v[0:3], v[64:67], a[52:55], v[0:3]
    v_mfma_f32_16x16x32_bf16 v[4:7], v[68:71], a[52:55], v[4:7]
    v_mfma_f32_16x16x32_bf16 v[8:11], v[64:67], a[108:111], v[8:11]
    v_mfma_f32_16x16x32_bf16 v[12:15], v[68:71], a[108:111], v[12:15]
    v_mfma_f32_16x16x32_bf16 v[16:19], v[64:67], a[164:167], v[16:19]
    v_mfma_f32_16x16x32_bf16 v[20:23], v[68:71], a[164:167], v[20:23]
    v_mfma_f32_16x16x32_bf16 v[24:27], v[64:67], a[220:223], v[24:27]
    v_mfma_f32_16x16x32_bf16 v[28:31], v[68:71], a[220:223], v[28:31]
    v_mfma_f32_16x16x32_bf16 v[32:35], v[64:67], v[140:143], v[32:35]
    v_mfma_f32_16x16x32_bf16 v[36:39], v[68:71], v[140:143], v[36:39]
    v_mfma_f32_16x16x32_bf16 v[40:43], v[64:67], v[196:199], v[40:43]
    v_mfma_f32_16x16x32_bf16 v[44:47], v[68:71], v[196:199], v[44:47]
    v_mfma_f32_16x16x32_bf16 v[48:51], v[64:67], v[252:255], v[48:51]
    v_mfma_f32_16x16x32_bf16 v[52:55], v[68:71], v[252:255], v[52:55]
    s_mov_b32 m0, s28
    s_add_u32 s63, s27, 4096
    buffer_load_dwordx4 v104, s[4:7], s27 offen offset:0 lds
    buffer_load_dwordx4 v104, s[4:7], s27 offen offset:1024 lds
    buffer_load_dwordx4 v104, s[4:7], s27 offen offset:2048 lds
    buffer_load_dwordx4 v104, s[4:7], s27 offen offset:3072 lds
    s_add_u32 m0, s28, 4096
    s_nop 0
    buffer_load_dwordx4 v104, s[4:7], s63 offen offset:0 lds
    buffer_load_dwordx4 v104, s[4:7], s63 offen offset:1024 lds
    buffer_load_dwordx4 v104, s[4:7], s63 offen offset:2048 lds
    s_branch RU_epi
RU_top:
    s_waitcnt vmcnt(0)
    s_barrier
    s_cmp_lg_u32 s20, 0
    s_cbranch_scc1 RU_nf
    v_mov_b32 v56, 1
    s_mov_b64 exec, 1
    buffer_store_byte v56, off, s[4:7], s31 sc1
    s_mov_b64 exec, -1
RU_nf:
    s_cmp_ge_u32 s24, 64
    s_cbranch_scc1 RV_role
    s_add_u32 s27, s27, 114688
    s_xor_b32 s28, s28, 32768
    s_cmp_ge_u32 s24, 60
    s_cbranch_scc1 RU_nd
    s_mov_b32 m0, s28
    s_add_u32 s63, s27, 4096
    buffer_load_dwordx4 v104, s[4:7], s27 offen offset:0 lds
    buffer_load_dwordx4 v104, s[4:7], s27 offen offset:1024 lds
    buffer_load_dwordx4 v104, s[4:7], s27 offen offset:2048 lds
    buffer_load_dwordx4 v104, s[4:7], s27 offen offset:3072 lds
    s_add_u32 m0, s28, 4096
    s_nop 0
    buffer_load_dwordx4 v104, s[4:7], s63 offen offset:0 lds
    buffer_load_dwordx4 v104, s[4:7], s63 offen offset:1024 lds
    buffer_load_dwordx4 v104, s[4:7], s63 offen offset:2048 lds
RU_nd:
    ds_read_b128 v[56:59], v105 offset:0
    ds_read_b128 v[60:63], v105 offset:14336
    ds_read_b128 v[64:67], v105 offset:1024
    ds_read_b128 v[68:71], v105 offset:15360
    s_waitcnt lgkmcnt(2)
    v_mfma_f32_16x16x32_bf16 v[0:3], v[56:59], a[0:3], 0
    v_mfma_f32_16x16x32_bf16 v[4:7], v[60:63], a[0:3], 0
    v_mfma_f32_16x16x32_bf16 v[8:11], v[56:59], a[56:59], 0
    v_mfma_f32_16x16x32_bf16 v[12:15], v[60:63], a[56:59], 0
    v_mfma_f32_16x16x32_bf16 v[16:19], v[56:59], a[112:115], 0
    v_mfma_f32_16x16x32_bf16 v[20:23], v[60:63], a[112:115], 0
    v_mfma_f32_16x16x32_bf16 v[24:27], v[56:59], a[168:171], 0
    v_mfma_f32_16x16x32_bf16 v[28:31], v[60:63], a[168:171], 0
    v_mfma_f32_16x16x32_bf16 v[32:35], v[56:59], a[224:227], 0
    v_mfma_f32_16x16x32_bf16 v[36:39], v[60:63], a[224:227], 0
    v_mfma_f32_16x16x32_bf16 v[40:43], v[56:59], v[144:147], 0
    v_mfma_f32_16x16x32_bf16 v[44:47], v[60:63], v[144:147], 0
    v_mfma_f32_16x16x32_bf16 v[48:51], v[56:59], v[200:203], 0
    v_mfma_f32_16x16x32_bf16 v[52:55], v[60:63], v[200:203], 0
    ds_read_b128 v[56:59], v105 offset:2048
    ds_read_b128 v[60:63], v105 offset:16384
    s_waitcnt lgkmcnt(2)
    v_mfma_f32_16x16x32_bf16 v[0:3], v[64:67], a[4:7], v[0:3]
    v_mfma_f32_16x16x32_bf16 v[4:7], v[68:71], a[4:7], v[4:7]
    v_mfma_f32_16x16x32_bf16 v[8:11], v[64:67], a[60:63], v[8:11]
    v_mfma_f32_16x16x32_bf16 v[12:15], v[68:71], a[60:63], v[12:15]
    v_mfma_f32_16x16x32_bf16 v[16:19], v[64:67], a[116:119], v[16:19]
    v_mfma_f32_16x16x32_bf16 v[20:23], v[68:71], a[116:119], v[20:23]
    v_mfma_f32_16x16x32_bf16 v[24:27], v[64:67], a[172:175], v[24:27]
    v_mfma_f32_16x16x32_bf16 v[28:31], v[68:71], a[172:175], v[28:31]
    v_mfma_f32_16x16x32_bf16 v[32:35], v[64:67], a[228:231], v[32:35]
    v_mfma_f32_16x16x32_bf16 v[36:39], v[68:71], a[228:231], v[36:39]
    v_mfma_f32_16x16x32_bf16 v[40:43], v[64:67], v[148:151], v[40:43]
    v_mfma_f32_16x16x32_bf16 v[44:47], v[68:71], v[148:151], v[44:47]
    v_mfma_f32_16x16x32_bf16 v[48:51], v[64:67], v[204:207], v[48:51]
    v_mfma_f32_16x16x32_bf16 v[52:55], v[68:71], v[204:207], v[52:55]
    ds_read_b128 v[64:67], v105 offset:3072
    ds_read_b128 v[68:71], v105 offset:17408
    s_waitcnt lgkmcnt(2)
    v_mfma_f32_16x16x32_bf16 v[0:3], v[56:59], a[8:11], v[0:3]
    v_mfma_f32_16x16x32_bf16 v[4:7], v[60:63], a[8:11], v[4:7]
    v_mfma_f32_16x16x32_bf16 v[8:11], v[56:59], a[64:67], v[8:11]
    v_mfma_f32_16x16x32_bf16 v[12:15], v[60:63], a[64:67], v[12:15]
    v_mfma_f32_16x16x32_bf16 v[16:19], v[56:59], a[120:123], v[16:19]
    v_mfma_f32_16x16x32_bf16 v[20:23], v[60:63], a[120:123], v[20:23]
    v_mfma_f32_16x16x32_bf16 v[24:27], v[56:59], a[176:179], v[24:27]
    v_mfma_f32_16x16x32_bf16 v[28:31], v[60:63], a[176:179], v[28:31]
    v_mfma_f32_16x16x32_bf16 v[32:35], v[56:59], a[232:235], v[32:35]
    v_mfma_f32_16x16x32_bf16 v[36:39], v[60:63], a[232:235], v[36:39]
    v_mfma_f32_16x16x32_bf16 v[40:43], v[56:59], v[152:155], v[40:43]
    v_mfma_f32_16x16x32_bf16 v[44:47], v[60:63], v[152:155], v[44:47]
    v_mfma_f32_16x16x32_bf16 v[48:51], v[56:59], v[208:211], v[48:51]
    v_mfma_f32_16x16x32_bf16 v[52:55], v[60:63], v[208:211], v[52:55]
    ds_read_b128 v[56:59], v105 offset:4096
    ds_read_b128 v[60:63], v105 offset:18432
    s_waitcnt lgkmcnt(2)
    v_mfma_f32_16x16x32_bf16 v[0:3], v[64:67], a[12:15], v[0:3]
    v_mfma_f32_16x16x32_bf16 v[4:7], v[68:71], a[12:15], v[4:7]
    v_mfma_f32_16x16x32_bf16 v[8:11], v[64:67], a[68:71], v[8:11]
    v_mfma_f32_16x16x32_bf16 v[12:15], v[68:71], a[68:71], v[12:15]
    v_mfma_f32_16x16x32_bf16 v[16:19], v[64:67], a[124:127], v[16:19]
    v_mfma_f32_16x16x32_bf16 v[20:23], v[68:71], a[124:127], v[20:23]
    v_mfma_f32_16x16x32_bf16 v[24:27], v[64:67], a[180:183], v[24:27]
    v_mfma_f32_16x16x32_bf16 v[28:31], v[68:71], a[180:183], v[28:31]
    v_mfma_f32_16x16x32_bf16 v[32:35], v[64:67], a[236:239], v[32:35]
    v_mfma_f32_16x16x32_bf16 v[36:39], v[68:71], a[236:239], v[36:39]
    v_mfma_f32_16x16x32_bf16 v[40:43], v[64:67], v[156:159], v[40:43]
    v_mfma_f32_16x16x32_bf16 v[44:47], v[68:71], v[156:159], v[44:47]
    v_mfma_f32_16x16x32_bf16 v[48:51], v[64:67], v[212:215], v[48:51]
    v_mfma_f32_16x16x32_bf16 v[52:55], v[68:71], v[212:215], v[52:55]
    ds_read_b128 v[64:67], v105 offset:5120
    ds_read_b128 v[68:71], v105 offset:19456
    s_waitcnt lgkmcnt(2)
    v_mfma_f32_16x16x32_bf16 v[0:3], v[56:59], a[16:19], v[0:3]
    v_mfma_f32_16x16x32_bf16 v[4:7], v[60:63], a[16:19], v[4:7]
    v_mfma_f32_16x16x32_bf16 v[8:11], v[56:59], a[72:75], v[8:11]
    v_mfma_f32_16x16x32_bf16 v[12:15], v[60:63], a[72:75], v[12:15]
    v_mfma_f32_16x16x32_bf16 v[16:19], v[56:59], a[128:131], v[16:19]
    v_mfma_f32_16x16x32_bf16 v[20:23], v[60:63], a[128:131], v[20:23]
    v_mfma_f32_16x16x32_bf16 v[24:27], v[56:59], a[184:187], v[24:27]
    v_mfma_f32_16x16x32_bf16 v[28:31], v[60:63], a[184:187], v[28:31]
    v_mfma_f32_16x16x32_bf16 v[32:35], v[56:59], a[240:243], v[32:35]
    v_mfma_f32_16x16x32_bf16 v[36:39], v[60:63], a[240:243], v[36:39]
    v_mfma_f32_16x16x32_bf16 v[40:43], v[56:59], v[160:163], v[40:43]
    v_mfma_f32_16x16x32_bf16 v[44:47], v[60:63], v[160:163], v[44:47]
    v_mfma_f32_16x16x32_bf16 v[48:51], v[56:59], v[216:219], v[48:51]
    v_mfma_f32_16x16x32_bf16 v[52:55], v[60:63], v[216:219], v[52:55]
    ds_read_b128 v[56:59], v105 offset:6144
    ds_read_b128 v[60:63], v105 offset:20480
    s_waitcnt lgkmcnt(2)
    v_mfma_f32_16x16x32_bf16 v[0:3], v[64:67], a[20:23], v[0:3]
    v_mfma_f32_16x16x32_bf16 v[4:7], v[68:71], a[20:23], v[4:7]
    v_mfma_f32_16x16x32_bf16 v[8:11], v[64:67], a[76:79], v[8:11]
    v_mfma_f32_16x16x32_bf16 v[12:15], v[68:71], a[76:79], v[12:15]
    v_mfma_f32_16x16x32_bf16 v[16:19], v[64:67], a[132:135], v[16:19]
    v_mfma_f32_16x16x32_bf16 v[20:23], v[68:71], a[132:135], v[20:23]
    v_mfma_f32_16x16x32_bf16 v[24:27], v[64:67], a[188:191], v[24:27]
    v_mfma_f32_16x16x32_bf16 v[28:31], v[68:71], a[188:191], v[28:31]
    v_mfma_f32_16x16x32_bf16 v[32:35], v[64:67], a[244:247], v[32:35]
    v_mfma_f32_16x16x32_bf16 v[36:39], v[68:71], a[244:247], v[36:39]
    v_mfma_f32_16x16x32_bf16 v[40:43], v[64:67], v[164:167], v[40:43]
    v_mfma_f32_16x16x32_bf16 v[44:47], v[68:71], v[164:167], v[44:47]
    v_mfma_f32_16x16x32_bf16 v[48:51], v[64:67], v[220:223], v[48:51]
    v_mfma_f32_16x16x32_bf16 v[52:55], v[68:71], v[220:223], v[52:55]
    ds_read_b128 v[64:67], v105 offset:7168
    ds_read_b128 v[68:71], v105 offset:21504
    s_waitcnt lgkmcnt(2)
    v_mfma_f32_16x16x32_bf16 v[0:3], v[56:59], a[24:27], v[0:3]
    v_mfma_f32_16x16x32_bf16 v[4:7], v[60:63], a[24:27], v[4:7]
    v_mfma_f32_16x16x32_bf16 v[8:11], v[56:59], a[80:83], v[8:11]
    v_mfma_f32_16x16x32_bf16 v[12:15], v[60:63], a[80:83], v[12:15]
    v_mfma_f32_16x16x32_bf16 v[16:19], v[56:59], a[136:139], v[16:19]
    v_mfma_f32_16x16x32_bf16 v[20:23], v[60:63], a[136:139], v[20:23]
    v_mfma_f32_16x16x32_bf16 v[24:27], v[56:59], a[192:195], v[24:27]
    v_mfma_f32_16x16x32_bf16 v[28:31], v[60:63], a[192:195], v[28:31]
    v_mfma_f32_16x16x32_bf16 v[32:35], v[56:59], a[248:251], v[32:35]
    v_mfma_f32_16x16x32_bf16 v[36:39], v[60:63], a[248:251], v[36:39]
    v_mfma_f32_16x16x32_bf16 v[40:43], v[56:59], v[168:171], v[40:43]
    v_mfma_f32_16x16x32_bf16 v[44:47], v[60:63], v[168:171], v[44:47]
    v_mfma_f32_16x16x32_bf16 v[48:51], v[56:59], v[224:227], v[48:51]
    v_mfma_f32_16x16x32_bf16 v[52:55], v[60:63], v[224:227], v[52:55]
    ds_read_b128 v[56:59], v105 offset:8192
    ds_read_b128 v[60:63], v105 offset:22528
    s_waitcnt lgkmcnt(2)
    v_mfma_f32_16x16x32_bf16 v[0:3], v[64:67], a[28:31], v[0:3]
    v_mfma_f32_16x16x32_bf16 v[4:7], v[68:71], a[28:31], v[4:7]
    v_mfma_f32_16x16x32_bf16 v[8:11], v[64:67], a[84:87], v[8:11]
    v_mfma_f32_16x16x32_bf16 v[12:15], v[68:71], a[84:87], v[12:15]
    v_mfma_f32_16x16x32_bf16 v[16:19], v[64:67], a[140:143], v[16:19]
    v_mfma_f32_16x16x32_bf16 v[20:23], v[68:71], a[140:143], v[20:23]
    v_mfma_f32_16x16x32_bf16 v[24:27], v[64:67], a[196:199], v[24:27]
    v_mfma_f32_16x16x32_bf16 v[28:31], v[68:71], a[196:199], v[28:31]
    v_mfma_f32_16x16x32_bf16 v[32:35], v[64:67], a[252:255], v[32:35]
    v_mfma_f32_16x16x32_bf16 v[36:39], v[68:71], a[252:255], v[36:39]
    v_mfma_f32_16x16x32_bf16 v[40:43], v[64:67], v[172:175], v[40:43]
    v_mfma_f32_16x16x32_bf16 v[44:47], v[68:71], v[172:175], v[44:47]
    v_mfma_f32_16x16x32_bf16 v[48:51], v[64:67], v[228:231], v[48:51]
    v_mfma_f32_16x16x32_bf16 v[52:55], v[68:71], v[228:231], v[52:55]
    ds_read_b128 v[64:67], v105 offset:9216
    ds_read_b128 v[68:71], v105 offset:23552
    s_waitcnt lgkmcnt(2)
    v_mfma_f32_16x16x32_bf16 v[0:3], v[56:59], a[32:35], v[0:3]
    v_mfma_f32_16x16x32_bf16 v[4:7], v[60:63], a[32:35], v[4:7]
    v_mfma_f32_16x16x32_bf16 v[8:11], v[56:59], a[88:91], v[8:11]
    v_mfma_f32_16x16x32_bf16 v[12:15], v[60:63], a[88:91], v[12:15]
    v_mfma_f32_16x16x32_bf16 v[16:19], v[56:59], a[144:147], v[16:19]
    v_mfma_f32_16x16x32_bf16 v[20:23], v[60:63], a[144:147], v[20:23]
    v_mfma_f32_16x16x32_bf16 v[24:27], v[56:59], a[200:203], v[24:27]
    v_mfma_f32_16x16x32_bf16 v[28:31], v[60:63], a[200:203], v[28:31]
    v_mfma_f32_16x16x32_bf16 v[32:35], v[56:59], v[120:123], v[32:35]
    v_mfma_f32_16x16x32_bf16 v[36:39], v[60:63], v[120:123], v[36:39]
    v_mfma_f32_16x16x32_bf16 v[40:43], v[56:59], v[176:179], v[40:43]
    v_mfma_f32_16x16x32_bf16 v[44:47], v[60:63], v[176:179], v[44:47]
    v_mfma_f32_16x16x32_bf16 v[48:51], v[56:59], v[232:235], v[48:51]
    v_mfma_f32_16x16x32_bf16 v[52:55], v[60:63], v[232:235], v[52:55]
    ds_read_b128 v[56:59], v105 offset:10240
    ds_read_b128 v[60:63], v105 offset:24576
    s_waitcnt lgkmcnt(2)
    v_mfma_f32_16x16x32_bf16 v[0:3], v[64:67], a[36:39], v[0:3]
    v_mfma_f32_16x16x32_bf16 v[4:7], v[68:71], a[36:39], v[4:7]
    v_mfma_f32_16x16x32_bf16 v[8:11], v[64:67], a[92:95], v[8:11]
    v_mfma_f32_16x16x32_bf16 v[12:15], v[68:71], a[92:95], v[12:15]
    v_mfma_f32_16x16x32_bf16 v[16:19], v[64:67], a[148:151], v[16:19]
    v_mfma_f32_16x16x32_bf16 v[20:23], v[68:71], a[148:151], v[20:23]
    v_mfma_f32_16x16x32_bf16 v[24:27], v[64:67], a[204:207], v[24:27]
    v_mfma_f32_16x16x32_bf16 v[28:31], v[68:71], a[204:207], v[28:31]
    v_mfma_f32_16x16x32_bf16 v[32:35], v[64:67], v[124:127], v[32:35]
    v_mfma_f32_16x16x32_bf16 v[36:39], v[68:71], v[124:127], v[36:39]
    v_mfma_f32_16x16x32_bf16 v[40:43], v[64:67], v[180:183], v[40:43]
    v_mfma_f32_16x16x32_bf16 v[44:47], v[68:71], v[180:183], v[44:47]
    v_mfma_f32_16x16x32_bf16 v[48:51], v[64:67], v[236:239], v[48:51]
    v_mfma_f32_16x16x32_bf16 v[52:55], v[68:71], v[236:239], v[52:55]
    ds_read_b128 v[64:67], v105 offset:11264
    ds_read_b128 v[68:71], v105 offset:25600
    s_waitcnt lgkmcnt(2)
    v_mfma_f32_16x16x32_bf16 v[0:3], v[56:59], a[40:43], v[0:3]
    v_mfma_f32_16x16x32_bf16 v[4:7], v[60:63], a[40:43], v[4:7]
    v_mfma_f32_16x16x32_bf16 v[8:11], v[56:59], a[96:99], v[8:11]
    v_mfma_f32_16x16x32_bf16 v[12:15], v[60:63], a[96:99], v[12:15]
    v_mfma_f32_16x16x32_bf16 v[16:19], v[56:59], a[152:155], v[16:19]
    v_mfma_f32_16x16x32_bf16 v[20:23], v[60:63], a[152:155], v[20:23]
    v_mfma_f32_16x16x32_bf16 v[24:27], v[56:59], a[208:211], v[24:27]
    v_mfma_f32_16x16x32_bf16 v[28:31], v[60:63], a[208:211], v[28:31]
    v_mfma_f32_16x16x32_bf16 v[32:35], v[56:59], v[128:131], v[32:35]
    v_mfma_f32_16x16x32_bf16 v[36:39], v[60:63], v[128:131], v[36:39]
    v_mfma_f32_16x16x32_bf16 v[40:43], v[56:59], v[184:187], v[40:43]
    v_mfma_f32_16x16x32_bf16 v[44:47], v[60:63], v[184:187], v[44:47]
    v_mfma_f32_16x16x32_bf16 v[48:51], v[56:59], v[240:243], v[48:51]
    v_mfma_f32_16x16x32_bf16 v[52:55], v[60:63], v[240:243], v[52:55]
    ds_read_b128 v[56:59], v105 offset:12288
    ds_read_b128 v[60:63], v105 offset:26624
    s_waitcnt lgkmcnt(2)
    v_mfma_f32_16x16x32_bf16 v[0:3], v[64:67], a[44:47], v[0:3]
    v_mfma_f32_16x16x32_bf16 v[4:7], v[68:71], a[44:47], v[4:7]
    v_mfma_f32_16x16x32_bf16 v[8:11], v[64:67], a[100:103], v[8:11]
    v_mfma_f32_16x16x32_bf16 v[12:15], v[68:71], a[100:103], v[12:15]
    v_mfma_f32_16x16x32_bf16 v[16:19], v[64:67], a[156:159], v[16:19]
    v_mfma_f32_16x16x32_bf16 v[20:23], v[68:71], a[156:159], v[20:23]
    v_mfma_f32_16x16x32_bf16 v[24:27], v[64:67], a[212:215], v[24:27]
    v_mfma_f32_16x16x32_bf16 v[28:31], v[68:71], a[212:215], v[28:31]
    v_mfma_f32_16x16x32_bf16 v[32:35], v[64:67], v[132:135], v[32:35]
    v_mfma_f32_16x16x32_bf16 v[36:39], v[68:71], v[132:135], v[36:39]
    v_mfma_f32_16x16x32_bf16 v[40:43], v[64:67], v[188:191], v[40:43]
    v_mfma_f32_16x16x32_bf16 v[44:47], v[68:71], v[188:191], v[44:47]
    v_mfma_f32_16x16x32_bf16 v[48:51], v[64:67], v[244:247], v[48:51]
    v_mfma_f32_16x16x32_bf16 v[52:55], v[68:71], v[244:247], v[52:55]
    ds_read_b128 v[64:67], v105 offset:13312
    ds_read_b128 v[68:71], v105 offset:27648
    s_waitcnt lgkmcnt(2)
    v_mfma_f32_16x16x32_bf16 v[0:3], v[56:59], a[48:51], v[0:3]
    v_mfma_f32_16x16x32_bf16 v[4:7], v[60:63], a[48:51], v[4:7]
    v_mfma_f32_16x16x32_bf16 v[8:11], v[56:59], a[104:107], v[8:11]
    v_mfma_f32_16x16x32_bf16 v[12:15], v[60:63], a[104:107], v[12:15]
    v_mfma_f32_16x16x32_bf16 v[16:19], v[56:59], a[160:163], v[16:19]
    v_mfma_f32_16x16x32_bf16 v[20:23], v[60:63], a[160:163], v[20:23]
    v_mfma_f32_16x16x32_bf16 v[24:27], v[56:59], a[216:219], v[24:27]
    v_mfma_f32_16x16x32_bf16 v[28:31], v[60:63], a[216:219], v[28:31]
    v_mfma_f32_16x16x32_bf16 v[32:35], v[56:59], v[136:139], v[32:35]
    v_mfma_f32_16x16x32_bf16 v[36:39], v[60:63], v[136:139], v[36:39]
    v_mfma_f32_16x16x32_bf16 v[40:43], v[56:59], v[192:195], v[40:43]
    v_mfma_f32_16x16x32_bf16 v[44:47], v[60:63], v[192:195], v[44:47]
    v_mfma_f32_16x16x32_bf16 v[48:51], v[56:59], v[248:251], v[48:51]
    v_mfma_f32_16x16x32_bf16 v[52:55], v[60:63], v[248:251], v[52:55]
    s_waitcnt lgkmcnt(0)
    v_mfma_f32_16x16x32_bf16 v[0:3], v[64:67], a[52:55], v[0:3]
    v_mfma_f32_16x16x32_bf16 v[4:7], v[68:71], a[52:55], v[4:7]
    v_mfma_f32_16x16x32_bf16 v[8:11], v[64:67], a[108:111], v[8:11]
    v_mfma_f32_16x16x32_bf16 v[12:15], v[68:71], a[108:111], v[12:15]
    v_mfma_f32_16x16x32_bf16 v[16:19], v[64:67], a[164:167], v[16:19]
    v_mfma_f32_16x16x32_bf16 v[20:23], v[68:71], a[164:167], v[20:23]
    v_mfma_f32_16x16x32_bf16 v[24:27], v[64:67], a[220:223], v[24:27]
    v_mfma_f32_16x16x32_bf16 v[28:31], v[68:71], a[220:223], v[28:31]
    v_mfma_f32_16x16x32_bf16 v[32:35], v[64:67], v[140:143], v[32:35]
    v_mfma_f32_16x16x32_bf16 v[36:39], v[68:71], v[140:143], v[36:39]
    v_mfma_f32_16x16x32_bf16 v[40:43], v[64:67], v[196:199], v[40:43]
    v_mfma_f32_16x16x32_bf16 v[44:47], v[68:71], v[196:199], v[44:47]
    v_mfma_f32_16x16x32_bf16 v[48:51], v[64:67], v[252:255], v[48:51]
    v_mfma_f32_16x16x32_bf16 v[52:55], v[68:71], v[252:255], v[52:55]
RU_epi:
    v_xor_b32 v105, 32768, v105
    s_nop 6
    s_add_u32 s32, s29, 4096
    v_cvt_pk_bf16_f32 v72, v0, v1
    v_cvt_pk_bf16_f32 v73, v2, v3
    v_cvt_pk_bf16_f32 v74, v4, v5
    v_cvt_pk_bf16_f32 v75, v6, v7
    buffer_store_dwordx4 v[72:75], v104, s[4:7], s29 offen offset:0 sc1
    v_cvt_pk_bf16_f32 v76, v8, v9
    v_cvt_pk_bf16_f32 v77, v10, v11
    v_cvt_pk_bf16_f32 v78, v12, v13
    v_cvt_pk_bf16_f32 v79, v14, v15
    buffer_store_dwordx4 v[76:79], v104, s[4:7], s29 offen offset:1024 sc1
    v_cvt_pk_bf16_f32 v80, v16, v17
    v_cvt_pk_bf16_f32 v81, v18, v19
    v_cvt_pk_bf16_f32 v82, v20, v21
    v_cvt_pk_bf16_f32 v83, v22, v23
    buffer_store_dwordx4 v[80:83], v104, s[4:7], s29 offen offset:2048 sc1
    v_cvt_pk_bf16_f32 v84, v24, v25
    v_cvt_pk_bf16_f32 v85, v26, v27
    v_cvt_pk_bf16_f32 v86, v28, v29
    v_cvt_pk_bf16_f32 v87, v30, v31
    buffer_store_dwordx4 v[84:87], v104, s[4:7], s29 offen offset:3072 sc1
    v_cvt_pk_bf16_f32 v88, v32, v33
    v_cvt_pk_bf16_f32 v89, v34, v35
    v_cvt_pk_bf16_f32 v90, v36, v37
    v_cvt_pk_bf16_f32 v91, v38, v39
    buffer_store_dwordx4 v[88:91], v104, s[4:7], s32 offen offset:0 sc1
    v_cvt_pk_bf16_f32 v92, v40, v41
    v_cvt_pk_bf16_f32 v93, v42, v43
    v_cvt_pk_bf16_f32 v94, v44, v45
    v_cvt_pk_bf16_f32 v95, v46, v47
    buffer_store_dwordx4 v[92:95], v104, s[4:7], s32 offen offset:1024 sc1
    v_cvt_pk_bf16_f32 v96, v48, v49
    v_cvt_pk_bf16_f32 v97, v50, v51
    v_cvt_pk_bf16_f32 v98, v52, v53
    v_cvt_pk_bf16_f32 v99, v54, v55
    buffer_store_dwordx4 v[96:99], v104, s[4:7], s32 offen offset:2048 sc1
    s_add_u32 s29, s29, 0x1c0000
    s_sub_u32 s32, s24, 4
    s_cmp_ge_u32 s32, 4
    s_cbranch_scc1 RU_nl
    v_lshrrev_b32 v8, 4, v104
    v_and_b32 v7, 63, v8
    v_lshlrev_b32 v7, 2, v7
L_Uf_145:
    s_sub_u32 s23, s23, 1
    s_cbranch_scc1 M_exit
    s_mov_b32 s63, 0x3fcc000
    buffer_load_dword v4, v7, s[4:7], s63 offen sc1
    buffer_load_dword v5, v7, s[4:7], s63 offen offset:256 sc1
    s_waitcnt vmcnt(0)
    v_min_u32 v4, v4, v5
    v_cmp_eq_u32 vcc, 0, v4
    s_cbranch_vccnz L_Uf_145
RU_nl:
    s_mov_b32 s31, s30
    s_add_u32 s30, s30, 64
    s_add_u32 s24, s24, 4
    s_branch RU_top
RV_role:
RV_top:
    v_mov_b32 v0, 0
    v_mov_b32 v1, 0
    v_mov_b32 v2, 0
    v_mov_b32 v3, 0
    v_mov_b32 v4, 0
    v_mov_b32 v5, 0
    v_mov_b32 v6, 0
    v_mov_b32 v7, 0
    v_mov_b32 v8, 0
    v_mov_b32 v9, 0
    v_mov_b32 v10, 0
    v_mov_b32 v11, 0
    v_mov_b32 v12, 0
    v_mov_b32 v13, 0
    v_mov_b32 v14, 0
    v_mov_b32 v15, 0
    v_mov_b32 v16, 0
    v_mov_b32 v17, 0
    v_mov_b32 v18, 0
    v_mov_b32 v19, 0
    v_mov_b32 v20, 0
    v_mov_b32 v21, 0
    v_mov_b32 v22, 0
    v_mov_b32 v23, 0
    v_mov_b32 v24, 0
    v_mov_b32 v25, 0
    v_mov_b32 v26, 0
    v_mov_b32 v27, 0
    s_add_u32 s51, s50, 4096
    s_add_u32 s54, s53, 4096
    s_cmp_lg_u32 s20, 0
    s_cbranch_scc1 L_gate_146
L_RVm0_147:
    s_sub_u32 s23, s23, 1
    s_cbranch_scc1 M_exit
    buffer_load_dword v109, off, s[4:7], s50 sc1
    s_waitcnt vmcnt(0)
    v_cmp_eq_u32 vcc, -1, v109
    s_cbranch_vccnz L_RVm0_147
L_gate_146:
    s_barrier
L_RVm1_148:
    s_sub_u32 s23, s23, 1
    s_cbranch_scc1 M_exit
    buffer_load_dwordx4 v[28:31], v104, s[4:7], s50 offen offset:0 sc1
    buffer_load_dwordx4 v[32:35], v104, s[4:7], s50 offen offset:1024 sc1
    buffer_load_dwordx4 v[36:39], v104, s[4:7], s50 offen offset:2048 sc1
    buffer_load_dwordx4 v[40:43], v104, s[4:7], s50 offen offset:3072 sc1
    buffer_load_dwordx4 v[44:47], v104, s[4:7], s51 offen offset:0 sc1
    buffer_load_dwordx4 v[48:51], v104, s[4:7], s51 offen offset:1024 sc1
    buffer_load_dwordx4 v[52:55], v104, s[4:7], s51 offen offset:2048 sc1
    s_waitcnt vmcnt(0)
    v_max3_u32 v109, v28, v29, v30
    v_max3_u32 v109, v109, v31, v32
    v_max3_u32 v109, v109, v33, v34
    v_max3_u32 v109, v109, v35, v36
    v_max3_u32 v109, v109, v37, v38
    v_max3_u32 v109, v109, v39, v40
    v_max3_u32 v109, v109, v41, v42
    v_max3_u32 v109, v109, v43, v44
    v_max3_u32 v109, v109, v45, v46
    v_max3_u32 v109, v109, v47, v48
    v_max3_u32 v109, v109, v49, v50
    v_max3_u32 v109, v109, v51, v52
    v_max3_u32 v109, v109, v53, v54
    v_max_u32 v109, v109, v55
    v_cmp_eq_u32 vcc, -1, v109
    s_cbranch_vccnz L_RVm1_148
    v_smfmac_f32_16x16x64_bf16 v[0:3], v[28:31], a[0:7], v106
    v_smfmac_f32_16x16x64_bf16 v[0:3], v[32:35], a[8:15], v106
    v_smfmac_f32_16x16x64_bf16 v[0:3], v[36:39], a[16:23], v106
    v_smfmac_f32_16x16x64_bf16 v[0:3], v[40:43], a[24:31], v106
    v_smfmac_f32_16x16x64_bf16 v[0:3], v[44:47], a[32:39], v106
    v_smfmac_f32_16x16x64_bf16 v[0:3], v[48:51], a[40:47], v106
    v_smfmac_f32_16x16x64_bf16 v[0:3], v[52:55], a[48:55], v106
    v_smfmac_f32_16x16x64_bf16 v[4:7], v[28:31], a[56:63], v106
    v_smfmac_f32_16x16x64_bf16 v[4:7], v[32:35], a[64:71], v106
    v_smfmac_f32_16x16x64_bf16 v[4:7], v[36:39], a[72:79], v106
    v_smfmac_f32_16x16x64_bf16 v[4:7], v[40:43], a[80:87], v106
    v_smfmac_f32_16x16x64_bf16 v[4:7], v[44:47], a[88:95], v106
    v_smfmac_f32_16x16x64_bf16 v[4:7], v[48:51], a[96:103], v106
    v_smfmac_f32_16x16x64_bf16 v[4:7], v[52:55], a[104:111], v106
    v_smfmac_f32_16x16x64_bf16 v[8:11], v[28:31], a[112:119], v106
    v_smfmac_f32_16x16x64_bf16 v[8:11], v[32:35], a[120:127], v106
    v_smfmac_f32_16x16x64_bf16 v[8:11], v[36:39], a[128:135], v106
    v_permlane32_swap_b32 v0, v4
    v_permlane32_swap_b32 v1, v5
    v_permlane32_swap_b32 v2, v6
    v_permlane32_swap_b32 v3, v7
    v_add_f32 v0, v0, v4
    v_add_f32 v1, v1, v5
    v_add_f32 v2, v2, v6
    v_add_f32 v3, v3, v7
    v_cvt_pk_bf16_f32 v56, v0, v1
    v_cvt_pk_bf16_f32 v57, v2, v3
    v_min_u32 v56, -2, v56
    v_min_u32 v57, -2, v57
    buffer_store_dwordx2 v[56:57], v107, s[4:7], s53 offen offset:0 sc1
    v_smfmac_f32_16x16x64_bf16 v[8:11], v[40:43], a[136:143], v106
    v_smfmac_f32_16x16x64_bf16 v[8:11], v[44:47], a[144:151], v106
    v_smfmac_f32_16x16x64_bf16 v[8:11], v[48:51], a[152:159], v106
    v_smfmac_f32_16x16x64_bf16 v[8:11], v[52:55], a[160:167], v106
    v_smfmac_f32_16x16x64_bf16 v[12:15], v[28:31], a[168:175], v106
    v_smfmac_f32_16x16x64_bf16 v[12:15], v[32:35], a[176:183], v106
    v_smfmac_f32_16x16x64_bf16 v[12:15], v[36:39], a[184:191], v106
    v_smfmac_f32_16x16x64_bf16 v[12:15], v[40:43], a[192:199], v106
    v_smfmac_f32_16x16x64_bf16 v[12:15], v[44:47], a[200:207], v106
    v_smfmac_f32_16x16x64_bf16 v[12:15], v[48:51], a[208:215], v106
    v_smfmac_f32_16x16x64_bf16 v[12:15], v[52:55], a[216:223], v106
    v_smfmac_f32_16x16x64_bf16 v[16:19], v[28:31], a[224:231], v106
    v_smfmac_f32_16x16x64_bf16 v[16:19], v[32:35], a[232:239], v106
    v_smfmac_f32_16x16x64_bf16 v[16:19], v[36:39], a[240:247], v106
    v_permlane32_swap_b32 v8, v12
    v_permlane32_swap_b32 v9, v13
    v_permlane32_swap_b32 v10, v14
    v_permlane32_swap_b32 v11, v15
    v_add_f32 v8, v8, v12
    v_add_f32 v9, v9, v13
    v_add_f32 v10, v10, v14
    v_add_f32 v11, v11, v15
    v_cvt_pk_bf16_f32 v58, v8, v9
    v_cvt_pk_bf16_f32 v59, v10, v11
    v_min_u32 v58, -2, v58
    v_min_u32 v59, -2, v59
    buffer_store_dwordx2 v[58:59], v107, s[4:7], s53 offen offset:2048 sc1
    v_smfmac_f32_16x16x64_bf16 v[16:19], v[40:43], a[248:255], v106
    v_smfmac_f32_16x16x64_bf16 v[16:19], v[44:47], v[120:127], v106
    v_smfmac_f32_16x16x64_bf16 v[16:19], v[48:51], v[128:135], v106
    v_smfmac_f32_16x16x64_bf16 v[16:19], v[52:55], v[136:143], v106
    v_smfmac_f32_16x16x64_bf16 v[20:23], v[28:31], v[144:151], v106
    v_smfmac_f32_16x16x64_bf16 v[20:23], v[32:35], v[152:159], v106
    v_smfmac_f32_16x16x64_bf16 v[20:23], v[36:39], v[160:167], v106
    v_smfmac_f32_16x16x64_bf16 v[20:23], v[40:43], v[168:175], v106
    v_smfmac_f32_16x16x64_bf16 v[20:23], v[44:47], v[176:183], v106
    v_smfmac_f32_16x16x64_bf16 v[20:23], v[48:51], v[184:191], v106
    v_smfmac_f32_16x16x64_bf16 v[20:23], v[52:55], v[192:199], v106
    v_smfmac_f32_16x16x64_bf16 v[24:27], v[28:31], v[200:207], v106
    v_smfmac_f32_16x16x64_bf16 v[24:27], v[32:35], v[208:215], v106
    v_smfmac_f32_16x16x64_bf16 v[24:27], v[36:39], v[216:223], v106
    v_permlane32_swap_b32 v16, v20
    v_permlane32_swap_b32 v17, v21
    v_permlane32_swap_b32 v18, v22
    v_permlane32_swap_b32 v19, v23
    v_add_f32 v16, v16, v20
    v_add_f32 v17, v17, v21
    v_add_f32 v18, v18, v22
    v_add_f32 v19, v19, v23
    v_cvt_pk_bf16_f32 v60, v16, v17
    v_cvt_pk_bf16_f32 v61, v18, v19
    v_min_u32 v60, -2, v60
    v_min_u32 v61, -2, v61
    buffer_store_dwordx2 v[60:61], v107, s[4:7], s54 offen offset:0 sc1
    v_smfmac_f32_16x16x64_bf16 v[24:27], v[40:43], v[224:231], v106
    v_smfmac_f32_16x16x64_bf16 v[24:27], v[44:47], v[232:239], v106
    v_smfmac_f32_16x16x64_bf16 v[24:27], v[48:51], v[240:247], v106
    v_smfmac_f32_16x16x64_bf16 v[24:27], v[52:55], v[248:255], v106
    s_nop 7
    v_mov_b32 v64, v24
    v_mov_b32 v65, v25
    v_mov_b32 v66, v26
    v_mov_b32 v67, v27
    s_nop 0
    v_permlane32_swap_b32 v24, v64
    v_permlane32_swap_b32 v25, v65
    v_permlane32_swap_b32 v26, v66
    v_permlane32_swap_b32 v27, v67
    v_add_f32 v24, v24, v64
    v_add_f32 v25, v25, v65
    v_add_f32 v26, v26, v66
    v_add_f32 v27, v27, v67
    v_cvt_pk_bf16_f32 v62, v24, v25
    v_cvt_pk_bf16_f32 v63, v26, v27
    v_min_u32 v62, -2, v62
    v_min_u32 v63, -2, v63
    buffer_store_dwordx2 v[62:63], v108, s[4:7], s54 offen offset:2048 sc1
    s_waitcnt vmcnt(0)
    s_barrier
    s_cmp_lg_u32 s20, 0
    s_cbranch_scc1 L_RVnf_149
    s_mov_b64 exec, 1
    buffer_store_dword v106, off, s[4:7], s55 sc1
    s_mov_b64 exec, -1
L_RVnf_149:
    s_add_u32 s50, s50, 28672
    s_add_u32 s53, s53, 0x70000
    s_add_u32 s55, s55, 256
    s_add_u32 s52, s52, 4
    s_cmp_lt_u32 s52, 64
    s_cbranch_scc1 RV_top
    s_endpgm
RT_role:
    s_sub_u32 s22, s22, 64
    s_lshr_b32 s25, s22, 2
    s_and_b32 s24, s22, 3
    s_add_u32 s26, s25, 16
    s_mul_i32 s26, s26, 512
    s_add_u32 s26, s26, 0x3fc8000
    s_cmp_lg_u32 s20, 0
    s_cbranch_scc1 L_one_150
    v_and_b32 v3, 7, v1
    v_min_u32 v3, 6, v3
    v_bfe_u32 v4, v1, 3, 2
    v_mul_u32_u24 v4, 128, v4
    v_lshl_add_u32 v3, v3, 2, v4
L_Tw_151:
    s_sub_u32 s23, s23, 1
    s_cbranch_scc1 M_exit
    buffer_load_dword v4, v3, s[4:7], s26 offen sc1
    s_waitcnt vmcnt(0)
    v_cmp_gt_u32 vcc, 7, v4
    s_cbranch_vccnz L_Tw_151
L_one_150:
    s_barrier
    s_lshl_b32 s33, s25, 2
    s_add_u32 s33, s33, 0x1141000
    s_mul_i32 s26, s25, 0x62000
    s_mul_i32 s29, s20, 100352
    s_add_u32 s26, s26, s29
    s_add_u32 s26, s26, 0x0
    v_and_b32 v7, 63, v1
    v_lshlrev_b32 v7, 2, v7
    s_add_u32 s63, s26, 0x0
    buffer_load_dwordx4 a[0:3], v104, s[4:7], s63 offen
    buffer_load_dwordx4 a[4:7], v104, s[4:7], s63 offen offset:1024
    s_add_u32 s63, s26, 0x800
    buffer_load_dwordx4 a[8:11], v104, s[4:7], s63 offen
    buffer_load_dwordx4 a[12:15], v104, s[4:7], s63 offen offset:1024
    s_add_u32 s63, s26, 0x1000
    buffer_load_dwordx4 a[16:19], v104, s[4:7], s63 offen
    buffer_load_dwordx4 a[20:23], v104, s[4:7], s63 offen offset:1024
    s_add_u32 s63, s26, 0x1800
    buffer_load_dwordx4 a[24:27], v104, s[4:7], s63 offen
    buffer_load_dwordx4 a[28:31], v104, s[4:7], s63 offen offset:1024
    s_add_u32 s63, s26, 0x2000
    buffer_load_dwordx4 a[32:35], v104, s[4:7], s63 offen
    buffer_load_dwordx4 a[36:39], v104, s[4:7], s63 offen offset:1024
    s_add_u32 s63, s26, 0x2800
    buffer_load_dwordx4 a[40:43], v104, s[4:7], s63 offen
    buffer_load_dwordx4 a[44:47], v104, s[4:7], s63 offen offset:1024
    s_add_u32 s63, s26, 0x3000
    buffer_load_dwordx4 a[48:51], v104, s[4:7], s63 offen
    buffer_load_dwordx4 a[52:55], v104, s[4:7], s63 offen offset:1024
    s_add_u32 s63, s26, 0x3800
    buffer_load_dwordx4 a[56:59], v104, s[4:7], s63 offen
    buffer_load_dwordx4 a[60:63], v104, s[4:7], s63 offen offset:1024
    s_add_u32 s63, s26, 0x4000
    buffer_load_dwordx4 a[64:67], v104, s[4:7], s63 offen
    buffer_load_dwordx4 a[68:71], v104, s[4:7], s63 offen offset:1024
    s_add_u32 s63, s26, 0x4800
    buffer_load_dwordx4 a[72:75], v104, s[4:7], s63 offen
    buffer_load_dwordx4 a[76:79], v104, s[4:7], s63 offen offset:1024
    s_add_u32 s63, s26, 0x5000
    buffer_load_dwordx4 a[80:83], v104, s[4:7], s63 offen
    buffer_load_dwordx4 a[84:87], v104, s[4:7], s63 offen offset:1024
    s_add_u32 s63, s26, 0x5800
    buffer_load_dwordx4 a[88:91], v104, s[4:7], s63 offen
    buffer_load_dwordx4 a[92:95], v104, s[4:7], s63 offen offset:1024
    s_add_u32 s63, s26, 0x6000
    buffer_load_dwordx4 a[96:99], v104, s[4:7], s63 offen
    buffer_load_dwordx4 a[100:103], v104, s[4:7], s63 offen offset:1024
    s_add_u32 s63, s26, 0x6800
    buffer_load_dwordx4 a[104:107], v104, s[4:7], s63 offen
    buffer_load_dwordx4 a[108:111], v104, s[4:7], s63 offen offset:1024
    s_add_u32 s63, s26, 0x7000
    buffer_load_dwordx4 a[112:115], v104, s[4:7], s63 offen
    buffer_load_dwordx4 a[116:119], v104, s[4:7], s63 offen offset:1024
    s_add_u32 s63, s26, 0x7800
    buffer_load_dwordx4 a[120:123], v104, s[4:7], s63 offen
    buffer_load_dwordx4 a[124:127], v104, s[4:7], s63 offen offset:1024
    s_add_u32 s63, s26, 0x8000
    buffer_load_dwordx4 a[128:131], v104, s[4:7], s63 offen
    buffer_load_dwordx4 a[132:135], v104, s[4:7], s63 offen offset:1024
    s_add_u32 s63, s26, 0x8800
    buffer_load_dwordx4 a[136:139], v104, s[4:7], s63 offen
    buffer_load_dwordx4 a[140:143], v104, s[4:7], s63 offen offset:1024
    s_add_u32 s63, s26, 0x9000
    buffer_load_dwordx4 a[144:147], v104, s[4:7], s63 offen
    buffer_load_dwordx4 a[148:151], v104, s[4:7], s63 offen offset:1024
    s_add_u32 s63, s26, 0x9800
    buffer_load_dwordx4 a[152:155], v104, s[4:7], s63 offen
    buffer_load_dwordx4 a[156:159], v104, s[4:7], s63 offen offset:1024
    s_mov_b32 s63, 0x3fcc000
    buffer_load_dword v4, v7, s[4:7], s63 offen sc1
    buffer_load_dword v5, v7, s[4:7], s63 offen offset:256 sc1
    s_add_u32 s63, s26, 0xa000
    buffer_load_dwordx4 a[160:163], v104, s[4:7], s63 offen
    buffer_load_dwordx4 a[164:167], v104, s[4:7], s63 offen offset:1024
    s_add_u32 s63, s26, 0xa800
    buffer_load_dwordx4 a[168:171], v104, s[4:7], s63 offen
    buffer_load_dwordx4 a[172:175], v104, s[4:7], s63 offen offset:1024
    s_add_u32 s63, s26, 0xb000
    buffer_load_dwordx4 a[176:179], v104, s[4:7], s63 offen
    buffer_load_dwordx4 a[180:183], v104, s[4:7], s63 offen offset:1024
    s_add_u32 s63, s26, 0xb800
    buffer_load_dwordx4 a[184:187], v104, s[4:7], s63 offen
    buffer_load_dwordx4 a[188:191], v104, s[4:7], s63 offen offset:1024
    s_add_u32 s63, s26, 0xc000
    buffer_load_dwordx4 a[192:195], v104, s[4:7], s63 offen
    buffer_load_dwordx4 a[196:199], v104, s[4:7], s63 offen offset:1024
    s_add_u32 s63, s26, 0xc800
    buffer_load_dwordx4 a[200:203], v104, s[4:7], s63 offen
    buffer_load_dwordx4 a[204:207], v104, s[4:7], s63 offen offset:1024
    s_add_u32 s63, s26, 0xd000
    buffer_load_dwordx4 a[208:211], v104, s[4:7], s63 offen
    buffer_load_dwordx4 a[212:215], v104, s[4:7], s63 offen offset:1024
    s_add_u32 s63, s26, 0xd800
    buffer_load_dwordx4 a[216:219], v104, s[4:7], s63 offen
    buffer_load_dwordx4 a[220:223], v104, s[4:7], s63 offen offset:1024
    s_waitcnt vmcnt(48)
    s_add_u32 s63, s26, 0xe000
    buffer_load_dwordx4 a[224:227], v104, s[4:7], s63 offen
    buffer_load_dwordx4 a[228:231], v104, s[4:7], s63 offen offset:1024
    s_add_u32 s63, s26, 0xe800
    buffer_load_dwordx4 a[232:235], v104, s[4:7], s63 offen
    buffer_load_dwordx4 a[236:239], v104, s[4:7], s63 offen offset:1024
    s_add_u32 s63, s26, 0xf000
    buffer_load_dwordx4 a[240:243], v104, s[4:7], s63 offen
    buffer_load_dwordx4 a[244:247], v104, s[4:7], s63 offen offset:1024
    s_add_u32 s63, s26, 0xf800
    buffer_load_dwordx4 a[248:251], v104, s[4:7], s63 offen
    buffer_load_dwordx4 a[252:255], v104, s[4:7], s63 offen offset:1024
    s_waitcnt vmcnt(48)
    s_add_u32 s63, s26, 0x10000
    buffer_load_dwordx4 v[120:123], v104, s[4:7], s63 offen
    buffer_load_dwordx4 v[124:127], v104, s[4:7], s63 offen offset:1024
    s_add_u32 s63, s26, 0x10800
    buffer_load_dwordx4 v[128:131], v104, s[4:7], s63 offen
    buffer_load_dwordx4 v[132:135], v104, s[4:7], s63 offen offset:1024
    s_add_u32 s63, s26, 0x11000
    buffer_load_dwordx4 v[136:139], v104, s[4:7], s63 offen
    buffer_load_dwordx4 v[140:143], v104, s[4:7], s63 offen offset:1024
    s_add_u32 s63, s26, 0x11800
    buffer_load_dwordx4 v[144:147], v104, s[4:7], s63 offen
    buffer_load_dwordx4 v[148:151], v104, s[4:7], s63 offen offset:1024
    s_waitcnt vmcnt(48)
    s_add_u32 s63, s26, 0x12000
    buffer_load_dwordx4 v[152:155], v104, s[4:7], s63 offen
    buffer_load_dwordx4 v[156:159], v104, s[4:7], s63 offen offset:1024
    s_add_u32 s63, s26, 0x12800
    buffer_load_dwordx4 v[160:163], v104, s[4:7], s63 offen
    buffer_load_dwordx4 v[164:167], v104, s[4:7], s63 offen offset:1024
    s_add_u32 s63, s26, 0x13000
    buffer_load_dwordx4 v[168:171], v104, s[4:7], s63 offen
    buffer_load_dwordx4 v[172:175], v104, s[4:7], s63 offen offset:1024
    s_add_u32 s63, s26, 0x13800
    buffer_load_dwordx4 v[176:179], v104, s[4:7], s63 offen
    buffer_load_dwordx4 v[180:183], v104, s[4:7], s63 offen offset:1024
    s_waitcnt vmcnt(48)
    s_add_u32 s63, s26, 0x14000
    buffer_load_dwordx4 v[184:187], v104, s[4:7], s63 offen
    buffer_load_dwordx4 v[188:191], v104, s[4:7], s63 offen offset:1024
    s_add_u32 s63, s26, 0x14800
    buffer_load_dwordx4 v[192:195], v104, s[4:7], s63 offen
    buffer_load_dwordx4 v[196:199], v104, s[4:7], s63 offen offset:1024
    s_add_u32 s63, s26, 0x15000
    buffer_load_dwordx4 v[200:203], v104, s[4:7], s63 offen
    buffer_load_dwordx4 v[204:207], v104, s[4:7], s63 offen offset:1024
    s_add_u32 s63, s26, 0x15800
    buffer_load_dwordx4 v[208:211], v104, s[4:7], s63 offen
    buffer_load_dwordx4 v[212:215], v104, s[4:7], s63 offen offset:1024
    s_waitcnt vmcnt(48)
    s_add_u32 s63, s26, 0x16000
    buffer_load_dwordx4 v[216:219], v104, s[4:7], s63 offen
    buffer_load_dwordx4 v[220:223], v104, s[4:7], s63 offen offset:1024
    v_min_u32 v4, v4, v5
    v_cmp_eq_u32 vcc, 0, v4
    s_cbranch_vccz L_Tlok_152
    v_and_b32 v7, 63, v1
    v_lshlrev_b32 v7, 2, v7
L_Tl_153:
    s_sub_u32 s23, s23, 1
    s_cbranch_scc1 M_exit
    s_mov_b32 s63, 0x3fcc000
    buffer_load_dword v4, v7, s[4:7], s63 offen sc1
    buffer_load_dword v5, v7, s[4:7], s63 offen offset:256 sc1
    s_waitcnt vmcnt(0)
    v_min_u32 v4, v4, v5
    v_cmp_eq_u32 vcc, 0, v4
    s_cbranch_vccnz L_Tl_153
L_Tlok_152:
    s_mul_i32 s27, s24, 28672
    s_mul_i32 s28, s20, 7168
    s_add_u32 s27, s27, s28
    s_add_u32 s27, s27, 0xe00000
    s_mov_b32 m0, s28
    s_add_u32 s63, s27, 4096
    buffer_load_dwordx4 v104, s[4:7], s27 offen offset:0 lds
    buffer_load_dwordx4 v104, s[4:7], s27 offen offset:1024 lds
    buffer_load_dwordx4 v104, s[4:7], s27 offen offset:2048 lds
    buffer_load_dwordx4 v104, s[4:7], s27 offen offset:3072 lds
    s_add_u32 m0, s28, 4096
    s_nop 0
    buffer_load_dwordx4 v104, s[4:7], s63 offen offset:0 lds
    buffer_load_dwordx4 v104, s[4:7], s63 offen offset:1024 lds
    buffer_load_dwordx4 v104, s[4:7], s63 offen offset:2048 lds
    v_mov_b32 v105, v104
    s_lshl_b32 s30, s24, 6
    s_add_u32 s30, s30, s33
    s_mov_b32 s31, 0x1145000
    s_add_u32 s63, s26, 0x16800
    buffer_load_dwordx4 v[224:227], v104, s[4:7], s63 offen
    buffer_load_dwordx4 v[228:231], v104, s[4:7], s63 offen offset:1024
    s_add_u32 s63, s26, 0x17000
    buffer_load_dwordx4 v[232:235], v104, s[4:7], s63 offen
    buffer_load_dwordx4 v[236:239], v104, s[4:7], s63 offen offset:1024
    s_add_u32 s63, s26, 0x17800
    buffer_load_dwordx4 v[240:243], v104, s[4:7], s63 offen
    buffer_load_dwordx4 v[244:247], v104, s[4:7], s63 offen offset:1024
    s_add_u32 s63, s26, 0x18000
    buffer_load_dwordx4 v[248:251], v104, s[4:7], s63 offen
    buffer_load_dwordx4 v[252:255], v104, s[4:7], s63 offen offset:1024
    v_and_b32 v2, 15, v1
    v_lshrrev_b32 v3, 4, v1
    v_and_b32 v4, 7, v1
    v_lshrrev_b32 v5, 1, v3
    v_and_b32 v6, 1, v3
    v_lshlrev_b32 v6, 9, v6
    v_lshl_add_u32 v6, v5, 10, v6
    v_lshl_add_u32 v106, v2, 4, v6
    s_lshr_b32 s33, s20, 1
    v_lshlrev_b32 v5, 4, v4
    v_and_b32 v6, 1, v3
    v_lshl_add_u32 v6, v6, 9, v5
    v_lshrrev_b32 v7, 1, v3
    v_lshl_add_u32 v6, v7, 7, v6
    s_lshl_b32 s32, s20, 10
    v_add_u32 v109, s32, v6
    v_lshl_add_u32 v5, v3, 8, v5
    s_and_b32 s34, s20, 1
    s_lshl_b32 s32, s33, 10
    s_lshl_b32 s35, s34, 7
    s_add_u32 s32, s32, s35
    s_add_u32 s32, s32, 4096
    v_add_u32 v110, s32, v5
    s_lshl_b32 s32, s33, 7
    s_add_u32 s32, s32, 6144
    v_add_u32 v111, s32, v5
    s_sub_u32 s50, s34, 1
    s_not_b32 s51, s50
    s_lshl_b32 s32, s20, 4
    v_lshlrev_b32 v5, 2, v3
    v_sub_u32 v5, v2, v5
    v_add_u32 v113, s32, v5
    s_lshr_b32 s32, s25, 2
    s_lshl_b32 s32, s32, 1
    s_add_u32 s32, s32, s20
    s_lshl_b32 s32, s32, 10
    s_add_u32 s32, s32, 32768
    s_and_b32 s33, s25, 1
    s_lshl_b32 s33, s33, 9
    s_add_u32 s32, s32, s33
    s_bfe_u32 s33, s25, 0x10001
    s_lshl_b32 s33, s33, 3
    s_add_u32 s32, s32, s33
    v_add_u32 v5, s32, v104
    v_mov_b32 v6, 0x40000000
    v_cmp_gt_u32 s[52:53], 32, v1
    s_nop 1
    v_cndmask_b32 v112, v6, v5, s[52:53]
    s_mul_i32 s32, s20, 6144
    s_add_u32 s32, s32, 65536
    v_add_u32 v114, s32, v104
    s_lshl_b32 s32, s20, 10
    s_add_u32 s32, s32, 65536
    v_add_u32 v116, s32, v104
    s_lshl_b32 s29, s24, 15
    s_lshl_b32 s32, s20, 13
    s_add_u32 s29, s29, s32
    s_add_u32 s29, s29, 0x3dc8000
    s_mul_i32 s33, s24, 7168
    s_add_u32 s33, s33, 0x1030000
    s_mul_i32 s34, s24, 40960
    s_add_u32 s34, s34, 0x3448000
    s_lshl_b32 s54, s25, 1
    s_add_u32 s54, s54, s20
    s_lshl_b32 s54, s54, 10
    s_mov_b32 s55, 0xceabfb8f
RT_top:
    s_waitcnt vmcnt(0)
    s_barrier
    s_cmp_lg_u32 s20, 0
    s_cbranch_scc1 RT_nf
    v_mov_b32 v56, 1
    s_mov_b64 exec, 1
    buffer_store_dword v56, off, s[4:7], s31 sc1
    s_mov_b64 exec, -1
RT_nf:
    s_cmp_ge_u32 s24, 64
    s_cbranch_scc1 M_exit
    s_add_u32 s27, s27, 114688
    s_xor_b32 s28, s28, 32768
    s_cmp_ge_u32 s24, 60
    s_cbranch_scc1 RT_nd
    s_mov_b32 m0, s28
    s_add_u32 s63, s27, 4096
    buffer_load_dwordx4 v104, s[4:7], s27 offen offset:0 lds
    buffer_load_dwordx4 v104, s[4:7], s27 offen offset:1024 lds
    buffer_load_dwordx4 v104, s[4:7], s27 offen offset:2048 lds
    buffer_load_dwordx4 v104, s[4:7], s27 offen offset:3072 lds
    s_add_u32 m0, s28, 4096
    s_nop 0
    buffer_load_dwordx4 v104, s[4:7], s63 offen offset:0 lds
    buffer_load_dwordx4 v104, s[4:7], s63 offen offset:1024 lds
    buffer_load_dwordx4 v104, s[4:7], s63 offen offset:2048 lds
RT_nd:
    ds_read_b128 v[56:59], v105 offset:0
    ds_read_b128 v[60:63], v105 offset:14336
    ds_read_b128 v[64:67], v105 offset:1024
    ds_read_b128 v[68:71], v105 offset:15360
    s_waitcnt lgkmcnt(2)
    v_mfma_f32_16x16x32_bf16 v[0:3], a[0:3], v[56:59], 0
    v_mfma_f32_16x16x32_bf16 v[4:7], a[0:3], v[60:63], 0
    v_mfma_f32_16x16x32_bf16 v[8:11], a[56:59], v[56:59], 0
    v_mfma_f32_16x16x32_bf16 v[12:15], a[56:59], v[60:63], 0
    v_mfma_f32_16x16x32_bf16 v[16:19], a[112:115], v[56:59], 0
    v_mfma_f32_16x16x32_bf16 v[20:23], a[112:115], v[60:63], 0
    v_mfma_f32_16x16x32_bf16 v[24:27], a[168:171], v[56:59], 0
    v_mfma_f32_16x16x32_bf16 v[28:31], a[168:171], v[60:63], 0
    v_mfma_f32_16x16x32_bf16 v[32:35], a[224:227], v[56:59], 0
    v_mfma_f32_16x16x32_bf16 v[36:39], a[224:227], v[60:63], 0
    v_mfma_f32_16x16x32_bf16 v[40:43], v[144:147], v[56:59], 0
    v_mfma_f32_16x16x32_bf16 v[44:47], v[144:147], v[60:63], 0
    v_mfma_f32_16x16x32_bf16 v[48:51], v[200:203], v[56:59], 0
    v_mfma_f32_16x16x32_bf16 v[52:55], v[200:203], v[60:63], 0
    ds_read_b128 v[56:59], v105 offset:2048
    ds_read_b128 v[60:63], v105 offset:16384
    s_waitcnt lgkmcnt(2)
    v_mfma_f32_16x16x32_bf16 v[0:3], a[4:7], v[64:67], v[0:3]
    v_mfma_f32_16x16x32_bf16 v[4:7], a[4:7], v[68:71], v[4:7]
    v_mfma_f32_16x16x32_bf16 v[8:11], a[60:63], v[64:67], v[8:11]
    v_mfma_f32_16x16x32_bf16 v[12:15], a[60:63], v[68:71], v[12:15]
    v_mfma_f32_16x16x32_bf16 v[16:19], a[116:119], v[64:67], v[16:19]
    v_mfma_f32_16x16x32_bf16 v[20:23], a[116:119], v[68:71], v[20:23]
    v_mfma_f32_16x16x32_bf16 v[24:27], a[172:175], v[64:67], v[24:27]
    v_mfma_f32_16x16x32_bf16 v[28:31], a[172:175], v[68:71], v[28:31]
    v_mfma_f32_16x16x32_bf16 v[32:35], a[228:231], v[64:67], v[32:35]
    v_mfma_f32_16x16x32_bf16 v[36:39], a[228:231], v[68:71], v[36:39]
    v_mfma_f32_16x16x32_bf16 v[40:43], v[148:151], v[64:67], v[40:43]
    v_mfma_f32_16x16x32_bf16 v[44:47], v[148:151], v[68:71], v[44:47]
    v_mfma_f32_16x16x32_bf16 v[48:51], v[204:207], v[64:67], v[48:51]
    v_mfma_f32_16x16x32_bf16 v[52:55], v[204:207], v[68:71], v[52:55]
    ds_read_b128 v[64:67], v105 offset:3072
    ds_read_b128 v[68:71], v105 offset:17408
    s_waitcnt lgkmcnt(2)
    v_mfma_f32_16x16x32_bf16 v[0:3], a[8:11], v[56:59], v[0:3]
    v_mfma_f32_16x16x32_bf16 v[4:7], a[8:11], v[60:63], v[4:7]
    v_mfma_f32_16x16x32_bf16 v[8:11], a[64:67], v[56:59], v[8:11]
    v_mfma_f32_16x16x32_bf16 v[12:15], a[64:67], v[60:63], v[12:15]
    v_mfma_f32_16x16x32_bf16 v[16:19], a[120:123], v[56:59], v[16:19]
    v_mfma_f32_16x16x32_bf16 v[20:23], a[120:123], v[60:63], v[20:23]
    v_mfma_f32_16x16x32_bf16 v[24:27], a[176:179], v[56:59], v[24:27]
    v_mfma_f32_16x16x32_bf16 v[28:31], a[176:179], v[60:63], v[28:31]
    v_mfma_f32_16x16x32_bf16 v[32:35], a[232:235], v[56:59], v[32:35]
    v_mfma_f32_16x16x32_bf16 v[36:39], a[232:235], v[60:63], v[36:39]
    v_mfma_f32_16x16x32_bf16 v[40:43], v[152:155], v[56:59], v[40:43]
    v_mfma_f32_16x16x32_bf16 v[44:47], v[152:155], v[60:63], v[44:47]
    v_mfma_f32_16x16x32_bf16 v[48:51], v[208:211], v[56:59], v[48:51]
    v_mfma_f32_16x16x32_bf16 v[52:55], v[208:211], v[60:63], v[52:55]
    ds_read_b128 v[56:59], v105 offset:4096
    ds_read_b128 v[60:63], v105 offset:18432
    s_waitcnt lgkmcnt(2)
    v_mfma_f32_16x16x32_bf16 v[0:3], a[12:15], v[64:67], v[0:3]
    v_mfma_f32_16x16x32_bf16 v[4:7], a[12:15], v[68:71], v[4:7]
    v_mfma_f32_16x16x32_bf16 v[8:11], a[68:71], v[64:67], v[8:11]
    v_mfma_f32_16x16x32_bf16 v[12:15], a[68:71], v[68:71], v[12:15]
    v_mfma_f32_16x16x32_bf16 v[16:19], a[124:127], v[64:67], v[16:19]
    v_mfma_f32_16x16x32_bf16 v[20:23], a[124:127], v[68:71], v[20:23]
    v_mfma_f32_16x16x32_bf16 v[24:27], a[180:183], v[64:67], v[24:27]
    v_mfma_f32_16x16x32_bf16 v[28:31], a[180:183], v[68:71], v[28:31]
    v_mfma_f32_16x16x32_bf16 v[32:35], a[236:239], v[64:67], v[32:35]
    v_mfma_f32_16x16x32_bf16 v[36:39], a[236:239], v[68:71], v[36:39]
    v_mfma_f32_16x16x32_bf16 v[40:43], v[156:159], v[64:67], v[40:43]
    v_mfma_f32_16x16x32_bf16 v[44:47], v[156:159], v[68:71], v[44:47]
    v_mfma_f32_16x16x32_bf16 v[48:51], v[212:215], v[64:67], v[48:51]
    v_mfma_f32_16x16x32_bf16 v[52:55], v[212:215], v[68:71], v[52:55]
    ds_read_b128 v[64:67], v105 offset:5120
    ds_read_b128 v[68:71], v105 offset:19456
    s_waitcnt lgkmcnt(2)
    v_mfma_f32_16x16x32_bf16 v[0:3], a[16:19], v[56:59], v[0:3]
    v_mfma_f32_16x16x32_bf16 v[4:7], a[16:19], v[60:63], v[4:7]
    v_mfma_f32_16x16x32_bf16 v[8:11], a[72:75], v[56:59], v[8:11]
    v_mfma_f32_16x16x32_bf16 v[12:15], a[72:75], v[60:63], v[12:15]
    v_mfma_f32_16x16x32_bf16 v[16:19], a[128:131], v[56:59], v[16:19]
    v_mfma_f32_16x16x32_bf16 v[20:23], a[128:131], v[60:63], v[20:23]
    v_mfma_f32_16x16x32_bf16 v[24:27], a[184:187], v[56:59], v[24:27]
    v_mfma_f32_16x16x32_bf16 v[28:31], a[184:187], v[60:63], v[28:31]
    v_mfma_f32_16x16x32_bf16 v[32:35], a[240:243], v[56:59], v[32:35]
    v_mfma_f32_16x16x32_bf16 v[36:39], a[240:243], v[60:63], v[36:39]
    v_mfma_f32_16x16x32_bf16 v[40:43], v[160:163], v[56:59], v[40:43]
    v_mfma_f32_16x16x32_bf16 v[44:47], v[160:163], v[60:63], v[44:47]
    v_mfma_f32_16x16x32_bf16 v[48:51], v[216:219], v[56:59], v[48:51]
    v_mfma_f32_16x16x32_bf16 v[52:55], v[216:219], v[60:63], v[52:55]
    ds_read_b128 v[56:59], v105 offset:6144
    ds_read_b128 v[60:63], v105 offset:20480
    s_waitcnt lgkmcnt(2)
    v_mfma_f32_16x16x32_bf16 v[0:3], a[20:23], v[64:67], v[0:3]
    v_mfma_f32_16x16x32_bf16 v[4:7], a[20:23], v[68:71], v[4:7]
    v_mfma_f32_16x16x32_bf16 v[8:11], a[76:79], v[64:67], v[8:11]
    v_mfma_f32_16x16x32_bf16 v[12:15], a[76:79], v[68:71], v[12:15]
    v_mfma_f32_16x16x32_bf16 v[16:19], a[132:135], v[64:67], v[16:19]
    v_mfma_f32_16x16x32_bf16 v[20:23], a[132:135], v[68:71], v[20:23]
    v_mfma_f32_16x16x32_bf16 v[24:27], a[188:191], v[64:67], v[24:27]
    v_mfma_f32_16x16x32_bf16 v[28:31], a[188:191], v[68:71], v[28:31]
    v_mfma_f32_16x16x32_bf16 v[32:35], a[244:247], v[64:67], v[32:35]
    v_mfma_f32_16x16x32_bf16 v[36:39], a[244:247], v[68:71], v[36:39]
    v_mfma_f32_16x16x32_bf16 v[40:43], v[164:167], v[64:67], v[40:43]
    v_mfma_f32_16x16x32_bf16 v[44:47], v[164:167], v[68:71], v[44:47]
    v_mfma_f32_16x16x32_bf16 v[48:51], v[220:223], v[64:67], v[48:51]
    v_mfma_f32_16x16x32_bf16 v[52:55], v[220:223], v[68:71], v[52:55]
    ds_read_b128 v[64:67], v105 offset:7168
    ds_read_b128 v[68:71], v105 offset:21504
    s_waitcnt lgkmcnt(2)
    v_mfma_f32_16x16x32_bf16 v[0:3], a[24:27], v[56:59], v[0:3]
    v_mfma_f32_16x16x32_bf16 v[4:7], a[24:27], v[60:63], v[4:7]
    v_mfma_f32_16x16x32_bf16 v[8:11], a[80:83], v[56:59], v[8:11]
    v_mfma_f32_16x16x32_bf16 v[12:15], a[80:83], v[60:63], v[12:15]
    v_mfma_f32_16x16x32_bf16 v[16:19], a[136:139], v[56:59], v[16:19]
    v_mfma_f32_16x16x32_bf16 v[20:23], a[136:139], v[60:63], v[20:23]
    v_mfma_f32_16x16x32_bf16 v[24:27], a[192:195], v[56:59], v[24:27]
    v_mfma_f32_16x16x32_bf16 v[28:31], a[192:195], v[60:63], v[28:31]
    v_mfma_f32_16x16x32_bf16 v[32:35], a[248:251], v[56:59], v[32:35]
    v_mfma_f32_16x16x32_bf16 v[36:39], a[248:251], v[60:63], v[36:39]
    v_mfma_f32_16x16x32_bf16 v[40:43], v[168:171], v[56:59], v[40:43]
    v_mfma_f32_16x16x32_bf16 v[44:47], v[168:171], v[60:63], v[44:47]
    v_mfma_f32_16x16x32_bf16 v[48:51], v[224:227], v[56:59], v[48:51]
    v_mfma_f32_16x16x32_bf16 v[52:55], v[224:227], v[60:63], v[52:55]
    ds_read_b128 v[56:59], v105 offset:8192
    ds_read_b128 v[60:63], v105 offset:22528
    s_waitcnt lgkmcnt(2)
    v_mfma_f32_16x16x32_bf16 v[0:3], a[28:31], v[64:67], v[0:3]
    v_mfma_f32_16x16x32_bf16 v[4:7], a[28:31], v[68:71], v[4:7]
    v_mfma_f32_16x16x32_bf16 v[8:11], a[84:87], v[64:67], v[8:11]
    v_mfma_f32_16x16x32_bf16 v[12:15], a[84:87], v[68:71], v[12:15]
    v_mfma_f32_16x16x32_bf16 v[16:19], a[140:143], v[64:67], v[16:19]
    v_mfma_f32_16x16x32_bf16 v[20:23], a[140:143], v[68:71], v[20:23]
    v_mfma_f32_16x16x32_bf16 v[24:27], a[196:199], v[64:67], v[24:27]
    v_mfma_f32_16x16x32_bf16 v[28:31], a[196:199], v[68:71], v[28:31]
    v_mfma_f32_16x16x32_bf16 v[32:35], a[252:255], v[64:67], v[32:35]
    v_mfma_f32_16x16x32_bf16 v[36:39], a[252:255], v[68:71], v[36:39]
    v_mfma_f32_16x16x32_bf16 v[40:43], v[172:175], v[64:67], v[40:43]
    v_mfma_f32_16x16x32_bf16 v[44:47], v[172:175], v[68:71], v[44:47]
    v_mfma_f32_16x16x32_bf16 v[48:51], v[228:231], v[64:67], v[48:51]
    v_mfma_f32_16x16x32_bf16 v[52:55], v[228:231], v[68:71], v[52:55]
    ds_read_b128 v[64:67], v105 offset:9216
    ds_read_b128 v[68:71], v105 offset:23552
    s_waitcnt lgkmcnt(2)
    v_mfma_f32_16x16x32_bf16 v[0:3], a[32:35], v[56:59], v[0:3]
    v_mfma_f32_16x16x32_bf16 v[4:7], a[32:35], v[60:63], v[4:7]
    v_mfma_f32_16x16x32_bf16 v[8:11], a[88:91], v[56:59], v[8:11]
    v_mfma_f32_16x16x32_bf16 v[12:15], a[88:91], v[60:63], v[12:15]
    v_mfma_f32_16x16x32_bf16 v[16:19], a[144:147], v[56:59], v[16:19]
    v_mfma_f32_16x16x32_bf16 v[20:23], a[144:147], v[60:63], v[20:23]
    v_mfma_f32_16x16x32_bf16 v[24:27], a[200:203], v[56:59], v[24:27]
    v_mfma_f32_16x16x32_bf16 v[28:31], a[200:203], v[60:63], v[28:31]
    v_mfma_f32_16x16x32_bf16 v[32:35], v[120:123], v[56:59], v[32:35]
    v_mfma_f32_16x16x32_bf16 v[36:39], v[120:123], v[60:63], v[36:39]
    v_mfma_f32_16x16x32_bf16 v[40:43], v[176:179], v[56:59], v[40:43]
    v_mfma_f32_16x16x32_bf16 v[44:47], v[176:179], v[60:63], v[44:47]
    v_mfma_f32_16x16x32_bf16 v[48:51], v[232:235], v[56:59], v[48:51]
    v_mfma_f32_16x16x32_bf16 v[52:55], v[232:235], v[60:63], v[52:55]
    ds_read_b128 v[56:59], v105 offset:10240
    ds_read_b128 v[60:63], v105 offset:24576
    s_waitcnt lgkmcnt(2)
    v_mfma_f32_16x16x32_bf16 v[0:3], a[36:39], v[64:67], v[0:3]
    v_mfma_f32_16x16x32_bf16 v[4:7], a[36:39], v[68:71], v[4:7]
    v_mfma_f32_16x16x32_bf16 v[8:11], a[92:95], v[64:67], v[8:11]
    v_mfma_f32_16x16x32_bf16 v[12:15], a[92:95], v[68:71], v[12:15]
    v_mfma_f32_16x16x32_bf16 v[16:19], a[148:151], v[64:67], v[16:19]
    v_mfma_f32_16x16x32_bf16 v[20:23], a[148:151], v[68:71], v[20:23]
    v_mfma_f32_16x16x32_bf16 v[24:27], a[204:207], v[64:67], v[24:27]
    v_mfma_f32_16x16x32_bf16 v[28:31], a[204:207], v[68:71], v[28:31]
    v_mfma_f32_16x16x32_bf16 v[32:35], v[124:127], v[64:67], v[32:35]
    v_mfma_f32_16x16x32_bf16 v[36:39], v[124:127], v[68:71], v[36:39]
    v_mfma_f32_16x16x32_bf16 v[40:43], v[180:183], v[64:67], v[40:43]
    v_mfma_f32_16x16x32_bf16 v[44:47], v[180:183], v[68:71], v[44:47]
    v_mfma_f32_16x16x32_bf16 v[48:51], v[236:239], v[64:67], v[48:51]
    v_mfma_f32_16x16x32_bf16 v[52:55], v[236:239], v[68:71], v[52:55]
    ds_read_b128 v[64:67], v105 offset:11264
    ds_read_b128 v[68:71], v105 offset:25600
    s_waitcnt lgkmcnt(2)
    v_mfma_f32_16x16x32_bf16 v[0:3], a[40:43], v[56:59], v[0:3]
    v_mfma_f32_16x16x32_bf16 v[4:7], a[40:43], v[60:63], v[4:7]
    v_mfma_f32_16x16x32_bf16 v[8:11], a[96:99], v[56:59], v[8:11]
    v_mfma_f32_16x16x32_bf16 v[12:15], a[96:99], v[60:63], v[12:15]
    v_mfma_f32_16x16x32_bf16 v[16:19], a[152:155], v[56:59], v[16:19]
    v_mfma_f32_16x16x32_bf16 v[20:23], a[152:155], v[60:63], v[20:23]
    v_mfma_f32_16x16x32_bf16 v[24:27], a[208:211], v[56:59], v[24:27]
    v_mfma_f32_16x16x32_bf16 v[28:31], a[208:211], v[60:63], v[28:31]
    v_mfma_f32_16x16x32_bf16 v[32:35], v[128:131], v[56:59], v[32:35]
    v_mfma_f32_16x16x32_bf16 v[36:39], v[128:131], v[60:63], v[36:39]
    v_mfma_f32_16x16x32_bf16 v[40:43], v[184:187], v[56:59], v[40:43]
    v_mfma_f32_16x16x32_bf16 v[44:47], v[184:187], v[60:63], v[44:47]
    v_mfma_f32_16x16x32_bf16 v[48:51], v[240:243], v[56:59], v[48:51]
    v_mfma_f32_16x16x32_bf16 v[52:55], v[240:243], v[60:63], v[52:55]
    ds_read_b128 v[56:59], v105 offset:12288
    ds_read_b128 v[60:63], v105 offset:26624
    s_waitcnt lgkmcnt(2)
    v_mfma_f32_16x16x32_bf16 v[0:3], a[44:47], v[64:67], v[0:3]
    v_mfma_f32_16x16x32_bf16 v[4:7], a[44:47], v[68:71], v[4:7]
    v_mfma_f32_16x16x32_bf16 v[8:11], a[100:103], v[64:67], v[8:11]
    v_mfma_f32_16x16x32_bf16 v[12:15], a[100:103], v[68:71], v[12:15]
    v_mfma_f32_16x16x32_bf16 v[16:19], a[156:159], v[64:67], v[16:19]
    v_mfma_f32_16x16x32_bf16 v[20:23], a[156:159], v[68:71], v[20:23]
    v_mfma_f32_16x16x32_bf16 v[24:27], a[212:215], v[64:67], v[24:27]
    v_mfma_f32_16x16x32_bf16 v[28:31], a[212:215], v[68:71], v[28:31]
    v_mfma_f32_16x16x32_bf16 v[32:35], v[132:135], v[64:67], v[32:35]
    v_mfma_f32_16x16x32_bf16 v[36:39], v[132:135], v[68:71], v[36:39]
    v_mfma_f32_16x16x32_bf16 v[40:43], v[188:191], v[64:67], v[40:43]
    v_mfma_f32_16x16x32_bf16 v[44:47], v[188:191], v[68:71], v[44:47]
    v_mfma_f32_16x16x32_bf16 v[48:51], v[244:247], v[64:67], v[48:51]
    v_mfma_f32_16x16x32_bf16 v[52:55], v[244:247], v[68:71], v[52:55]
    ds_read_b128 v[64:67], v105 offset:13312
    ds_read_b128 v[68:71], v105 offset:27648
    s_waitcnt lgkmcnt(2)
    v_mfma_f32_16x16x32_bf16 v[0:3], a[48:51], v[56:59], v[0:3]
    v_mfma_f32_16x16x32_bf16 v[4:7], a[48:51], v[60:63], v[4:7]
    v_mfma_f32_16x16x32_bf16 v[8:11], a[104:107], v[56:59], v[8:11]
    v_mfma_f32_16x16x32_bf16 v[12:15], a[104:107], v[60:63], v[12:15]
    v_mfma_f32_16x16x32_bf16 v[16:19], a[160:163], v[56:59], v[16:19]
    v_mfma_f32_16x16x32_bf16 v[20:23], a[160:163], v[60:63], v[20:23]
    v_mfma_f32_16x16x32_bf16 v[24:27], a[216:219], v[56:59], v[24:27]
    v_mfma_f32_16x16x32_bf16 v[28:31], a[216:219], v[60:63], v[28:31]
    v_mfma_f32_16x16x32_bf16 v[32:35], v[136:139], v[56:59], v[32:35]
    v_mfma_f32_16x16x32_bf16 v[36:39], v[136:139], v[60:63], v[36:39]
    v_mfma_f32_16x16x32_bf16 v[40:43], v[192:195], v[56:59], v[40:43]
    v_mfma_f32_16x16x32_bf16 v[44:47], v[192:195], v[60:63], v[44:47]
    v_mfma_f32_16x16x32_bf16 v[48:51], v[248:251], v[56:59], v[48:51]
    v_mfma_f32_16x16x32_bf16 v[52:55], v[248:251], v[60:63], v[52:55]
    s_waitcnt lgkmcnt(0)
    v_mfma_f32_16x16x32_bf16 v[0:3], a[52:55], v[64:67], v[0:3]
    v_mfma_f32_16x16x32_bf16 v[4:7], a[52:55], v[68:71], v[4:7]
    v_mfma_f32_16x16x32_bf16 v[8:11], a[108:111], v[64:67], v[8:11]
    v_mfma_f32_16x16x32_bf16 v[12:15], a[108:111], v[68:71], v[12:15]
    v_mfma_f32_16x16x32_bf16 v[16:19], a[164:167], v[64:67], v[16:19]
    v_mfma_f32_16x16x32_bf16 v[20:23], a[164:167], v[68:71], v[20:23]
    v_mfma_f32_16x16x32_bf16 v[24:27], a[220:223], v[64:67], v[24:27]
    v_mfma_f32_16x16x32_bf16 v[28:31], a[220:223], v[68:71], v[28:31]
    v_mfma_f32_16x16x32_bf16 v[32:35], v[140:143], v[64:67], v[32:35]
    v_mfma_f32_16x16x32_bf16 v[36:39], v[140:143], v[68:71], v[36:39]
    v_mfma_f32_16x16x32_bf16 v[40:43], v[196:199], v[64:67], v[40:43]
    v_mfma_f32_16x16x32_bf16 v[44:47], v[196:199], v[68:71], v[44:47]
    v_mfma_f32_16x16x32_bf16 v[48:51], v[252:255], v[64:67], v[48:51]
    v_mfma_f32_16x16x32_bf16 v[52:55], v[252:255], v[68:71], v[52:55]
RT_epi:
    v_xor_b32 v105, 32768, v105
    s_nop 6
    v_cvt_pk_bf16_f32 v72, v0, v1
    v_cvt_pk_bf16_f32 v73, v8, v9
    v_cvt_pk_bf16_f32 v74, v2, v3
    v_cvt_pk_bf16_f32 v75, v10, v11
    v_cvt_pk_bf16_f32 v76, v16, v17
    v_cvt_pk_bf16_f32 v77, v24, v25
    v_cvt_pk_bf16_f32 v78, v18, v19
    v_cvt_pk_bf16_f32 v79, v26, v27
    v_cvt_pk_bf16_f32 v80, v32, v33
    v_cvt_pk_bf16_f32 v81, v40, v41
    v_cvt_pk_bf16_f32 v82, v34, v35
    v_cvt_pk_bf16_f32 v83, v42, v43
    v_cvt_pk_bf16_f32 v84, v48, v49
    v_and_b32 v85, s51, v84
    v_and_b32 v84, s50, v84
    v_cvt_pk_bf16_f32 v86, v50, v51
    v_and_b32 v87, s51, v86
    v_and_b32 v86, s50, v86
    v_cvt_pk_bf16_f32 v88, v4, v5
    v_cvt_pk_bf16_f32 v89, v12, v13
    v_cvt_pk_bf16_f32 v90, v6, v7
    v_cvt_pk_bf16_f32 v91, v14, v15
    v_cvt_pk_bf16_f32 v92, v20, v21
    v_cvt_pk_bf16_f32 v93, v28, v29
    v_cvt_pk_bf16_f32 v94, v22, v23
    v_cvt_pk_bf16_f32 v95, v30, v31
    v_cvt_pk_bf16_f32 v96, v36, v37
    v_cvt_pk_bf16_f32 v97, v44, v45
    v_cvt_pk_bf16_f32 v98, v38, v39
    v_cvt_pk_bf16_f32 v99, v46, v47
    v_cvt_pk_bf16_f32 v100, v52, v53
    v_and_b32 v101, s51, v100
    v_and_b32 v100, s50, v100
    v_cvt_pk_bf16_f32 v102, v54, v55
    v_and_b32 v103, s51, v102
    v_and_b32 v102, s50, v102
    s_add_u32 s32, s29, 4096
    buffer_load_dwordx4 v[0:3], v106, s[4:7], s29 offen offset:0
    buffer_load_dwordx4 v[4:7], v106, s[4:7], s29 offen offset:256
    buffer_load_dwordx4 v[8:11], v106, s[4:7], s32 offen offset:0
    buffer_load_dwordx4 v[12:15], v106, s[4:7], s32 offen offset:256
    buffer_load_dwordx4 v[16:19], v106, s[4:7], s29 offen offset:2048
    buffer_load_dwordx4 v[20:23], v106, s[4:7], s29 offen offset:2304
    buffer_load_dwordx4 v[24:27], v106, s[4:7], s32 offen offset:2048
    buffer_load_dwordx4 v[28:31], v106, s[4:7], s32 offen offset:2304
    s_waitcnt vmcnt(7)
    v_mfma_f32_16x16x32_bf16 v[48:51], v[0:3], v[72:75], 0
    v_mfma_f32_16x16x32_bf16 v[52:55], v[0:3], v[88:91], 0
    s_waitcnt vmcnt(6)
    v_mfma_f32_16x16x32_bf16 v[48:51], v[4:7], v[76:79], v[48:51]
    v_mfma_f32_16x16x32_bf16 v[52:55], v[4:7], v[92:95], v[52:55]
    s_waitcnt vmcnt(5)
    v_mfma_f32_16x16x32_bf16 v[48:51], v[8:11], v[80:83], v[48:51]
    v_mfma_f32_16x16x32_bf16 v[52:55], v[8:11], v[96:99], v[52:55]
    s_waitcnt vmcnt(4)
    v_mfma_f32_16x16x32_bf16 v[48:51], v[12:15], v[84:87], v[48:51]
    v_mfma_f32_16x16x32_bf16 v[52:55], v[12:15], v[100:103], v[52:55]
    s_waitcnt vmcnt(3)
    v_mfma_f32_16x16x32_bf16 v[60:63], v[16:19], v[88:91], 0
    s_waitcnt vmcnt(2)
    v_mfma_f32_16x16x32_bf16 v[60:63], v[20:23], v[92:95], v[60:63]
    s_waitcnt vmcnt(1)
    v_mfma_f32_16x16x32_bf16 v[60:63], v[24:27], v[96:99], v[60:63]
    s_waitcnt vmcnt(0)
    v_mfma_f32_16x16x32_bf16 v[60:63], v[28:31], v[100:103], v[60:63]
    s_nop 4
    ds_write_b128 v114, v[48:51] offset:0
    ds_write_b128 v114, v[52:55] offset:1024
    s_nop 2
    ds_write_b128 v114, v[60:63] offset:3072
    s_waitcnt lgkmcnt(0)
    s_barrier
    s_cmp_ge_u32 s20, 2
    s_cbranch_scc1 RT_p1
    ds_read_b128 v[0:3], v116 offset:0
    ds_read_b128 v[4:7], v116 offset:6144
    ds_read_b128 v[8:11], v116 offset:12288
    ds_read_b128 v[12:15], v116 offset:18432
    ds_read_b128 v[16:19], v116 offset:2048
    ds_read_b128 v[20:23], v116 offset:8192
    ds_read_b128 v[24:27], v116 offset:14336
    ds_read_b128 v[28:31], v116 offset:20480
    s_waitcnt lgkmcnt(4)
    v_add_f32 v0, v0, v4
    v_add_f32 v8, v8, v12
    v_add_f32 v0, v0, v8
    v_cmp_le_i32 vcc, 0, v113
    v_mov_b32 v4, s55
    s_nop 0
    v_cndmask_b32 v0, v4, v0, vcc
    v_add_f32 v1, v1, v5
    v_add_f32 v9, v9, v13
    v_add_f32 v1, v1, v9
    v_cmp_le_i32 vcc, 1, v113
    v_mov_b32 v5, s55
    s_nop 0
    v_cndmask_b32 v1, v5, v1, vcc
    v_add_f32 v2, v2, v6
    v_add_f32 v10, v10, v14
    v_add_f32 v2, v2, v10
    v_cmp_le_i32 vcc, 2, v113
    v_mov_b32 v6, s55
    s_nop 0
    v_cndmask_b32 v2, v6, v2, vcc
    v_add_f32 v3, v3, v7
    v_add_f32 v11, v11, v15
    v_add_f32 v3, v3, v11
    v_cmp_le_i32 vcc, 3, v113
    v_mov_b32 v7, s55
    s_nop 0
    v_cndmask_b32 v3, v7, v3, vcc
    s_waitcnt lgkmcnt(0)
    v_add_f32 v16, v16, v20
    v_add_f32 v24, v24, v28
    v_add_f32 v16, v16, v24
    v_cmp_le_i32 vcc, 16, v113
    v_mov_b32 v20, s55
    s_nop 0
    v_cndmask_b32 v8, v20, v16, vcc
    v_add_f32 v17, v17, v21
    v_add_f32 v25, v25, v29
    v_add_f32 v17, v17, v25
    v_cmp_le_i32 vcc, 17, v113
    v_mov_b32 v21, s55
    s_nop 0
    v_cndmask_b32 v9, v21, v17, vcc
    v_add_f32 v18, v18, v22
    v_add_f32 v26, v26, v30
    v_add_f32 v18, v18, v26
    v_cmp_le_i32 vcc, 18, v113
    v_mov_b32 v22, s55
    s_nop 0
    v_cndmask_b32 v10, v22, v18, vcc
    v_add_f32 v19, v19, v23
    v_add_f32 v27, v27, v31
    v_add_f32 v19, v19, v27
    v_cmp_le_i32 vcc, 19, v113
    v_mov_b32 v23, s55
    s_nop 0
    v_cndmask_b32 v11, v23, v19, vcc
    v_max3_f32 v4, v0, v1, v2
    v_max3_f32 v4, v4, v3, v8
    v_max3_f32 v4, v4, v9, v10
    v_max_f32 v4, v4, v11
RT_p1:
    s_cmp_lg_u32 s20, 2
    s_cbranch_scc1 L_gate_154
L_RTm0_155:
    s_sub_u32 s23, s23, 1
    s_cbranch_scc1 M_exit
    buffer_load_dword v115, off, s[4:7], s33 sc1
    s_waitcnt vmcnt(0)
    v_cmp_eq_u32 vcc, -1, v115
    s_cbranch_vccnz L_RTm0_155
L_gate_154:
    s_barrier
L_RTm1_156:
    s_sub_u32 s23, s23, 1
    s_cbranch_scc1 M_exit
    buffer_load_dwordx4 v[32:35], v109, s[4:7], s33 offen offset:0 sc1
    buffer_load_dwordx4 v[36:39], v109, s[4:7], s33 offen offset:256 sc1
    buffer_load_dwordx4 v[40:43], v110, s[4:7], s33 offen offset:0 sc1
    buffer_load_dwordx4 v[44:47], v111, s[4:7], s33 offen offset:0 sc1
    s_waitcnt vmcnt(0)
    v_max3_u32 v115, v32, v33, v34
    v_max3_u32 v115, v115, v35, v36
    v_max3_u32 v115, v115, v37, v38
    v_max3_u32 v115, v115, v39, v40
    v_max3_u32 v115, v115, v41, v42
    v_max3_u32 v115, v115, v43, v44
    v_max3_u32 v115, v115, v45, v46
    v_max_u32 v115, v115, v47
    v_cmp_eq_u32 vcc, -1, v115
    s_cbranch_vccnz L_RTm1_156
    v_mfma_f32_16x16x32_bf16 v[64:67], v[32:35], v[72:75], 0
    v_mfma_f32_16x16x32_bf16 v[68:71], v[32:35], v[88:91], 0
    v_mfma_f32_16x16x32_bf16 v[64:67], v[36:39], v[76:79], v[64:67]
    v_mfma_f32_16x16x32_bf16 v[68:71], v[36:39], v[92:95], v[68:71]
    v_mfma_f32_16x16x32_bf16 v[64:67], v[40:43], v[80:83], v[64:67]
    v_mfma_f32_16x16x32_bf16 v[68:71], v[40:43], v[96:99], v[68:71]
    v_mfma_f32_16x16x32_bf16 v[64:67], v[44:47], v[84:87], v[64:67]
    v_mfma_f32_16x16x32_bf16 v[68:71], v[44:47], v[100:103], v[68:71]
    s_nop 4
    ds_write_b128 v114, v[64:67] offset:4096
    s_nop 2
    ds_write_b128 v114, v[68:71] offset:5120
    s_waitcnt lgkmcnt(0)
    s_barrier
    s_cmp_ge_u32 s20, 2
    s_cbranch_scc1 RT_p2
    ds_read_b128 v[16:19], v116 offset:4096
    ds_read_b128 v[20:23], v116 offset:10240
    ds_read_b128 v[24:27], v116 offset:16384
    ds_read_b128 v[28:31], v116 offset:22528
    v_mov_b32 v5, 0xff800000
    s_waitcnt lgkmcnt(0)
    v_add_f32 v16, v16, v20
    v_add_f32 v24, v24, v28
    v_add_f32 v16, v16, v24
    v_cndmask_b32 v12, v5, v16, s[52:53]
    v_add_f32 v17, v17, v21
    v_add_f32 v25, v25, v29
    v_add_f32 v17, v17, v25
    v_cndmask_b32 v13, v5, v17, s[52:53]
    v_add_f32 v18, v18, v22
    v_add_f32 v26, v26, v30
    v_add_f32 v18, v18, v26
    v_cndmask_b32 v14, v5, v18, s[52:53]
    v_add_f32 v19, v19, v23
    v_add_f32 v27, v27, v31
    v_add_f32 v19, v19, v27
    v_cndmask_b32 v15, v5, v19, s[52:53]
    v_max3_f32 v4, v4, v12, v13
    v_max3_f32 v4, v4, v14, v15
    v_mov_b32 v5, v4
    s_nop 1
    v_permlane16_swap_b32 v5, v4
    v_max_f32 v4, v4, v5
    v_mov_b32 v5, v4
    s_nop 1
    v_permlane32_swap_b32 v5, v4
    v_max_f32 v4, v4, v5
    v_sub_f32 v0, v0, v4
    v_sub_f32 v1, v1, v4
    v_sub_f32 v2, v2, v4
    v_sub_f32 v3, v3, v4
    v_sub_f32 v8, v8, v4
    v_sub_f32 v9, v9, v4
    v_sub_f32 v10, v10, v4
    v_sub_f32 v11, v11, v4
    v_sub_f32 v12, v12, v4
    v_sub_f32 v13, v13, v4
    v_sub_f32 v14, v14, v4
    v_sub_f32 v15, v15, v4
    v_exp_f32 v0, v0
    v_exp_f32 v1, v1
    v_exp_f32 v2, v2
    v_exp_f32 v3, v3
    v_exp_f32 v8, v8
    v_exp_f32 v9, v9
    v_exp_f32 v10, v10
    v_exp_f32 v11, v11
    v_exp_f32 v12, v12
    v_exp_f32 v13, v13
    v_exp_f32 v14, v14
    v_exp_f32 v15, v15
    v_add_f32 v4, v0, v1
    v_add_f32 v5, v2, v3
    v_add_f32 v6, v8, v9
    v_add_f32 v7, v10, v11
    v_add_f32 v16, v12, v13
    v_add_f32 v17, v14, v15
    v_add_f32 v4, v4, v5
    v_add_f32 v6, v6, v7
    v_add_f32 v16, v16, v17
    v_add_f32 v4, v4, v6
    v_add_f32 v4, v4, v16
    v_mov_b32 v5, v4
    s_nop 1
    v_permlane16_swap_b32 v5, v4
    v_add_f32 v4, v4, v5
    v_mov_b32 v5, v4
    s_nop 1
    v_permlane32_swap_b32 v5, v4
    v_add_f32 v4, v4, v5
    v_rcp_f32 v4, v4
    s_add_u32 s32, s34, s54
    v_mul_f32 v0, v0, v4
    v_mul_f32 v1, v1, v4
    v_mul_f32 v2, v2, v4
    v_mul_f32 v3, v3, v4
    v_mul_f32 v8, v8, v4
    v_mul_f32 v9, v9, v4
    v_mul_f32 v10, v10, v4
    v_mul_f32 v11, v11, v4
    v_mul_f32 v12, v12, v4
    v_mul_f32 v13, v13, v4
    v_mul_f32 v14, v14, v4
    v_mul_f32 v15, v15, v4
    v_cvt_pk_bf16_f32 v16, v0, v1
    v_cvt_pk_bf16_f32 v17, v2, v3
    v_cvt_pk_bf16_f32 v18, v8, v9
    v_cvt_pk_bf16_f32 v19, v10, v11
    v_cvt_pk_bf16_f32 v20, v12, v13
    v_cvt_pk_bf16_f32 v21, v14, v15
    v_min_u32 v16, -2, v16
    v_min_u32 v17, -2, v17
    v_min_u32 v18, -2, v18
    v_min_u32 v19, -2, v19
    v_min_u32 v20, -2, v20
    v_min_u32 v21, -2, v21
    buffer_store_dwordx4 v[16:19], v104, s[4:7], s32 offen sc1
    buffer_store_dwordx2 v[20:21], v112, s[4:7], s34 offen sc1
RT_p2:
    s_add_u32 s29, s29, 131072
    s_add_u32 s33, s33, 28672
    s_add_u32 s34, s34, 163840
    s_mov_b32 s31, s30
    s_add_u32 s30, s30, 256
    s_add_u32 s24, s24, 4
    s_branch RT_top
RH_role:
    s_sub_u32 s22, s22, 128
    s_lshr_b32 s25, s22, 3
    s_and_b32 s24, s22, 7
    s_mov_b32 s8, s40
    s_mov_b32 s9, s41
    s_mov_b32 s10, 0x188000
    s_mov_b32 s11, 0x20000
    s_movk_i32 s27, 4682
    v_add_u32 v2, 0, v1
    v_mul_u32_u24 v3, s27, v2
    v_lshrrev_b32 v3, 16, v3
    v_mul_u32_u24 v4, 14, v3
    v_sub_u32 v4, v2, v4
    v_mul_u32_u24 v3, 3584, v3
    v_lshl_add_u32 v6, v4, 4, v3
    v_add_u32 v2, 64, v1
    v_mul_u32_u24 v3, s27, v2
    v_lshrrev_b32 v3, 16, v3
    v_mul_u32_u24 v4, 14, v3
    v_sub_u32 v4, v2, v4
    v_mul_u32_u24 v3, 3584, v3
    v_lshl_add_u32 v7, v4, 4, v3
    v_add_u32 v2, 128, v1
    v_mul_u32_u24 v3, s27, v2
    v_lshrrev_b32 v3, 16, v3
    v_mul_u32_u24 v4, 14, v3
    v_sub_u32 v4, v2, v4
    v_mul_u32_u24 v3, 3584, v3
    v_lshl_add_u32 v8, v4, 4, v3
    v_add_u32 v2, 192, v1
    v_mul_u32_u24 v3, s27, v2
    v_lshrrev_b32 v3, 16, v3
    v_mul_u32_u24 v4, 14, v3
    v_sub_u32 v4, v2, v4
    v_mul_u32_u24 v3, 3584, v3
    v_lshl_add_u32 v9, v4, 4, v3
    v_add_u32 v2, 256, v1
    v_mul_u32_u24 v3, s27, v2
    v_lshrrev_b32 v3, 16, v3
    v_mul_u32_u24 v4, 14, v3
    v_sub_u32 v4, v2, v4
    v_mul_u32_u24 v3, 3584, v3
    v_lshl_add_u32 v10, v4, 4, v3
    v_add_u32 v2, 320, v1
    v_mul_u32_u24 v3, s27, v2
    v_lshrrev_b32 v3, 16, v3
    v_mul_u32_u24 v4, 14, v3
    v_sub_u32 v4, v2, v4
    v_mul_u32_u24 v3, 3584, v3
    v_lshl_add_u32 v11, v4, 4, v3
    v_add_u32 v2, 384, v1
    v_mul_u32_u24 v3, s27, v2
    v_lshrrev_b32 v3, 16, v3
    v_mul_u32_u24 v4, 14, v3
    v_sub_u32 v4, v2, v4
    v_mul_u32_u24 v3, 3584, v3
    v_lshl_add_u32 v12, v4, 4, v3
    v_add_u32 v2, 448, v1
    v_mul_u32_u24 v3, s27, v2
    v_lshrrev_b32 v3, 16, v3
    v_mul_u32_u24 v4, 14, v3
    v_sub_u32 v4, v2, v4
    v_mul_u32_u24 v3, 3584, v3
    v_lshl_add_u32 v13, v4, 4, v3
    v_add_u32 v2, 512, v1
    v_mul_u32_u24 v3, s27, v2
    v_lshrrev_b32 v3, 16, v3
    v_mul_u32_u24 v4, 14, v3
    v_sub_u32 v4, v2, v4
    v_mul_u32_u24 v3, 3584, v3
    v_lshl_add_u32 v14, v4, 4, v3
    v_add_u32 v2, 576, v1
    v_mul_u32_u24 v3, s27, v2
    v_lshrrev_b32 v3, 16, v3
    v_mul_u32_u24 v4, 14, v3
    v_sub_u32 v4, v2, v4
    v_mul_u32_u24 v3, 3584, v3
    v_lshl_add_u32 v15, v4, 4, v3
    v_add_u32 v2, 640, v1
    v_mul_u32_u24 v3, s27, v2
    v_lshrrev_b32 v3, 16, v3
    v_mul_u32_u24 v4, 14, v3
    v_sub_u32 v4, v2, v4
    v_mul_u32_u24 v3, 3584, v3
    v_lshl_add_u32 v16, v4, 4, v3
    v_add_u32 v2, 704, v1
    v_mul_u32_u24 v3, s27, v2
    v_lshrrev_b32 v3, 16, v3
    v_mul_u32_u24 v4, 14, v3
    v_sub_u32 v4, v2, v4
    v_mul_u32_u24 v3, 3584, v3
    v_lshl_add_u32 v17, v4, 4, v3
    v_add_u32 v2, 768, v1
    v_mul_u32_u24 v3, s27, v2
    v_lshrrev_b32 v3, 16, v3
    v_mul_u32_u24 v4, 14, v3
    v_sub_u32 v4, v2, v4
    v_mul_u32_u24 v3, 3584, v3
    v_lshl_add_u32 v18, v4, 4, v3
    v_add_u32 v2, 832, v1
    v_mul_u32_u24 v3, s27, v2
    v_lshrrev_b32 v3, 16, v3
    v_mul_u32_u24 v4, 14, v3
    v_sub_u32 v4, v2, v4
    v_mul_u32_u24 v3, 3584, v3
    v_lshl_add_u32 v19, v4, 4, v3
    s_mul_i32 s26, s25, 896
    s_mul_i32 s27, s20, 224
    s_add_u32 s26, s26, s27
    s_mul_i32 s35, s20, 28672
    v_lshrrev_b32 v2, 4, v1
    v_bfe_u32 v3, v1, 2, 1
    v_lshl_add_u32 v2, v2, 2, v3
    v_bfe_u32 v3, v1, 3, 1
    v_lshl_add_u32 v2, v3, 5, v2
    v_mul_u32_u24 v2, 224, v2
    v_and_b32 v3, 3, v1
    v_lshl_add_u32 v2, v3, 3, v2
    v_add_u32 v5, s35, v2
    s_add_u32 m0, s35, 0
    s_nop 0
    buffer_load_dwordx4 v6, s[8:11], s26 offen lds
    s_add_u32 m0, s35, 1024
    s_nop 0
    buffer_load_dwordx4 v7, s[8:11], s26 offen lds
    s_add_u32 m0, s35, 2048
    s_nop 0
    buffer_load_dwordx4 v8, s[8:11], s26 offen lds
    s_add_u32 m0, s35, 3072
    s_nop 0
    buffer_load_dwordx4 v9, s[8:11], s26 offen lds
    s_add_u32 m0, s35, 4096
    s_nop 0
    buffer_load_dwordx4 v10, s[8:11], s26 offen lds
    s_add_u32 m0, s35, 5120
    s_nop 0
    buffer_load_dwordx4 v11, s[8:11], s26 offen lds
    s_add_u32 m0, s35, 6144
    s_nop 0
    buffer_load_dwordx4 v12, s[8:11], s26 offen lds
    s_add_u32 m0, s35, 7168
    s_nop 0
    buffer_load_dwordx4 v13, s[8:11], s26 offen lds
    s_add_u32 m0, s35, 8192
    s_nop 0
    buffer_load_dwordx4 v14, s[8:11], s26 offen lds
    s_add_u32 m0, s35, 9216
    s_nop 0
    buffer_load_dwordx4 v15, s[8:11], s26 offen lds
    s_add_u32 m0, s35, 10240
    s_nop 0
    buffer_load_dwordx4 v16, s[8:11], s26 offen lds
    s_add_u32 m0, s35, 11264
    s_nop 0
    buffer_load_dwordx4 v17, s[8:11], s26 offen lds
    s_add_u32 m0, s35, 12288
    s_nop 0
    buffer_load_dwordx4 v18, s[8:11], s26 offen lds
    s_add_u32 m0, s35, 13312
    s_nop 0
    buffer_load_dwordx4 v19, s[8:11], s26 offen lds
    s_add_u32 s26, s26, 229376
    s_add_u32 m0, s35, 14336
    s_nop 0
    buffer_load_dwordx4 v6, s[8:11], s26 offen lds
    s_add_u32 m0, s35, 15360
    s_nop 0
    buffer_load_dwordx4 v7, s[8:11], s26 offen lds
    s_add_u32 m0, s35, 16384
    s_nop 0
    buffer_load_dwordx4 v8, s[8:11], s26 offen lds
    s_add_u32 m0, s35, 17408
    s_nop 0
    buffer_load_dwordx4 v9, s[8:11], s26 offen lds
    s_add_u32 m0, s35, 18432
    s_nop 0
    buffer_load_dwordx4 v10, s[8:11], s26 offen lds
    s_add_u32 m0, s35, 19456
    s_nop 0
    buffer_load_dwordx4 v11, s[8:11], s26 offen lds
    s_add_u32 m0, s35, 20480
    s_nop 0
    buffer_load_dwordx4 v12, s[8:11], s26 offen lds
    s_add_u32 m0, s35, 21504
    s_nop 0
    buffer_load_dwordx4 v13, s[8:11], s26 offen lds
    s_add_u32 m0, s35, 22528
    s_nop 0
    buffer_load_dwordx4 v14, s[8:11], s26 offen lds
    s_add_u32 m0, s35, 23552
    s_nop 0
    buffer_load_dwordx4 v15, s[8:11], s26 offen lds
    s_add_u32 m0, s35, 24576
    s_nop 0
    buffer_load_dwordx4 v16, s[8:11], s26 offen lds
    s_add_u32 m0, s35, 25600
    s_nop 0
    buffer_load_dwordx4 v17, s[8:11], s26 offen lds
    s_add_u32 m0, s35, 26624
    s_nop 0
    buffer_load_dwordx4 v18, s[8:11], s26 offen lds
    s_add_u32 m0, s35, 27648
    s_nop 0
    buffer_load_dwordx4 v19, s[8:11], s26 offen lds
    s_add_u32 s26, s26, 229376
    s_waitcnt vmcnt(14)
    ds_read_b64_tr_b16 a[0:1], v5 offset:0
    ds_read_b64_tr_b16 a[2:3], v5 offset:448
    ds_read_b64_tr_b16 a[4:5], v5 offset:3584
    ds_read_b64_tr_b16 a[6:7], v5 offset:4032
    ds_read_b64_tr_b16 a[56:57], v5 offset:32
    ds_read_b64_tr_b16 a[58:59], v5 offset:480
    ds_read_b64_tr_b16 a[60:61], v5 offset:3616
    ds_read_b64_tr_b16 a[62:63], v5 offset:4064
    s_waitcnt lgkmcnt(4)
    ds_read_b64_tr_b16 a[112:113], v5 offset:64
    ds_read_b64_tr_b16 a[114:115], v5 offset:512
    ds_read_b64_tr_b16 a[116:117], v5 offset:3648
    ds_read_b64_tr_b16 a[118:119], v5 offset:4096
    ds_read_b64_tr_b16 a[168:169], v5 offset:96
    ds_read_b64_tr_b16 a[170:171], v5 offset:544
    ds_read_b64_tr_b16 a[172:173], v5 offset:3680
    ds_read_b64_tr_b16 a[174:175], v5 offset:4128
    s_waitcnt lgkmcnt(4)
    ds_read_b64_tr_b16 a[224:225], v5 offset:128
    ds_read_b64_tr_b16 a[226:227], v5 offset:576
    ds_read_b64_tr_b16 a[228:229], v5 offset:3712
    ds_read_b64_tr_b16 a[230:231], v5 offset:4160
    ds_read_b64_tr_b16 v[144:145], v5 offset:160
    ds_read_b64_tr_b16 v[146:147], v5 offset:608
    ds_read_b64_tr_b16 v[148:149], v5 offset:3744
    ds_read_b64_tr_b16 v[150:151], v5 offset:4192
    s_waitcnt lgkmcnt(4)
    ds_read_b64_tr_b16 v[200:201], v5 offset:192
    ds_read_b64_tr_b16 v[202:203], v5 offset:640
    ds_read_b64_tr_b16 v[204:205], v5 offset:3776
    ds_read_b64_tr_b16 v[206:207], v5 offset:4224
    s_waitcnt lgkmcnt(0)
    s_add_u32 m0, s35, 0
    s_nop 0
    buffer_load_dwordx4 v6, s[8:11], s26 offen lds
    s_add_u32 m0, s35, 1024
    s_nop 0
    buffer_load_dwordx4 v7, s[8:11], s26 offen lds
    s_add_u32 m0, s35, 2048
    s_nop 0
    buffer_load_dwordx4 v8, s[8:11], s26 offen lds
    s_add_u32 m0, s35, 3072
    s_nop 0
    buffer_load_dwordx4 v9, s[8:11], s26 offen lds
    s_add_u32 m0, s35, 4096
    s_nop 0
    buffer_load_dwordx4 v10, s[8:11], s26 offen lds
    s_add_u32 m0, s35, 5120
    s_nop 0
    buffer_load_dwordx4 v11, s[8:11], s26 offen lds
    s_add_u32 m0, s35, 6144
    s_nop 0
    buffer_load_dwordx4 v12, s[8:11], s26 offen lds
    s_add_u32 m0, s35, 7168
    s_nop 0
    buffer_load_dwordx4 v13, s[8:11], s26 offen lds
    s_add_u32 m0, s35, 8192
    s_nop 0
    buffer_load_dwordx4 v14, s[8:11], s26 offen lds
    s_add_u32 m0, s35, 9216
    s_nop 0
    buffer_load_dwordx4 v15, s[8:11], s26 offen lds
    s_add_u32 m0, s35, 10240
    s_nop 0
    buffer_load_dwordx4 v16, s[8:11], s26 offen lds
    s_add_u32 m0, s35, 11264
    s_nop 0
    buffer_load_dwordx4 v17, s[8:11], s26 offen lds
    s_add_u32 m0, s35, 12288
    s_nop 0
    buffer_load_dwordx4 v18, s[8:11], s26 offen lds
    s_add_u32 m0, s35, 13312
    s_nop 0
    buffer_load_dwordx4 v19, s[8:11], s26 offen lds
    s_add_u32 s26, s26, 229376
    s_waitcnt vmcnt(14)
    ds_read_b64_tr_b16 a[8:9], v5 offset:14336
    ds_read_b64_tr_b16 a[10:11], v5 offset:14784
    ds_read_b64_tr_b16 a[12:13], v5 offset:17920
    ds_read_b64_tr_b16 a[14:15], v5 offset:18368
    ds_read_b64_tr_b16 a[64:65], v5 offset:14368
    ds_read_b64_tr_b16 a[66:67], v5 offset:14816
    ds_read_b64_tr_b16 a[68:69], v5 offset:17952
    ds_read_b64_tr_b16 a[70:71], v5 offset:18400
    s_waitcnt lgkmcnt(4)
    ds_read_b64_tr_b16 a[120:121], v5 offset:14400
    ds_read_b64_tr_b16 a[122:123], v5 offset:14848
    ds_read_b64_tr_b16 a[124:125], v5 offset:17984
    ds_read_b64_tr_b16 a[126:127], v5 offset:18432
    ds_read_b64_tr_b16 a[176:177], v5 offset:14432
    ds_read_b64_tr_b16 a[178:179], v5 offset:14880
    ds_read_b64_tr_b16 a[180:181], v5 offset:18016
    ds_read_b64_tr_b16 a[182:183], v5 offset:18464
    s_waitcnt lgkmcnt(4)
    ds_read_b64_tr_b16 a[232:233], v5 offset:14464
    ds_read_b64_tr_b16 a[234:235], v5 offset:14912
    ds_read_b64_tr_b16 a[236:237], v5 offset:18048
    ds_read_b64_tr_b16 a[238:239], v5 offset:18496
    ds_read_b64_tr_b16 v[152:153], v5 offset:14496
    ds_read_b64_tr_b16 v[154:155], v5 offset:14944
    ds_read_b64_tr_b16 v[156:157], v5 offset:18080
    ds_read_b64_tr_b16 v[158:159], v5 offset:18528
    s_waitcnt lgkmcnt(4)
    ds_read_b64_tr_b16 v[208:209], v5 offset:14528
    ds_read_b64_tr_b16 v[210:211], v5 offset:14976
    ds_read_b64_tr_b16 v[212:213], v5 offset:18112
    ds_read_b64_tr_b16 v[214:215], v5 offset:18560
    s_waitcnt lgkmcnt(0)
    s_add_u32 m0, s35, 14336
    s_nop 0
    buffer_load_dwordx4 v6, s[8:11], s26 offen lds
    s_add_u32 m0, s35, 15360
    s_nop 0
    buffer_load_dwordx4 v7, s[8:11], s26 offen lds
    s_add_u32 m0, s35, 16384
    s_nop 0
    buffer_load_dwordx4 v8, s[8:11], s26 offen lds
    s_add_u32 m0, s35, 17408
    s_nop 0
    buffer_load_dwordx4 v9, s[8:11], s26 offen lds
    s_add_u32 m0, s35, 18432
    s_nop 0
    buffer_load_dwordx4 v10, s[8:11], s26 offen lds
    s_add_u32 m0, s35, 19456
    s_nop 0
    buffer_load_dwordx4 v11, s[8:11], s26 offen lds
    s_add_u32 m0, s35, 20480
    s_nop 0
    buffer_load_dwordx4 v12, s[8:11], s26 offen lds
    s_add_u32 m0, s35, 21504
    s_nop 0
    buffer_load_dwordx4 v13, s[8:11], s26 offen lds
    s_add_u32 m0, s35, 22528
    s_nop 0
    buffer_load_dwordx4 v14, s[8:11], s26 offen lds
    s_add_u32 m0, s35, 23552
    s_nop 0
    buffer_load_dwordx4 v15, s[8:11], s26 offen lds
    s_add_u32 m0, s35, 24576
    s_nop 0
    buffer_load_dwordx4 v16, s[8:11], s26 offen lds
    s_add_u32 m0, s35, 25600
    s_nop 0
    buffer_load_dwordx4 v17, s[8:11], s26 offen lds
    s_add_u32 m0, s35, 26624
    s_nop 0
    buffer_load_dwordx4 v18, s[8:11], s26 offen lds
    s_add_u32 m0, s35, 27648
    s_nop 0
    buffer_load_dwordx4 v19, s[8:11], s26 offen lds
    s_add_u32 s26, s26, 229376
    s_waitcnt vmcnt(14)
    ds_read_b64_tr_b16 a[16:17], v5 offset:0
    ds_read_b64_tr_b16 a[18:19], v5 offset:448
    ds_read_b64_tr_b16 a[20:21], v5 offset:3584
    ds_read_b64_tr_b16 a[22:23], v5 offset:4032
    ds_read_b64_tr_b16 a[72:73], v5 offset:32
    ds_read_b64_tr_b16 a[74:75], v5 offset:480
    ds_read_b64_tr_b16 a[76:77], v5 offset:3616
    ds_read_b64_tr_b16 a[78:79], v5 offset:4064
    s_waitcnt lgkmcnt(4)
    ds_read_b64_tr_b16 a[128:129], v5 offset:64
    ds_read_b64_tr_b16 a[130:131], v5 offset:512
    ds_read_b64_tr_b16 a[132:133], v5 offset:3648
    ds_read_b64_tr_b16 a[134:135], v5 offset:4096
    ds_read_b64_tr_b16 a[184:185], v5 offset:96
    ds_read_b64_tr_b16 a[186:187], v5 offset:544
    ds_read_b64_tr_b16 a[188:189], v5 offset:3680
    ds_read_b64_tr_b16 a[190:191], v5 offset:4128
    s_waitcnt lgkmcnt(4)
    ds_read_b64_tr_b16 a[240:241], v5 offset:128
    ds_read_b64_tr_b16 a[242:243], v5 offset:576
    ds_read_b64_tr_b16 a[244:245], v5 offset:3712
    ds_read_b64_tr_b16 a[246:247], v5 offset:4160
    ds_read_b64_tr_b16 v[160:161], v5 offset:160
    ds_read_b64_tr_b16 v[162:163], v5 offset:608
    ds_read_b64_tr_b16 v[164:165], v5 offset:3744
    ds_read_b64_tr_b16 v[166:167], v5 offset:4192
    s_waitcnt lgkmcnt(4)
    ds_read_b64_tr_b16 v[216:217], v5 offset:192
    ds_read_b64_tr_b16 v[218:219], v5 offset:640
    ds_read_b64_tr_b16 v[220:221], v5 offset:3776
    ds_read_b64_tr_b16 v[222:223], v5 offset:4224
    s_waitcnt lgkmcnt(0)
    s_add_u32 m0, s35, 0
    s_nop 0
    buffer_load_dwordx4 v6, s[8:11], s26 offen lds
    s_add_u32 m0, s35, 1024
    s_nop 0
    buffer_load_dwordx4 v7, s[8:11], s26 offen lds
    s_add_u32 m0, s35, 2048
    s_nop 0
    buffer_load_dwordx4 v8, s[8:11], s26 offen lds
    s_add_u32 m0, s35, 3072
    s_nop 0
    buffer_load_dwordx4 v9, s[8:11], s26 offen lds
    s_add_u32 m0, s35, 4096
    s_nop 0
    buffer_load_dwordx4 v10, s[8:11], s26 offen lds
    s_add_u32 m0, s35, 5120
    s_nop 0
    buffer_load_dwordx4 v11, s[8:11], s26 offen lds
    s_add_u32 m0, s35, 6144
    s_nop 0
    buffer_load_dwordx4 v12, s[8:11], s26 offen lds
    s_add_u32 m0, s35, 7168
    s_nop 0
    buffer_load_dwordx4 v13, s[8:11], s26 offen lds
    s_add_u32 m0, s35, 8192
    s_nop 0
    buffer_load_dwordx4 v14, s[8:11], s26 offen lds
    s_add_u32 m0, s35, 9216
    s_nop 0
    buffer_load_dwordx4 v15, s[8:11], s26 offen lds
    s_add_u32 m0, s35, 10240
    s_nop 0
    buffer_load_dwordx4 v16, s[8:11], s26 offen lds
    s_add_u32 m0, s35, 11264
    s_nop 0
    buffer_load_dwordx4 v17, s[8:11], s26 offen lds
    s_add_u32 m0, s35, 12288
    s_nop 0
    buffer_load_dwordx4 v18, s[8:11], s26 offen lds
    s_add_u32 m0, s35, 13312
    s_nop 0
    buffer_load_dwordx4 v19, s[8:11], s26 offen lds
    s_add_u32 s26, s26, 229376
    s_waitcnt vmcnt(14)
    ds_read_b64_tr_b16 a[24:25], v5 offset:14336
    ds_read_b64_tr_b16 a[26:27], v5 offset:14784
    ds_read_b64_tr_b16 a[28:29], v5 offset:17920
    ds_read_b64_tr_b16 a[30:31], v5 offset:18368
    ds_read_b64_tr_b16 a[80:81], v5 offset:14368
    ds_read_b64_tr_b16 a[82:83], v5 offset:14816
    ds_read_b64_tr_b16 a[84:85], v5 offset:17952
    ds_read_b64_tr_b16 a[86:87], v5 offset:18400
    s_waitcnt lgkmcnt(4)
    ds_read_b64_tr_b16 a[136:137], v5 offset:14400
    ds_read_b64_tr_b16 a[138:139], v5 offset:14848
    ds_read_b64_tr_b16 a[140:141], v5 offset:17984
    ds_read_b64_tr_b16 a[142:143], v5 offset:18432
    ds_read_b64_tr_b16 a[192:193], v5 offset:14432
    ds_read_b64_tr_b16 a[194:195], v5 offset:14880
    ds_read_b64_tr_b16 a[196:197], v5 offset:18016
    ds_read_b64_tr_b16 a[198:199], v5 offset:18464
    s_waitcnt lgkmcnt(4)
    ds_read_b64_tr_b16 a[248:249], v5 offset:14464
    ds_read_b64_tr_b16 a[250:251], v5 offset:14912
    ds_read_b64_tr_b16 a[252:253], v5 offset:18048
    ds_read_b64_tr_b16 a[254:255], v5 offset:18496
    ds_read_b64_tr_b16 v[168:169], v5 offset:14496
    ds_read_b64_tr_b16 v[170:171], v5 offset:14944
    ds_read_b64_tr_b16 v[172:173], v5 offset:18080
    ds_read_b64_tr_b16 v[174:175], v5 offset:18528
    s_waitcnt lgkmcnt(4)
    ds_read_b64_tr_b16 v[224:225], v5 offset:14528
    ds_read_b64_tr_b16 v[226:227], v5 offset:14976
    ds_read_b64_tr_b16 v[228:229], v5 offset:18112
    ds_read_b64_tr_b16 v[230:231], v5 offset:18560
    s_waitcnt lgkmcnt(0)
    s_add_u32 m0, s35, 14336
    s_nop 0
    buffer_load_dwordx4 v6, s[8:11], s26 offen lds
    s_add_u32 m0, s35, 15360
    s_nop 0
    buffer_load_dwordx4 v7, s[8:11], s26 offen lds
    s_add_u32 m0, s35, 16384
    s_nop 0
    buffer_load_dwordx4 v8, s[8:11], s26 offen lds
    s_add_u32 m0, s35, 17408
    s_nop 0
    buffer_load_dwordx4 v9, s[8:11], s26 offen lds
    s_add_u32 m0, s35, 18432
    s_nop 0
    buffer_load_dwordx4 v10, s[8:11], s26 offen lds
    s_add_u32 m0, s35, 19456
    s_nop 0
    buffer_load_dwordx4 v11, s[8:11], s26 offen lds
    s_add_u32 m0, s35, 20480
    s_nop 0
    buffer_load_dwordx4 v12, s[8:11], s26 offen lds
    s_add_u32 m0, s35, 21504
    s_nop 0
    buffer_load_dwordx4 v13, s[8:11], s26 offen lds
    s_add_u32 m0, s35, 22528
    s_nop 0
    buffer_load_dwordx4 v14, s[8:11], s26 offen lds
    s_add_u32 m0, s35, 23552
    s_nop 0
    buffer_load_dwordx4 v15, s[8:11], s26 offen lds
    s_add_u32 m0, s35, 24576
    s_nop 0
    buffer_load_dwordx4 v16, s[8:11], s26 offen lds
    s_add_u32 m0, s35, 25600
    s_nop 0
    buffer_load_dwordx4 v17, s[8:11], s26 offen lds
    s_add_u32 m0, s35, 26624
    s_nop 0
    buffer_load_dwordx4 v18, s[8:11], s26 offen lds
    s_add_u32 m0, s35, 27648
    s_nop 0
    buffer_load_dwordx4 v19, s[8:11], s26 offen lds
    s_add_u32 s26, s26, 229376
    s_waitcnt vmcnt(14)
    ds_read_b64_tr_b16 a[32:33], v5 offset:0
    ds_read_b64_tr_b16 a[34:35], v5 offset:448
    ds_read_b64_tr_b16 a[36:37], v5 offset:3584
    ds_read_b64_tr_b16 a[38:39], v5 offset:4032
    ds_read_b64_tr_b16 a[88:89], v5 offset:32
    ds_read_b64_tr_b16 a[90:91], v5 offset:480
    ds_read_b64_tr_b16 a[92:93], v5 offset:3616
    ds_read_b64_tr_b16 a[94:95], v5 offset:4064
    s_waitcnt lgkmcnt(4)
    ds_read_b64_tr_b16 a[144:145], v5 offset:64
    ds_read_b64_tr_b16 a[146:147], v5 offset:512
    ds_read_b64_tr_b16 a[148:149], v5 offset:3648
    ds_read_b64_tr_b16 a[150:151], v5 offset:4096
    ds_read_b64_tr_b16 a[200:201], v5 offset:96
    ds_read_b64_tr_b16 a[202:203], v5 offset:544
    ds_read_b64_tr_b16 a[204:205], v5 offset:3680
    ds_read_b64_tr_b16 a[206:207], v5 offset:4128
    s_waitcnt lgkmcnt(4)
    ds_read_b64_tr_b16 v[120:121], v5 offset:128
    ds_read_b64_tr_b16 v[122:123], v5 offset:576
    ds_read_b64_tr_b16 v[124:125], v5 offset:3712
    ds_read_b64_tr_b16 v[126:127], v5 offset:4160
    ds_read_b64_tr_b16 v[176:177], v5 offset:160
    ds_read_b64_tr_b16 v[178:179], v5 offset:608
    ds_read_b64_tr_b16 v[180:181], v5 offset:3744
    ds_read_b64_tr_b16 v[182:183], v5 offset:4192
    s_waitcnt lgkmcnt(4)
    ds_read_b64_tr_b16 v[232:233], v5 offset:192
    ds_read_b64_tr_b16 v[234:235], v5 offset:640
    ds_read_b64_tr_b16 v[236:237], v5 offset:3776
    ds_read_b64_tr_b16 v[238:239], v5 offset:4224
    s_waitcnt lgkmcnt(0)
    s_add_u32 m0, s35, 0
    s_nop 0
    buffer_load_dwordx4 v6, s[8:11], s26 offen lds
    s_add_u32 m0, s35, 1024
    s_nop 0
    buffer_load_dwordx4 v7, s[8:11], s26 offen lds
    s_add_u32 m0, s35, 2048
    s_nop 0
    buffer_load_dwordx4 v8, s[8:11], s26 offen lds
    s_add_u32 m0, s35, 3072
    s_nop 0
    buffer_load_dwordx4 v9, s[8:11], s26 offen lds
    s_add_u32 m0, s35, 4096
    s_nop 0
    buffer_load_dwordx4 v10, s[8:11], s26 offen lds
    s_add_u32 m0, s35, 5120
    s_nop 0
    buffer_load_dwordx4 v11, s[8:11], s26 offen lds
    s_add_u32 m0, s35, 6144
    s_nop 0
    buffer_load_dwordx4 v12, s[8:11], s26 offen lds
    s_add_u32 m0, s35, 7168
    s_nop 0
    buffer_load_dwordx4 v13, s[8:11], s26 offen lds
    s_add_u32 m0, s35, 8192
    s_nop 0
    buffer_load_dwordx4 v14, s[8:11], s26 offen lds
    s_add_u32 m0, s35, 9216
    s_nop 0
    buffer_load_dwordx4 v15, s[8:11], s26 offen lds
    s_add_u32 m0, s35, 10240
    s_nop 0
    buffer_load_dwordx4 v16, s[8:11], s26 offen lds
    s_add_u32 m0, s35, 11264
    s_nop 0
    buffer_load_dwordx4 v17, s[8:11], s26 offen lds
    s_add_u32 m0, s35, 12288
    s_nop 0
    buffer_load_dwordx4 v18, s[8:11], s26 offen lds
    s_add_u32 m0, s35, 13312
    s_nop 0
    buffer_load_dwordx4 v19, s[8:11], s26 offen lds
    s_add_u32 s26, s26, 229376
    s_waitcnt vmcnt(14)
    ds_read_b64_tr_b16 a[40:41], v5 offset:14336
    ds_read_b64_tr_b16 a[42:43], v5 offset:14784
    ds_read_b64_tr_b16 a[44:45], v5 offset:17920
    ds_read_b64_tr_b16 a[46:47], v5 offset:18368
    ds_read_b64_tr_b16 a[96:97], v5 offset:14368
    ds_read_b64_tr_b16 a[98:99], v5 offset:14816
    ds_read_b64_tr_b16 a[100:101], v5 offset:17952
    ds_read_b64_tr_b16 a[102:103], v5 offset:18400
    s_waitcnt lgkmcnt(4)
    ds_read_b64_tr_b16 a[152:153], v5 offset:14400
    ds_read_b64_tr_b16 a[154:155], v5 offset:14848
    ds_read_b64_tr_b16 a[156:157], v5 offset:17984
    ds_read_b64_tr_b16 a[158:159], v5 offset:18432
    ds_read_b64_tr_b16 a[208:209], v5 offset:14432
    ds_read_b64_tr_b16 a[210:211], v5 offset:14880
    ds_read_b64_tr_b16 a[212:213], v5 offset:18016
    ds_read_b64_tr_b16 a[214:215], v5 offset:18464
    s_waitcnt lgkmcnt(4)
    ds_read_b64_tr_b16 v[128:129], v5 offset:14464
    ds_read_b64_tr_b16 v[130:131], v5 offset:14912
    ds_read_b64_tr_b16 v[132:133], v5 offset:18048
    ds_read_b64_tr_b16 v[134:135], v5 offset:18496
    ds_read_b64_tr_b16 v[184:185], v5 offset:14496
    ds_read_b64_tr_b16 v[186:187], v5 offset:14944
    ds_read_b64_tr_b16 v[188:189], v5 offset:18080
    ds_read_b64_tr_b16 v[190:191], v5 offset:18528
    s_waitcnt lgkmcnt(4)
    ds_read_b64_tr_b16 v[240:241], v5 offset:14528
    ds_read_b64_tr_b16 v[242:243], v5 offset:14976
    ds_read_b64_tr_b16 v[244:245], v5 offset:18112
    ds_read_b64_tr_b16 v[246:247], v5 offset:18560
    s_waitcnt lgkmcnt(0)
    s_waitcnt vmcnt(0)
    ds_read_b64_tr_b16 a[48:49], v5 offset:0
    ds_read_b64_tr_b16 a[50:51], v5 offset:448
    ds_read_b64_tr_b16 a[52:53], v5 offset:3584
    ds_read_b64_tr_b16 a[54:55], v5 offset:4032
    ds_read_b64_tr_b16 a[104:105], v5 offset:32
    ds_read_b64_tr_b16 a[106:107], v5 offset:480
    ds_read_b64_tr_b16 a[108:109], v5 offset:3616
    ds_read_b64_tr_b16 a[110:111], v5 offset:4064
    s_waitcnt lgkmcnt(4)
    ds_read_b64_tr_b16 a[160:161], v5 offset:64
    ds_read_b64_tr_b16 a[162:163], v5 offset:512
    ds_read_b64_tr_b16 a[164:165], v5 offset:3648
    ds_read_b64_tr_b16 a[166:167], v5 offset:4096
    ds_read_b64_tr_b16 a[216:217], v5 offset:96
    ds_read_b64_tr_b16 a[218:219], v5 offset:544
    ds_read_b64_tr_b16 a[220:221], v5 offset:3680
    ds_read_b64_tr_b16 a[222:223], v5 offset:4128
    s_waitcnt lgkmcnt(4)
    ds_read_b64_tr_b16 v[136:137], v5 offset:128
    ds_read_b64_tr_b16 v[138:139], v5 offset:576
    ds_read_b64_tr_b16 v[140:141], v5 offset:3712
    ds_read_b64_tr_b16 v[142:143], v5 offset:4160
    ds_read_b64_tr_b16 v[192:193], v5 offset:160
    ds_read_b64_tr_b16 v[194:195], v5 offset:608
    ds_read_b64_tr_b16 v[196:197], v5 offset:3744
    ds_read_b64_tr_b16 v[198:199], v5 offset:4192
    s_waitcnt lgkmcnt(4)
    ds_read_b64_tr_b16 v[248:249], v5 offset:192
    ds_read_b64_tr_b16 v[250:251], v5 offset:640
    ds_read_b64_tr_b16 v[252:253], v5 offset:3776
    ds_read_b64_tr_b16 v[254:255], v5 offset:4224
    s_waitcnt lgkmcnt(0)
    s_barrier
    s_cmp_lg_u32 s20, 0
    s_cbranch_scc1 L_one_157
    v_and_b32 v5, 63, v1
    v_lshlrev_b32 v5, 2, v5
L_Hi_158:
    s_sub_u32 s23, s23, 1
    s_cbranch_scc1 M_exit
    s_mov_b32 s63, 0x3fcc000
    buffer_load_dword v2, v5, s[4:7], s63 offen sc1
    buffer_load_dword v3, v5, s[4:7], s63 offen offset:256 sc1
    s_waitcnt vmcnt(0)
    v_min_u32 v2, v2, v3
    v_cmp_eq_u32 vcc, 0, v2
    s_cbranch_vccnz L_Hi_158
L_one_157:
    s_barrier
    s_lshl_b32 s26, s25, 2
    s_add_u32 s26, s26, 0x1142000
    s_mul_i32 s27, s24, 28672
    s_mul_i32 s28, s20, 7168
    s_add_u32 s27, s27, s28
    s_add_u32 s27, s27, 0xe00000
    s_mov_b32 m0, s28
    s_add_u32 s63, s27, 4096
    buffer_load_dwordx4 v104, s[4:7], s27 offen offset:0 lds
    buffer_load_dwordx4 v104, s[4:7], s27 offen offset:1024 lds
    buffer_load_dwordx4 v104, s[4:7], s27 offen offset:2048 lds
    buffer_load_dwordx4 v104, s[4:7], s27 offen offset:3072 lds
    s_add_u32 m0, s28, 4096
    s_nop 0
    buffer_load_dwordx4 v104, s[4:7], s63 offen offset:0 lds
    buffer_load_dwordx4 v104, s[4:7], s63 offen offset:1024 lds
    buffer_load_dwordx4 v104, s[4:7], s63 offen offset:2048 lds
    v_mov_b32 v105, v104
    s_lshl_b32 s30, s24, 6
    s_add_u32 s30, s30, s26
    s_mov_b32 s31, 0x1145000
    s_mul_i32 s29, s24, 0x1c000
    s_mul_i32 s32, s25, 28672
    s_add_u32 s29, s29, s32
    s_add_u32 s29, s29, 0x36c8000
    s_mul_i32 s33, s20, 3072
    s_lshr_b32 s34, s20, 1
    s_lshl_b32 s34, s34, 10
    s_and_b32 s32, s20, 1
    s_lshl_b32 s32, s32, 3
    s_add_u32 s34, s34, s32
    s_add_u32 s34, s34, 12288
    s_mov_b32 s35, 0xbfb8aa3b
RH_top:
    s_waitcnt vmcnt(0)
    s_barrier
    s_cmp_lg_u32 s20, 0
    s_cbranch_scc1 RH_nf
    v_mov_b32 v56, 1
    s_mov_b64 exec, 1
    buffer_store_dword v56, off, s[4:7], s31 sc1
    s_mov_b64 exec, -1
RH_nf:
    s_cmp_ge_u32 s24, 64
    s_cbranch_scc1 M_exit
    s_add_u32 s27, s27, 229376
    s_xor_b32 s28, s28, 32768
    s_cmp_ge_u32 s24, 56
    s_cbranch_scc1 RH_nd
    s_mov_b32 m0, s28
    s_add_u32 s63, s27, 4096
    buffer_load_dwordx4 v104, s[4:7], s27 offen offset:0 lds
    buffer_load_dwordx4 v104, s[4:7], s27 offen offset:1024 lds
    buffer_load_dwordx4 v104, s[4:7], s27 offen offset:2048 lds
    buffer_load_dwordx4 v104, s[4:7], s27 offen offset:3072 lds
    s_add_u32 m0, s28, 4096
    s_nop 0
    buffer_load_dwordx4 v104, s[4:7], s63 offen offset:0 lds
    buffer_load_dwordx4 v104, s[4:7], s63 offen offset:1024 lds
    buffer_load_dwordx4 v104, s[4:7], s63 offen offset:2048 lds
RH_nd:
    ds_read_b128 v[56:59], v105 offset:0
    ds_read_b128 v[60:63], v105 offset:14336
    ds_read_b128 v[64:67], v105 offset:1024
    ds_read_b128 v[68:71], v105 offset:15360
    s_waitcnt lgkmcnt(2)
    v_mfma_f32_16x16x32_bf16 v[0:3], a[0:3], v[56:59], 0
    v_mfma_f32_16x16x32_bf16 v[4:7], a[0:3], v[60:63], 0
    v_mfma_f32_16x16x32_bf16 v[8:11], a[56:59], v[56:59], 0
    v_mfma_f32_16x16x32_bf16 v[12:15], a[56:59], v[60:63], 0
    v_mfma_f32_16x16x32_bf16 v[16:19], a[112:115], v[56:59], 0
    v_mfma_f32_16x16x32_bf16 v[20:23], a[112:115], v[60:63], 0
    v_mfma_f32_16x16x32_bf16 v[24:27], a[168:171], v[56:59], 0
    v_mfma_f32_16x16x32_bf16 v[28:31], a[168:171], v[60:63], 0
    v_mfma_f32_16x16x32_bf16 v[32:35], a[224:227], v[56:59], 0
    v_mfma_f32_16x16x32_bf16 v[36:39], a[224:227], v[60:63], 0
    v_mfma_f32_16x16x32_bf16 v[40:43], v[144:147], v[56:59], 0
    v_mfma_f32_16x16x32_bf16 v[44:47], v[144:147], v[60:63], 0
    v_mfma_f32_16x16x32_bf16 v[48:51], v[200:203], v[56:59], 0
    v_mfma_f32_16x16x32_bf16 v[52:55], v[200:203], v[60:63], 0
    ds_read_b128 v[56:59], v105 offset:2048
    ds_read_b128 v[60:63], v105 offset:16384
    s_waitcnt lgkmcnt(2)
    v_mfma_f32_16x16x32_bf16 v[0:3], a[4:7], v[64:67], v[0:3]
    v_mfma_f32_16x16x32_bf16 v[4:7], a[4:7], v[68:71], v[4:7]
    v_mfma_f32_16x16x32_bf16 v[8:11], a[60:63], v[64:67], v[8:11]
    v_mfma_f32_16x16x32_bf16 v[12:15], a[60:63], v[68:71], v[12:15]
    v_mfma_f32_16x16x32_bf16 v[16:19], a[116:119], v[64:67], v[16:19]
    v_mfma_f32_16x16x32_bf16 v[20:23], a[116:119], v[68:71], v[20:23]
    v_mfma_f32_16x16x32_bf16 v[24:27], a[172:175], v[64:67], v[24:27]
    v_mfma_f32_16x16x32_bf16 v[28:31], a[172:175], v[68:71], v[28:31]
    v_mfma_f32_16x16x32_bf16 v[32:35], a[228:231], v[64:67], v[32:35]
    v_mfma_f32_16x16x32_bf16 v[36:39], a[228:231], v[68:71], v[36:39]
    v_mfma_f32_16x16x32_bf16 v[40:43], v[148:151], v[64:67], v[40:43]
    v_mfma_f32_16x16x32_bf16 v[44:47], v[148:151], v[68:71], v[44:47]
    v_mfma_f32_16x16x32_bf16 v[48:51], v[204:207], v[64:67], v[48:51]
    v_mfma_f32_16x16x32_bf16 v[52:55], v[204:207], v[68:71], v[52:55]
    ds_read_b128 v[64:67], v105 offset:3072
    ds_read_b128 v[68:71], v105 offset:17408
    s_waitcnt lgkmcnt(2)
    v_mfma_f32_16x16x32_bf16 v[0:3], a[8:11], v[56:59], v[0:3]
    v_mfma_f32_16x16x32_bf16 v[4:7], a[8:11], v[60:63], v[4:7]
    v_mfma_f32_16x16x32_bf16 v[8:11], a[64:67], v[56:59], v[8:11]
    v_mfma_f32_16x16x32_bf16 v[12:15], a[64:67], v[60:63], v[12:15]
    v_mfma_f32_16x16x32_bf16 v[16:19], a[120:123], v[56:59], v[16:19]
    v_mfma_f32_16x16x32_bf16 v[20:23], a[120:123], v[60:63], v[20:23]
    v_mfma_f32_16x16x32_bf16 v[24:27], a[176:179], v[56:59], v[24:27]
    v_mfma_f32_16x16x32_bf16 v[28:31], a[176:179], v[60:63], v[28:31]
    v_mfma_f32_16x16x32_bf16 v[32:35], a[232:235], v[56:59], v[32:35]
    v_mfma_f32_16x16x32_bf16 v[36:39], a[232:235], v[60:63], v[36:39]
    v_mfma_f32_16x16x32_bf16 v[40:43], v[152:155], v[56:59], v[40:43]
    v_mfma_f32_16x16x32_bf16 v[44:47], v[152:155], v[60:63], v[44:47]
    v_mfma_f32_16x16x32_bf16 v[48:51], v[208:211], v[56:59], v[48:51]
    v_mfma_f32_16x16x32_bf16 v[52:55], v[208:211], v[60:63], v[52:55]
    ds_read_b128 v[56:59], v105 offset:4096
    ds_read_b128 v[60:63], v105 offset:18432
    s_waitcnt lgkmcnt(2)
    v_mfma_f32_16x16x32_bf16 v[0:3], a[12:15], v[64:67], v[0:3]
    v_mfma_f32_16x16x32_bf16 v[4:7], a[12:15], v[68:71], v[4:7]
    v_mfma_f32_16x16x32_bf16 v[8:11], a[68:71], v[64:67], v[8:11]
    v_mfma_f32_16x16x32_bf16 v[12:15], a[68:71], v[68:71], v[12:15]
    v_mfma_f32_16x16x32_bf16 v[16:19], a[124:127], v[64:67], v[16:19]
    v_mfma_f32_16x16x32_bf16 v[20:23], a[124:127], v[68:71], v[20:23]
    v_mfma_f32_16x16x32_bf16 v[24:27], a[180:183], v[64:67], v[24:27]
    v_mfma_f32_16x16x32_bf16 v[28:31], a[180:183], v[68:71], v[28:31]
    v_mfma_f32_16x16x32_bf16 v[32:35], a[236:239], v[64:67], v[32:35]
    v_mfma_f32_16x16x32_bf16 v[36:39], a[236:239], v[68:71], v[36:39]
    v_mfma_f32_16x16x32_bf16 v[40:43], v[156:159], v[64:67], v[40:43]
    v_mfma_f32_16x16x32_bf16 v[44:47], v[156:159], v[68:71], v[44:47]
    v_mfma_f32_16x16x32_bf16 v[48:51], v[212:215], v[64:67], v[48:51]
    v_mfma_f32_16x16x32_bf16 v[52:55], v[212:215], v[68:71], v[52:55]
    ds_read_b128 v[64:67], v105 offset:5120
    ds_read_b128 v[68:71], v105 offset:19456
    s_waitcnt lgkmcnt(2)
    v_mfma_f32_16x16x32_bf16 v[0:3], a[16:19], v[56:59], v[0:3]
    v_mfma_f32_16x16x32_bf16 v[4:7], a[16:19], v[60:63], v[4:7]
    v_mfma_f32_16x16x32_bf16 v[8:11], a[72:75], v[56:59], v[8:11]
    v_mfma_f32_16x16x32_bf16 v[12:15], a[72:75], v[60:63], v[12:15]
    v_mfma_f32_16x16x32_bf16 v[16:19], a[128:131], v[56:59], v[16:19]
    v_mfma_f32_16x16x32_bf16 v[20:23], a[128:131], v[60:63], v[20:23]
    v_mfma_f32_16x16x32_bf16 v[24:27], a[184:187], v[56:59], v[24:27]
    v_mfma_f32_16x16x32_bf16 v[28:31], a[184:187], v[60:63], v[28:31]
    v_mfma_f32_16x16x32_bf16 v[32:35], a[240:243], v[56:59], v[32:35]
    v_mfma_f32_16x16x32_bf16 v[36:39], a[240:243], v[60:63], v[36:39]
    v_mfma_f32_16x16x32_bf16 v[40:43], v[160:163], v[56:59], v[40:43]
    v_mfma_f32_16x16x32_bf16 v[44:47], v[160:163], v[60:63], v[44:47]
    v_mfma_f32_16x16x32_bf16 v[48:51], v[216:219], v[56:59], v[48:51]
    v_mfma_f32_16x16x32_bf16 v[52:55], v[216:219], v[60:63], v[52:55]
    ds_read_b128 v[56:59], v105 offset:6144
    ds_read_b128 v[60:63], v105 offset:20480
    s_waitcnt lgkmcnt(2)
    v_mfma_f32_16x16x32_bf16 v[0:3], a[20:23], v[64:67], v[0:3]
    v_mfma_f32_16x16x32_bf16 v[4:7], a[20:23], v[68:71], v[4:7]
    v_mfma_f32_16x16x32_bf16 v[8:11], a[76:79], v[64:67], v[8:11]
    v_mfma_f32_16x16x32_bf16 v[12:15], a[76:79], v[68:71], v[12:15]
    v_mfma_f32_16x16x32_bf16 v[16:19], a[132:135], v[64:67], v[16:19]
    v_mfma_f32_16x16x32_bf16 v[20:23], a[132:135], v[68:71], v[20:23]
    v_mfma_f32_16x16x32_bf16 v[24:27], a[188:191], v[64:67], v[24:27]
    v_mfma_f32_16x16x32_bf16 v[28:31], a[188:191], v[68:71], v[28:31]
    v_mfma_f32_16x16x32_bf16 v[32:35], a[244:247], v[64:67], v[32:35]
    v_mfma_f32_16x16x32_bf16 v[36:39], a[244:247], v[68:71], v[36:39]
    v_mfma_f32_16x16x32_bf16 v[40:43], v[164:167], v[64:67], v[40:43]
    v_mfma_f32_16x16x32_bf16 v[44:47], v[164:167], v[68:71], v[44:47]
    v_mfma_f32_16x16x32_bf16 v[48:51], v[220:223], v[64:67], v[48:51]
    v_mfma_f32_16x16x32_bf16 v[52:55], v[220:223], v[68:71], v[52:55]
    ds_read_b128 v[64:67], v105 offset:7168
    ds_read_b128 v[68:71], v105 offset:21504
    s_waitcnt lgkmcnt(2)
    v_mfma_f32_16x16x32_bf16 v[0:3], a[24:27], v[56:59], v[0:3]
    v_mfma_f32_16x16x32_bf16 v[4:7], a[24:27], v[60:63], v[4:7]
    v_mfma_f32_16x16x32_bf16 v[8:11], a[80:83], v[56:59], v[8:11]
    v_mfma_f32_16x16x32_bf16 v[12:15], a[80:83], v[60:63], v[12:15]
    v_mfma_f32_16x16x32_bf16 v[16:19], a[136:139], v[56:59], v[16:19]
    v_mfma_f32_16x16x32_bf16 v[20:23], a[136:139], v[60:63], v[20:23]
    v_mfma_f32_16x16x32_bf16 v[24:27], a[192:195], v[56:59], v[24:27]
    v_mfma_f32_16x16x32_bf16 v[28:31], a[192:195], v[60:63], v[28:31]
    v_mfma_f32_16x16x32_bf16 v[32:35], a[248:251], v[56:59], v[32:35]
    v_mfma_f32_16x16x32_bf16 v[36:39], a[248:251], v[60:63], v[36:39]
    v_mfma_f32_16x16x32_bf16 v[40:43], v[168:171], v[56:59], v[40:43]
    v_mfma_f32_16x16x32_bf16 v[44:47], v[168:171], v[60:63], v[44:47]
    v_mfma_f32_16x16x32_bf16 v[48:51], v[224:227], v[56:59], v[48:51]
    v_mfma_f32_16x16x32_bf16 v[52:55], v[224:227], v[60:63], v[52:55]
    ds_read_b128 v[56:59], v105 offset:8192
    ds_read_b128 v[60:63], v105 offset:22528
    s_waitcnt lgkmcnt(2)
    v_mfma_f32_16x16x32_bf16 v[0:3], a[28:31], v[64:67], v[0:3]
    v_mfma_f32_16x16x32_bf16 v[4:7], a[28:31], v[68:71], v[4:7]
    v_mfma_f32_16x16x32_bf16 v[8:11], a[84:87], v[64:67], v[8:11]
    v_mfma_f32_16x16x32_bf16 v[12:15], a[84:87], v[68:71], v[12:15]
    v_mfma_f32_16x16x32_bf16 v[16:19], a[140:143], v[64:67], v[16:19]
    v_mfma_f32_16x16x32_bf16 v[20:23], a[140:143], v[68:71], v[20:23]
    v_mfma_f32_16x16x32_bf16 v[24:27], a[196:199], v[64:67], v[24:27]
    v_mfma_f32_16x16x32_bf16 v[28:31], a[196:199], v[68:71], v[28:31]
    v_mfma_f32_16x16x32_bf16 v[32:35], a[252:255], v[64:67], v[32:35]
    v_mfma_f32_16x16x32_bf16 v[36:39], a[252:255], v[68:71], v[36:39]
    v_mfma_f32_16x16x32_bf16 v[40:43], v[172:175], v[64:67], v[40:43]
    v_mfma_f32_16x16x32_bf16 v[44:47], v[172:175], v[68:71], v[44:47]
    v_mfma_f32_16x16x32_bf16 v[48:51], v[228:231], v[64:67], v[48:51]
    v_mfma_f32_16x16x32_bf16 v[52:55], v[228:231], v[68:71], v[52:55]
    ds_read_b128 v[64:67], v105 offset:9216
    ds_read_b128 v[68:71], v105 offset:23552
    s_waitcnt lgkmcnt(2)
    v_mfma_f32_16x16x32_bf16 v[0:3], a[32:35], v[56:59], v[0:3]
    v_mfma_f32_16x16x32_bf16 v[4:7], a[32:35], v[60:63], v[4:7]
    v_mfma_f32_16x16x32_bf16 v[8:11], a[88:91], v[56:59], v[8:11]
    v_mfma_f32_16x16x32_bf16 v[12:15], a[88:91], v[60:63], v[12:15]
    v_mfma_f32_16x16x32_bf16 v[16:19], a[144:147], v[56:59], v[16:19]
    v_mfma_f32_16x16x32_bf16 v[20:23], a[144:147], v[60:63], v[20:23]
    v_mfma_f32_16x16x32_bf16 v[24:27], a[200:203], v[56:59], v[24:27]
    v_mfma_f32_16x16x32_bf16 v[28:31], a[200:203], v[60:63], v[28:31]
    v_mfma_f32_16x16x32_bf16 v[32:35], v[120:123], v[56:59], v[32:35]
    v_mfma_f32_16x16x32_bf16 v[36:39], v[120:123], v[60:63], v[36:39]
    v_mfma_f32_16x16x32_bf16 v[40:43], v[176:179], v[56:59], v[40:43]
    v_mfma_f32_16x16x32_bf16 v[44:47], v[176:179], v[60:63], v[44:47]
    v_mfma_f32_16x16x32_bf16 v[48:51], v[232:235], v[56:59], v[48:51]
    v_mfma_f32_16x16x32_bf16 v[52:55], v[232:235], v[60:63], v[52:55]
    ds_read_b128 v[56:59], v105 offset:10240
    ds_read_b128 v[60:63], v105 offset:24576
    s_waitcnt lgkmcnt(2)
    v_mfma_f32_16x16x32_bf16 v[0:3], a[36:39], v[64:67], v[0:3]
    v_mfma_f32_16x16x32_bf16 v[4:7], a[36:39], v[68:71], v[4:7]
    v_mfma_f32_16x16x32_bf16 v[8:11], a[92:95], v[64:67], v[8:11]
    v_mfma_f32_16x16x32_bf16 v[12:15], a[92:95], v[68:71], v[12:15]
    v_mfma_f32_16x16x32_bf16 v[16:19], a[148:151], v[64:67], v[16:19]
    v_mfma_f32_16x16x32_bf16 v[20:23], a[148:151], v[68:71], v[20:23]
    v_mfma_f32_16x16x32_bf16 v[24:27], a[204:207], v[64:67], v[24:27]
    v_mfma_f32_16x16x32_bf16 v[28:31], a[204:207], v[68:71], v[28:31]
    v_mfma_f32_16x16x32_bf16 v[32:35], v[124:127], v[64:67], v[32:35]
    v_mfma_f32_16x16x32_bf16 v[36:39], v[124:127], v[68:71], v[36:39]
    v_mfma_f32_16x16x32_bf16 v[40:43], v[180:183], v[64:67], v[40:43]
    v_mfma_f32_16x16x32_bf16 v[44:47], v[180:183], v[68:71], v[44:47]
    v_mfma_f32_16x16x32_bf16 v[48:51], v[236:239], v[64:67], v[48:51]
    v_mfma_f32_16x16x32_bf16 v[52:55], v[236:239], v[68:71], v[52:55]
    ds_read_b128 v[64:67], v105 offset:11264
    ds_read_b128 v[68:71], v105 offset:25600
    s_waitcnt lgkmcnt(2)
    v_mfma_f32_16x16x32_bf16 v[0:3], a[40:43], v[56:59], v[0:3]
    v_mfma_f32_16x16x32_bf16 v[4:7], a[40:43], v[60:63], v[4:7]
    v_mfma_f32_16x16x32_bf16 v[8:11], a[96:99], v[56:59], v[8:11]
    v_mfma_f32_16x16x32_bf16 v[12:15], a[96:99], v[60:63], v[12:15]
    v_mfma_f32_16x16x32_bf16 v[16:19], a[152:155], v[56:59], v[16:19]
    v_mfma_f32_16x16x32_bf16 v[20:23], a[152:155], v[60:63], v[20:23]
    v_mfma_f32_16x16x32_bf16 v[24:27], a[208:211], v[56:59], v[24:27]
    v_mfma_f32_16x16x32_bf16 v[28:31], a[208:211], v[60:63], v[28:31]
    v_mfma_f32_16x16x32_bf16 v[32:35], v[128:131], v[56:59], v[32:35]
    v_mfma_f32_16x16x32_bf16 v[36:39], v[128:131], v[60:63], v[36:39]
    v_mfma_f32_16x16x32_bf16 v[40:43], v[184:187], v[56:59], v[40:43]
    v_mfma_f32_16x16x32_bf16 v[44:47], v[184:187], v[60:63], v[44:47]
    v_mfma_f32_16x16x32_bf16 v[48:51], v[240:243], v[56:59], v[48:51]
    v_mfma_f32_16x16x32_bf16 v[52:55], v[240:243], v[60:63], v[52:55]
    ds_read_b128 v[56:59], v105 offset:12288
    ds_read_b128 v[60:63], v105 offset:26624
    s_waitcnt lgkmcnt(2)
    v_mfma_f32_16x16x32_bf16 v[0:3], a[44:47], v[64:67], v[0:3]
    v_mfma_f32_16x16x32_bf16 v[4:7], a[44:47], v[68:71], v[4:7]
    v_mfma_f32_16x16x32_bf16 v[8:11], a[100:103], v[64:67], v[8:11]
    v_mfma_f32_16x16x32_bf16 v[12:15], a[100:103], v[68:71], v[12:15]
    v_mfma_f32_16x16x32_bf16 v[16:19], a[156:159], v[64:67], v[16:19]
    v_mfma_f32_16x16x32_bf16 v[20:23], a[156:159], v[68:71], v[20:23]
    v_mfma_f32_16x16x32_bf16 v[24:27], a[212:215], v[64:67], v[24:27]
    v_mfma_f32_16x16x32_bf16 v[28:31], a[212:215], v[68:71], v[28:31]
    v_mfma_f32_16x16x32_bf16 v[32:35], v[132:135], v[64:67], v[32:35]
    v_mfma_f32_16x16x32_bf16 v[36:39], v[132:135], v[68:71], v[36:39]
    v_mfma_f32_16x16x32_bf16 v[40:43], v[188:191], v[64:67], v[40:43]
    v_mfma_f32_16x16x32_bf16 v[44:47], v[188:191], v[68:71], v[44:47]
    v_mfma_f32_16x16x32_bf16 v[48:51], v[244:247], v[64:67], v[48:51]
    v_mfma_f32_16x16x32_bf16 v[52:55], v[244:247], v[68:71], v[52:55]
    ds_read_b128 v[64:67], v105 offset:13312
    ds_read_b128 v[68:71], v105 offset:27648
    s_waitcnt lgkmcnt(2)
    v_mfma_f32_16x16x32_bf16 v[0:3], a[48:51], v[56:59], v[0:3]
    v_mfma_f32_16x16x32_bf16 v[4:7], a[48:51], v[60:63], v[4:7]
    v_mfma_f32_16x16x32_bf16 v[8:11], a[104:107], v[56:59], v[8:11]
    v_mfma_f32_16x16x32_bf16 v[12:15], a[104:107], v[60:63], v[12:15]
    v_mfma_f32_16x16x32_bf16 v[16:19], a[160:163], v[56:59], v[16:19]
    v_mfma_f32_16x16x32_bf16 v[20:23], a[160:163], v[60:63], v[20:23]
    v_mfma_f32_16x16x32_bf16 v[24:27], a[216:219], v[56:59], v[24:27]
    v_mfma_f32_16x16x32_bf16 v[28:31], a[216:219], v[60:63], v[28:31]
    v_mfma_f32_16x16x32_bf16 v[32:35], v[136:139], v[56:59], v[32:35]
    v_mfma_f32_16x16x32_bf16 v[36:39], v[136:139], v[60:63], v[36:39]
    v_mfma_f32_16x16x32_bf16 v[40:43], v[192:195], v[56:59], v[40:43]
    v_mfma_f32_16x16x32_bf16 v[44:47], v[192:195], v[60:63], v[44:47]
    v_mfma_f32_16x16x32_bf16 v[48:51], v[248:251], v[56:59], v[48:51]
    v_mfma_f32_16x16x32_bf16 v[52:55], v[248:251], v[60:63], v[52:55]
    s_waitcnt lgkmcnt(0)
    v_mfma_f32_16x16x32_bf16 v[0:3], a[52:55], v[64:67], v[0:3]
    v_mfma_f32_16x16x32_bf16 v[4:7], a[52:55], v[68:71], v[4:7]
    v_mfma_f32_16x16x32_bf16 v[8:11], a[108:111], v[64:67], v[8:11]
    v_mfma_f32_16x16x32_bf16 v[12:15], a[108:111], v[68:71], v[12:15]
    v_mfma_f32_16x16x32_bf16 v[16:19], a[164:167], v[64:67], v[16:19]
    v_mfma_f32_16x16x32_bf16 v[20:23], a[164:167], v[68:71], v[20:23]
    v_mfma_f32_16x16x32_bf16 v[24:27], a[220:223], v[64:67], v[24:27]
    v_mfma_f32_16x16x32_bf16 v[28:31], a[220:223], v[68:71], v[28:31]
    v_mfma_f32_16x16x32_bf16 v[32:35], v[140:143], v[64:67], v[32:35]
    v_mfma_f32_16x16x32_bf16 v[36:39], v[140:143], v[68:71], v[36:39]
    v_mfma_f32_16x16x32_bf16 v[40:43], v[196:199], v[64:67], v[40:43]
    v_mfma_f32_16x16x32_bf16 v[44:47], v[196:199], v[68:71], v[44:47]
    v_mfma_f32_16x16x32_bf16 v[48:51], v[252:255], v[64:67], v[48:51]
    v_mfma_f32_16x16x32_bf16 v[52:55], v[252:255], v[68:71], v[52:55]
RH_epi:
    v_xor_b32 v105, 32768, v105
    s_nop 6
    s_add_u32 s32, s29, s33
    s_add_u32 s26, s29, s34
    v_mul_f32 v56, s35, v0
    v_mul_f32 v57, s35, v1
    v_mul_f32 v58, s35, v2
    v_mul_f32 v59, s35, v3
    v_exp_f32 v56, v56
    v_exp_f32 v57, v57
    v_exp_f32 v58, v58
    v_exp_f32 v59, v59
    v_add_f32 v56, 1.0, v56
    v_add_f32 v57, 1.0, v57
    v_add_f32 v58, 1.0, v58
    v_add_f32 v59, 1.0, v59
    v_rcp_f32 v56, v56
    v_rcp_f32 v57, v57
    v_rcp_f32 v58, v58
    v_rcp_f32 v59, v59
    v_mul_f32 v0, v0, v56
    v_mul_f32 v1, v1, v57
    v_mul_f32 v2, v2, v58
    v_mul_f32 v3, v3, v59
    v_cvt_pk_bf16_f32 v72, v0, v1
    v_cvt_pk_bf16_f32 v73, v2, v3
    v_mul_f32 v60, s35, v8
    v_mul_f32 v61, s35, v9
    v_mul_f32 v62, s35, v10
    v_mul_f32 v63, s35, v11
    v_exp_f32 v60, v60
    v_exp_f32 v61, v61
    v_exp_f32 v62, v62
    v_exp_f32 v63, v63
    v_add_f32 v60, 1.0, v60
    v_add_f32 v61, 1.0, v61
    v_add_f32 v62, 1.0, v62
    v_add_f32 v63, 1.0, v63
    v_rcp_f32 v60, v60
    v_rcp_f32 v61, v61
    v_rcp_f32 v62, v62
    v_rcp_f32 v63, v63
    v_mul_f32 v8, v8, v60
    v_mul_f32 v9, v9, v61
    v_mul_f32 v10, v10, v62
    v_mul_f32 v11, v11, v63
    v_cvt_pk_bf16_f32 v74, v8, v9
    v_cvt_pk_bf16_f32 v75, v10, v11
    buffer_store_dwordx4 v[72:75], v104, s[4:7], s32 offen offset:0 sc1
    v_mul_f32 v56, s35, v16
    v_mul_f32 v57, s35, v17
    v_mul_f32 v58, s35, v18
    v_mul_f32 v59, s35, v19
    v_exp_f32 v56, v56
    v_exp_f32 v57, v57
    v_exp_f32 v58, v58
    v_exp_f32 v59, v59
    v_add_f32 v56, 1.0, v56
    v_add_f32 v57, 1.0, v57
    v_add_f32 v58, 1.0, v58
    v_add_f32 v59, 1.0, v59
    v_rcp_f32 v56, v56
    v_rcp_f32 v57, v57
    v_rcp_f32 v58, v58
    v_rcp_f32 v59, v59
    v_mul_f32 v16, v16, v56
    v_mul_f32 v17, v17, v57
    v_mul_f32 v18, v18, v58
    v_mul_f32 v19, v19, v59
    v_cvt_pk_bf16_f32 v76, v16, v17
    v_cvt_pk_bf16_f32 v77, v18, v19
    v_mul_f32 v60, s35, v24
    v_mul_f32 v61, s35, v25
    v_mul_f32 v62, s35, v26
    v_mul_f32 v63, s35, v27
    v_exp_f32 v60, v60
    v_exp_f32 v61, v61
    v_exp_f32 v62, v62
    v_exp_f32 v63, v63
    v_add_f32 v60, 1.0, v60
    v_add_f32 v61, 1.0, v61
    v_add_f32 v62, 1.0, v62
    v_add_f32 v63, 1.0, v63
    v_rcp_f32 v60, v60
    v_rcp_f32 v61, v61
    v_rcp_f32 v62, v62
    v_rcp_f32 v63, v63
    v_mul_f32 v24, v24, v60
    v_mul_f32 v25, v25, v61
    v_mul_f32 v26, v26, v62
    v_mul_f32 v27, v27, v63
    v_cvt_pk_bf16_f32 v78, v24, v25
    v_cvt_pk_bf16_f32 v79, v26, v27
    buffer_store_dwordx4 v[76:79], v104, s[4:7], s32 offen offset:1024 sc1
    v_mul_f32 v56, s35, v32
    v_mul_f32 v57, s35, v33
    v_mul_f32 v58, s35, v34
    v_mul_f32 v59, s35, v35
    v_exp_f32 v56, v56
    v_exp_f32 v57, v57
    v_exp_f32 v58, v58
    v_exp_f32 v59, v59
    v_add_f32 v56, 1.0, v56
    v_add_f32 v57, 1.0, v57
    v_add_f32 v58, 1.0, v58
    v_add_f32 v59, 1.0, v59
    v_rcp_f32 v56, v56
    v_rcp_f32 v57, v57
    v_rcp_f32 v58, v58
    v_rcp_f32 v59, v59
    v_mul_f32 v32, v32, v56
    v_mul_f32 v33, v33, v57
    v_mul_f32 v34, v34, v58
    v_mul_f32 v35, v35, v59
    v_cvt_pk_bf16_f32 v80, v32, v33
    v_cvt_pk_bf16_f32 v81, v34, v35
    v_mul_f32 v60, s35, v40
    v_mul_f32 v61, s35, v41
    v_mul_f32 v62, s35, v42
    v_mul_f32 v63, s35, v43
    v_exp_f32 v60, v60
    v_exp_f32 v61, v61
    v_exp_f32 v62, v62
    v_exp_f32 v63, v63
    v_add_f32 v60, 1.0, v60
    v_add_f32 v61, 1.0, v61
    v_add_f32 v62, 1.0, v62
    v_add_f32 v63, 1.0, v63
    v_rcp_f32 v60, v60
    v_rcp_f32 v61, v61
    v_rcp_f32 v62, v62
    v_rcp_f32 v63, v63
    v_mul_f32 v40, v40, v60
    v_mul_f32 v41, v41, v61
    v_mul_f32 v42, v42, v62
    v_mul_f32 v43, v43, v63
    v_cvt_pk_bf16_f32 v82, v40, v41
    v_cvt_pk_bf16_f32 v83, v42, v43
    buffer_store_dwordx4 v[80:83], v104, s[4:7], s32 offen offset:2048 sc1
    v_mul_f32 v56, s35, v48
    v_mul_f32 v57, s35, v49
    v_mul_f32 v58, s35, v50
    v_mul_f32 v59, s35, v51
    v_exp_f32 v56, v56
    v_exp_f32 v57, v57
    v_exp_f32 v58, v58
    v_exp_f32 v59, v59
    v_add_f32 v56, 1.0, v56
    v_add_f32 v57, 1.0, v57
    v_add_f32 v58, 1.0, v58
    v_add_f32 v59, 1.0, v59
    v_rcp_f32 v56, v56
    v_rcp_f32 v57, v57
    v_rcp_f32 v58, v58
    v_rcp_f32 v59, v59
    v_mul_f32 v48, v48, v56
    v_mul_f32 v49, v49, v57
    v_mul_f32 v50, v50, v58
    v_mul_f32 v51, v51, v59
    v_cvt_pk_bf16_f32 v84, v48, v49
    v_cvt_pk_bf16_f32 v85, v50, v51
    buffer_store_dwordx2 v[84:85], v104, s[4:7], s26 offen sc1
    s_add_u32 s29, s29, 0x3800
    s_add_u32 s32, s29, s33
    s_add_u32 s26, s29, s34
    v_mul_f32 v56, s35, v4
    v_mul_f32 v57, s35, v5
    v_mul_f32 v58, s35, v6
    v_mul_f32 v59, s35, v7
    v_exp_f32 v56, v56
    v_exp_f32 v57, v57
    v_exp_f32 v58, v58
    v_exp_f32 v59, v59
    v_add_f32 v56, 1.0, v56
    v_add_f32 v57, 1.0, v57
    v_add_f32 v58, 1.0, v58
    v_add_f32 v59, 1.0, v59
    v_rcp_f32 v56, v56
    v_rcp_f32 v57, v57
    v_rcp_f32 v58, v58
    v_rcp_f32 v59, v59
    v_mul_f32 v4, v4, v56
    v_mul_f32 v5, v5, v57
    v_mul_f32 v6, v6, v58
    v_mul_f32 v7, v7, v59
    v_cvt_pk_bf16_f32 v88, v4, v5
    v_cvt_pk_bf16_f32 v89, v6, v7
    v_mul_f32 v60, s35, v12
    v_mul_f32 v61, s35, v13
    v_mul_f32 v62, s35, v14
    v_mul_f32 v63, s35, v15
    v_exp_f32 v60, v60
    v_exp_f32 v61, v61
    v_exp_f32 v62, v62
    v_exp_f32 v63, v63
    v_add_f32 v60, 1.0, v60
    v_add_f32 v61, 1.0, v61
    v_add_f32 v62, 1.0, v62
    v_add_f32 v63, 1.0, v63
    v_rcp_f32 v60, v60
    v_rcp_f32 v61, v61
    v_rcp_f32 v62, v62
    v_rcp_f32 v63, v63
    v_mul_f32 v12, v12, v60
    v_mul_f32 v13, v13, v61
    v_mul_f32 v14, v14, v62
    v_mul_f32 v15, v15, v63
    v_cvt_pk_bf16_f32 v90, v12, v13
    v_cvt_pk_bf16_f32 v91, v14, v15
    buffer_store_dwordx4 v[88:91], v104, s[4:7], s32 offen offset:0 sc1
    v_mul_f32 v56, s35, v20
    v_mul_f32 v57, s35, v21
    v_mul_f32 v58, s35, v22
    v_mul_f32 v59, s35, v23
    v_exp_f32 v56, v56
    v_exp_f32 v57, v57
    v_exp_f32 v58, v58
    v_exp_f32 v59, v59
    v_add_f32 v56, 1.0, v56
    v_add_f32 v57, 1.0, v57
    v_add_f32 v58, 1.0, v58
    v_add_f32 v59, 1.0, v59
    v_rcp_f32 v56, v56
    v_rcp_f32 v57, v57
    v_rcp_f32 v58, v58
    v_rcp_f32 v59, v59
    v_mul_f32 v20, v20, v56
    v_mul_f32 v21, v21, v57
    v_mul_f32 v22, v22, v58
    v_mul_f32 v23, v23, v59
    v_cvt_pk_bf16_f32 v92, v20, v21
    v_cvt_pk_bf16_f32 v93, v22, v23
    v_mul_f32 v60, s35, v28
    v_mul_f32 v61, s35, v29
    v_mul_f32 v62, s35, v30
    v_mul_f32 v63, s35, v31
    v_exp_f32 v60, v60
    v_exp_f32 v61, v61
    v_exp_f32 v62, v62
    v_exp_f32 v63, v63
    v_add_f32 v60, 1.0, v60
    v_add_f32 v61, 1.0, v61
    v_add_f32 v62, 1.0, v62
    v_add_f32 v63, 1.0, v63
    v_rcp_f32 v60, v60
    v_rcp_f32 v61, v61
    v_rcp_f32 v62, v62
    v_rcp_f32 v63, v63
    v_mul_f32 v28, v28, v60
    v_mul_f32 v29, v29, v61
    v_mul_f32 v30, v30, v62
    v_mul_f32 v31, v31, v63
    v_cvt_pk_bf16_f32 v94, v28, v29
    v_cvt_pk_bf16_f32 v95, v30, v31
    buffer_store_dwordx4 v[92:95], v104, s[4:7], s32 offen offset:1024 sc1
    v_mul_f32 v56, s35, v36
    v_mul_f32 v57, s35, v37
    v_mul_f32 v58, s35, v38
    v_mul_f32 v59, s35, v39
    v_exp_f32 v56, v56
    v_exp_f32 v57, v57
    v_exp_f32 v58, v58
    v_exp_f32 v59, v59
    v_add_f32 v56, 1.0, v56
    v_add_f32 v57, 1.0, v57
    v_add_f32 v58, 1.0, v58
    v_add_f32 v59, 1.0, v59
    v_rcp_f32 v56, v56
    v_rcp_f32 v57, v57
    v_rcp_f32 v58, v58
    v_rcp_f32 v59, v59
    v_mul_f32 v36, v36, v56
    v_mul_f32 v37, v37, v57
    v_mul_f32 v38, v38, v58
    v_mul_f32 v39, v39, v59
    v_cvt_pk_bf16_f32 v96, v36, v37
    v_cvt_pk_bf16_f32 v97, v38, v39
    v_mul_f32 v60, s35, v44
    v_mul_f32 v61, s35, v45
    v_mul_f32 v62, s35, v46
    v_mul_f32 v63, s35, v47
    v_exp_f32 v60, v60
    v_exp_f32 v61, v61
    v_exp_f32 v62, v62
    v_exp_f32 v63, v63
    v_add_f32 v60, 1.0, v60
    v_add_f32 v61, 1.0, v61
    v_add_f32 v62, 1.0, v62
    v_add_f32 v63, 1.0, v63
    v_rcp_f32 v60, v60
    v_rcp_f32 v61, v61
    v_rcp_f32 v62, v62
    v_rcp_f32 v63, v63
    v_mul_f32 v44, v44, v60
    v_mul_f32 v45, v45, v61
    v_mul_f32 v46, v46, v62
    v_mul_f32 v47, v47, v63
    v_cvt_pk_bf16_f32 v98, v44, v45
    v_cvt_pk_bf16_f32 v99, v46, v47
    buffer_store_dwordx4 v[96:99], v104, s[4:7], s32 offen offset:2048 sc1
    v_mul_f32 v56, s35, v52
    v_mul_f32 v57, s35, v53
    v_mul_f32 v58, s35, v54
    v_mul_f32 v59, s35, v55
    v_exp_f32 v56, v56
    v_exp_f32 v57, v57
    v_exp_f32 v58, v58
    v_exp_f32 v59, v59
    v_add_f32 v56, 1.0, v56
    v_add_f32 v57, 1.0, v57
    v_add_f32 v58, 1.0, v58
    v_add_f32 v59, 1.0, v59
    v_rcp_f32 v56, v56
    v_rcp_f32 v57, v57
    v_rcp_f32 v58, v58
    v_rcp_f32 v59, v59
    v_mul_f32 v52, v52, v56
    v_mul_f32 v53, v53, v57
    v_mul_f32 v54, v54, v58
    v_mul_f32 v55, v55, v59
    v_cvt_pk_bf16_f32 v100, v52, v53
    v_cvt_pk_bf16_f32 v101, v54, v55
    buffer_store_dwordx2 v[100:101], v104, s[4:7], s26 offen sc1
    s_add_u32 s29, s29, 0xdc800
    s_mov_b32 s31, s30
    s_add_u32 s30, s30, 512
    s_add_u32 s24, s24, 8
    s_branch RH_top
W3_role:
    s_sub_u32 s22, s22, 160
    s_cmp_ge_u32 s22, 63
    s_cbranch_scc1 M_exit
    s_mul_i32 s24, s22, 37
    s_lshr_b32 s24, s24, 8
    s_mul_i32 s25, s24, 7
    s_sub_u32 s25, s22, s25
    s_mov_b32 s8, s42
    s_mov_b32 s9, s43
    s_mov_b32 s10, 0x188000
    s_mov_b32 s11, 0x20000
    s_mov_b32 s12, s44
    s_mov_b32 s13, s45
    s_mov_b32 s14, 0x1c0000
    s_mov_b32 s15, 0x20000
    s_mov_b32 s52, s36
    s_mov_b32 s53, s37
    s_mov_b32 s54, 0x1c0000
    s_mov_b32 s55, 0x20000
    v_lshlrev_b32 v244, 4, v1
    v_lshrrev_b32 v2, 3, v1
    v_mul_u32_u24 v2, 0x380, v2
    v_and_b32 v3, 7, v1
    v_lshl_add_u32 v6, v3, 4, v2
    s_mul_i32 s26, s20, 401408
    s_lshl_b32 s27, s25, 7
    s_add_u32 s26, s26, s27
    s_mul_i32 s35, s20, 28672
    v_lshrrev_b32 v2, 2, v1
    v_lshlrev_b32 v2, 7, v2
    v_and_b32 v3, 3, v1
    v_lshl_add_u32 v2, v3, 3, v2
    v_add_u32 v5, s35, v2
    s_add_u32 m0, s35, 0
    s_nop 0
    buffer_load_dwordx4 v6, s[8:11], s26 offen lds
    s_add_u32 s26, s26, 7168
    s_add_u32 m0, s35, 1024
    s_nop 0
    buffer_load_dwordx4 v6, s[8:11], s26 offen lds
    s_add_u32 s26, s26, 7168
    s_add_u32 m0, s35, 2048
    s_nop 0
    buffer_load_dwordx4 v6, s[8:11], s26 offen lds
    s_add_u32 s26, s26, 7168
    s_add_u32 m0, s35, 3072
    s_nop 0
    buffer_load_dwordx4 v6, s[8:11], s26 offen lds
    s_add_u32 s26, s26, 7168
    s_add_u32 m0, s35, 4096
    s_nop 0
    buffer_load_dwordx4 v6, s[8:11], s26 offen lds
    s_add_u32 s26, s26, 7168
    s_add_u32 m0, s35, 5120
    s_nop 0
    buffer_load_dwordx4 v6, s[8:11], s26 offen lds
    s_add_u32 s26, s26, 7168
    s_add_u32 m0, s35, 6144
    s_nop 0
    buffer_load_dwordx4 v6, s[8:11], s26 offen lds
    s_add_u32 s26, s26, 7168
    s_add_u32 m0, s35, 7168
    s_nop 0
    buffer_load_dwordx4 v6, s[8:11], s26 offen lds
    s_add_u32 s26, s26, 7168
    s_add_u32 m0, s35, 8192
    s_nop 0
    buffer_load_dwordx4 v6, s[8:11], s26 offen lds
    s_add_u32 s26, s26, 7168
    s_add_u32 m0, s35, 9216
    s_nop 0
    buffer_load_dwordx4 v6, s[8:11], s26 offen lds
    s_add_u32 s26, s26, 7168
    s_add_u32 m0, s35, 10240
    s_nop 0
    buffer_load_dwordx4 v6, s[8:11], s26 offen lds
    s_add_u32 s26, s26, 7168
    s_add_u32 m0, s35, 11264
    s_nop 0
    buffer_load_dwordx4 v6, s[8:11], s26 offen lds
    s_add_u32 s26, s26, 7168
    s_add_u32 m0, s35, 12288
    s_nop 0
    buffer_load_dwordx4 v6, s[8:11], s26 offen lds
    s_add_u32 s26, s26, 7168
    s_add_u32 m0, s35, 13312
    s_nop 0
    buffer_load_dwordx4 v6, s[8:11], s26 offen lds
    s_add_u32 s26, s26, 7168
    s_add_u32 m0, s35, 14336
    s_nop 0
    buffer_load_dwordx4 v6, s[8:11], s26 offen lds
    s_add_u32 s26, s26, 7168
    s_add_u32 m0, s35, 15360
    s_nop 0
    buffer_load_dwordx4 v6, s[8:11], s26 offen lds
    s_add_u32 s26, s26, 7168
    s_add_u32 m0, s35, 16384
    s_nop 0
    buffer_load_dwordx4 v6, s[8:11], s26 offen lds
    s_add_u32 s26, s26, 7168
    s_add_u32 m0, s35, 17408
    s_nop 0
    buffer_load_dwordx4 v6, s[8:11], s26 offen lds
    s_add_u32 s26, s26, 7168
    s_add_u32 m0, s35, 18432
    s_nop 0
    buffer_load_dwordx4 v6, s[8:11], s26 offen lds
    s_add_u32 s26, s26, 7168
    s_add_u32 m0, s35, 19456
    s_nop 0
    buffer_load_dwordx4 v6, s[8:11], s26 offen lds
    s_add_u32 s26, s26, 7168
    s_add_u32 m0, s35, 20480
    s_nop 0
    buffer_load_dwordx4 v6, s[8:11], s26 offen lds
    s_add_u32 s26, s26, 7168
    s_add_u32 m0, s35, 21504
    s_nop 0
    buffer_load_dwordx4 v6, s[8:11], s26 offen lds
    s_add_u32 s26, s26, 7168
    s_add_u32 m0, s35, 22528
    s_nop 0
    buffer_load_dwordx4 v6, s[8:11], s26 offen lds
    s_add_u32 s26, s26, 7168
    s_add_u32 m0, s35, 23552
    s_nop 0
    buffer_load_dwordx4 v6, s[8:11], s26 offen lds
    s_add_u32 s26, s26, 7168
    s_add_u32 m0, s35, 24576
    s_nop 0
    buffer_load_dwordx4 v6, s[8:11], s26 offen lds
    s_add_u32 s26, s26, 7168
    s_add_u32 m0, s35, 25600
    s_nop 0
    buffer_load_dwordx4 v6, s[8:11], s26 offen lds
    s_add_u32 s26, s26, 7168
    s_add_u32 m0, s35, 26624
    s_nop 0
    buffer_load_dwordx4 v6, s[8:11], s26 offen lds
    s_add_u32 s26, s26, 7168
    s_add_u32 m0, s35, 27648
    s_nop 0
    buffer_load_dwordx4 v6, s[8:11], s26 offen lds
    s_add_u32 s26, s26, 7168
    s_waitcnt vmcnt(14)
    ds_read_b64_tr_b16 a[0:1], v5 offset:0
    ds_read_b64_tr_b16 a[4:5], v5 offset:32
    ds_read_b64_tr_b16 a[8:9], v5 offset:64
    ds_read_b64_tr_b16 a[12:13], v5 offset:96
    ds_read_b64_tr_b16 a[2:3], v5 offset:2048
    ds_read_b64_tr_b16 a[6:7], v5 offset:2080
    ds_read_b64_tr_b16 a[10:11], v5 offset:2112
    ds_read_b64_tr_b16 a[14:15], v5 offset:2144
    s_waitcnt lgkmcnt(4)
    ds_read_b64_tr_b16 a[16:17], v5 offset:4096
    ds_read_b64_tr_b16 a[20:21], v5 offset:4128
    ds_read_b64_tr_b16 a[24:25], v5 offset:4160
    ds_read_b64_tr_b16 a[28:29], v5 offset:4192
    ds_read_b64_tr_b16 a[18:19], v5 offset:6144
    ds_read_b64_tr_b16 a[22:23], v5 offset:6176
    ds_read_b64_tr_b16 a[26:27], v5 offset:6208
    ds_read_b64_tr_b16 a[30:31], v5 offset:6240
    s_waitcnt lgkmcnt(4)
    ds_read_b64_tr_b16 a[32:33], v5 offset:8192
    ds_read_b64_tr_b16 a[36:37], v5 offset:8224
    ds_read_b64_tr_b16 a[40:41], v5 offset:8256
    ds_read_b64_tr_b16 a[44:45], v5 offset:8288
    ds_read_b64_tr_b16 a[34:35], v5 offset:10240
    ds_read_b64_tr_b16 a[38:39], v5 offset:10272
    ds_read_b64_tr_b16 a[42:43], v5 offset:10304
    ds_read_b64_tr_b16 a[46:47], v5 offset:10336
    s_waitcnt lgkmcnt(4)
    ds_read_b64_tr_b16 a[192:193], v5 offset:12288
    ds_read_b64_tr_b16 a[196:197], v5 offset:12320
    ds_read_b64_tr_b16 a[200:201], v5 offset:12352
    ds_read_b64_tr_b16 a[204:205], v5 offset:12384
    s_waitcnt lgkmcnt(0)
    s_add_u32 m0, s35, 0
    s_nop 0
    buffer_load_dwordx4 v6, s[8:11], s26 offen lds
    s_add_u32 s26, s26, 7168
    s_add_u32 m0, s35, 1024
    s_nop 0
    buffer_load_dwordx4 v6, s[8:11], s26 offen lds
    s_add_u32 s26, s26, 7168
    s_add_u32 m0, s35, 2048
    s_nop 0
    buffer_load_dwordx4 v6, s[8:11], s26 offen lds
    s_add_u32 s26, s26, 7168
    s_add_u32 m0, s35, 3072
    s_nop 0
    buffer_load_dwordx4 v6, s[8:11], s26 offen lds
    s_add_u32 s26, s26, 7168
    s_add_u32 m0, s35, 4096
    s_nop 0
    buffer_load_dwordx4 v6, s[8:11], s26 offen lds
    s_add_u32 s26, s26, 7168
    s_add_u32 m0, s35, 5120
    s_nop 0
    buffer_load_dwordx4 v6, s[8:11], s26 offen lds
    s_add_u32 s26, s26, 7168
    s_add_u32 m0, s35, 6144
    s_nop 0
    buffer_load_dwordx4 v6, s[8:11], s26 offen lds
    s_add_u32 s26, s26, 7168
    s_add_u32 m0, s35, 7168
    s_nop 0
    buffer_load_dwordx4 v6, s[8:11], s26 offen lds
    s_add_u32 s26, s26, 7168
    s_add_u32 m0, s35, 8192
    s_nop 0
    buffer_load_dwordx4 v6, s[8:11], s26 offen lds
    s_add_u32 s26, s26, 7168
    s_add_u32 m0, s35, 9216
    s_nop 0
    buffer_load_dwordx4 v6, s[8:11], s26 offen lds
    s_add_u32 s26, s26, 7168
    s_add_u32 m0, s35, 10240
    s_nop 0
    buffer_load_dwordx4 v6, s[8:11], s26 offen lds
    s_add_u32 s26, s26, 7168
    s_add_u32 m0, s35, 11264
    s_nop 0
    buffer_load_dwordx4 v6, s[8:11], s26 offen lds
    s_add_u32 s26, s26, 7168
    s_add_u32 m0, s35, 12288
    s_nop 0
    buffer_load_dwordx4 v6, s[8:11], s26 offen lds
    s_add_u32 s26, s26, 7168
    s_add_u32 m0, s35, 13312
    s_nop 0
    buffer_load_dwordx4 v6, s[8:11], s26 offen lds
    s_add_u32 s26, s26, 7168
    s_waitcnt vmcnt(14)
    ds_read_b64_tr_b16 a[48:49], v5 offset:14336
    ds_read_b64_tr_b16 a[52:53], v5 offset:14368
    ds_read_b64_tr_b16 a[56:57], v5 offset:14400
    ds_read_b64_tr_b16 a[60:61], v5 offset:14432
    ds_read_b64_tr_b16 a[50:51], v5 offset:16384
    ds_read_b64_tr_b16 a[54:55], v5 offset:16416
    ds_read_b64_tr_b16 a[58:59], v5 offset:16448
    ds_read_b64_tr_b16 a[62:63], v5 offset:16480
    s_waitcnt lgkmcnt(4)
    ds_read_b64_tr_b16 a[64:65], v5 offset:18432
    ds_read_b64_tr_b16 a[68:69], v5 offset:18464
    ds_read_b64_tr_b16 a[72:73], v5 offset:18496
    ds_read_b64_tr_b16 a[76:77], v5 offset:18528
    ds_read_b64_tr_b16 a[66:67], v5 offset:20480
    ds_read_b64_tr_b16 a[70:71], v5 offset:20512
    ds_read_b64_tr_b16 a[74:75], v5 offset:20544
    ds_read_b64_tr_b16 a[78:79], v5 offset:20576
    s_waitcnt lgkmcnt(4)
    ds_read_b64_tr_b16 a[80:81], v5 offset:22528
    ds_read_b64_tr_b16 a[84:85], v5 offset:22560
    ds_read_b64_tr_b16 a[88:89], v5 offset:22592
    ds_read_b64_tr_b16 a[92:93], v5 offset:22624
    ds_read_b64_tr_b16 a[82:83], v5 offset:24576
    ds_read_b64_tr_b16 a[86:87], v5 offset:24608
    ds_read_b64_tr_b16 a[90:91], v5 offset:24640
    ds_read_b64_tr_b16 a[94:95], v5 offset:24672
    s_waitcnt lgkmcnt(4)
    ds_read_b64_tr_b16 a[194:195], v5 offset:26624
    ds_read_b64_tr_b16 a[198:199], v5 offset:26656
    ds_read_b64_tr_b16 a[202:203], v5 offset:26688
    ds_read_b64_tr_b16 a[206:207], v5 offset:26720
    s_waitcnt lgkmcnt(0)
    s_add_u32 m0, s35, 14336
    s_nop 0
    buffer_load_dwordx4 v6, s[8:11], s26 offen lds
    s_add_u32 s26, s26, 7168
    s_add_u32 m0, s35, 15360
    s_nop 0
    buffer_load_dwordx4 v6, s[8:11], s26 offen lds
    s_add_u32 s26, s26, 7168
    s_add_u32 m0, s35, 16384
    s_nop 0
    buffer_load_dwordx4 v6, s[8:11], s26 offen lds
    s_add_u32 s26, s26, 7168
    s_add_u32 m0, s35, 17408
    s_nop 0
    buffer_load_dwordx4 v6, s[8:11], s26 offen lds
    s_add_u32 s26, s26, 7168
    s_add_u32 m0, s35, 18432
    s_nop 0
    buffer_load_dwordx4 v6, s[8:11], s26 offen lds
    s_add_u32 s26, s26, 7168
    s_add_u32 m0, s35, 19456
    s_nop 0
    buffer_load_dwordx4 v6, s[8:11], s26 offen lds
    s_add_u32 s26, s26, 7168
    s_add_u32 m0, s35, 20480
    s_nop 0
    buffer_load_dwordx4 v6, s[8:11], s26 offen lds
    s_add_u32 s26, s26, 7168
    s_add_u32 m0, s35, 21504
    s_nop 0
    buffer_load_dwordx4 v6, s[8:11], s26 offen lds
    s_add_u32 s26, s26, 7168
    s_add_u32 m0, s35, 22528
    s_nop 0
    buffer_load_dwordx4 v6, s[8:11], s26 offen lds
    s_add_u32 s26, s26, 7168
    s_add_u32 m0, s35, 23552
    s_nop 0
    buffer_load_dwordx4 v6, s[8:11], s26 offen lds
    s_add_u32 s26, s26, 7168
    s_add_u32 m0, s35, 24576
    s_nop 0
    buffer_load_dwordx4 v6, s[8:11], s26 offen lds
    s_add_u32 s26, s26, 7168
    s_add_u32 m0, s35, 25600
    s_nop 0
    buffer_load_dwordx4 v6, s[8:11], s26 offen lds
    s_add_u32 s26, s26, 7168
    s_add_u32 m0, s35, 26624
    s_nop 0
    buffer_load_dwordx4 v6, s[8:11], s26 offen lds
    s_add_u32 s26, s26, 7168
    s_add_u32 m0, s35, 27648
    s_nop 0
    buffer_load_dwordx4 v6, s[8:11], s26 offen lds
    s_add_u32 s26, s26, 7168
    s_waitcnt vmcnt(14)
    ds_read_b64_tr_b16 a[96:97], v5 offset:0
    ds_read_b64_tr_b16 a[100:101], v5 offset:32
    ds_read_b64_tr_b16 a[104:105], v5 offset:64
    ds_read_b64_tr_b16 a[108:109], v5 offset:96
    ds_read_b64_tr_b16 a[98:99], v5 offset:2048
    ds_read_b64_tr_b16 a[102:103], v5 offset:2080
    ds_read_b64_tr_b16 a[106:107], v5 offset:2112
    ds_read_b64_tr_b16 a[110:111], v5 offset:2144
    s_waitcnt lgkmcnt(4)
    ds_read_b64_tr_b16 a[112:113], v5 offset:4096
    ds_read_b64_tr_b16 a[116:117], v5 offset:4128
    ds_read_b64_tr_b16 a[120:121], v5 offset:4160
    ds_read_b64_tr_b16 a[124:125], v5 offset:4192
    ds_read_b64_tr_b16 a[114:115], v5 offset:6144
    ds_read_b64_tr_b16 a[118:119], v5 offset:6176
    ds_read_b64_tr_b16 a[122:123], v5 offset:6208
    ds_read_b64_tr_b16 a[126:127], v5 offset:6240
    s_waitcnt lgkmcnt(4)
    ds_read_b64_tr_b16 a[128:129], v5 offset:8192
    ds_read_b64_tr_b16 a[132:133], v5 offset:8224
    ds_read_b64_tr_b16 a[136:137], v5 offset:8256
    ds_read_b64_tr_b16 a[140:141], v5 offset:8288
    ds_read_b64_tr_b16 a[130:131], v5 offset:10240
    ds_read_b64_tr_b16 a[134:135], v5 offset:10272
    ds_read_b64_tr_b16 a[138:139], v5 offset:10304
    ds_read_b64_tr_b16 a[142:143], v5 offset:10336
    s_waitcnt lgkmcnt(4)
    ds_read_b64_tr_b16 a[208:209], v5 offset:12288
    ds_read_b64_tr_b16 a[212:213], v5 offset:12320
    ds_read_b64_tr_b16 a[216:217], v5 offset:12352
    ds_read_b64_tr_b16 a[220:221], v5 offset:12384
    s_waitcnt lgkmcnt(0)
    s_waitcnt vmcnt(0)
    ds_read_b64_tr_b16 a[144:145], v5 offset:14336
    ds_read_b64_tr_b16 a[148:149], v5 offset:14368
    ds_read_b64_tr_b16 a[152:153], v5 offset:14400
    ds_read_b64_tr_b16 a[156:157], v5 offset:14432
    ds_read_b64_tr_b16 a[146:147], v5 offset:16384
    ds_read_b64_tr_b16 a[150:151], v5 offset:16416
    ds_read_b64_tr_b16 a[154:155], v5 offset:16448
    ds_read_b64_tr_b16 a[158:159], v5 offset:16480
    s_waitcnt lgkmcnt(4)
    ds_read_b64_tr_b16 a[160:161], v5 offset:18432
    ds_read_b64_tr_b16 a[164:165], v5 offset:18464
    ds_read_b64_tr_b16 a[168:169], v5 offset:18496
    ds_read_b64_tr_b16 a[172:173], v5 offset:18528
    ds_read_b64_tr_b16 a[162:163], v5 offset:20480
    ds_read_b64_tr_b16 a[166:167], v5 offset:20512
    ds_read_b64_tr_b16 a[170:171], v5 offset:20544
    ds_read_b64_tr_b16 a[174:175], v5 offset:20576
    s_waitcnt lgkmcnt(4)
    ds_read_b64_tr_b16 a[176:177], v5 offset:22528
    ds_read_b64_tr_b16 a[180:181], v5 offset:22560
    ds_read_b64_tr_b16 a[184:185], v5 offset:22592
    ds_read_b64_tr_b16 a[188:189], v5 offset:22624
    ds_read_b64_tr_b16 a[178:179], v5 offset:24576
    ds_read_b64_tr_b16 a[182:183], v5 offset:24608
    ds_read_b64_tr_b16 a[186:187], v5 offset:24640
    ds_read_b64_tr_b16 a[190:191], v5 offset:24672
    s_waitcnt lgkmcnt(4)
    ds_read_b64_tr_b16 a[210:211], v5 offset:26624
    ds_read_b64_tr_b16 a[214:215], v5 offset:26656
    ds_read_b64_tr_b16 a[218:219], v5 offset:26688
    ds_read_b64_tr_b16 a[222:223], v5 offset:26720
    s_waitcnt lgkmcnt(0)
    s_barrier
    v_and_b32 v2, 15, v1
    v_lshrrev_b32 v3, 4, v1
    v_mul_u32_u24 v2, 0x380, v2
    v_lshl_add_u32 v2, v3, 3, v2
    s_lshl_b32 s26, s25, 7
    s_lshl_b32 s27, s20, 5
    s_add_u32 s26, s26, s27
    v_add_u32 v245, s26, v2
    s_lshl_b32 s26, s20, 13
    v_add_u32 v246, s26, v244
    s_lshl_b32 s26, s20, 11
    v_add_u32 v247, s26, v244
    s_cmp_lg_u32 s20, 0
    s_cbranch_scc1 L_one_159
    v_and_b32 v7, 31, v1
    v_lshlrev_b32 v7, 2, v7
L_Wi_160:
    s_sub_u32 s23, s23, 1
    s_cbranch_scc1 M_exit
    s_mov_b32 s63, 0x3fcc000
    buffer_load_dword v4, v7, s[4:7], s63 offen sc1
    v_mov_b32 v5, 1
    s_waitcnt vmcnt(0)
    v_min_u32 v4, v4, v5
    v_cmp_eq_u32 vcc, 0, v4
    s_cbranch_vccnz L_Wi_160
L_one_159:
    s_barrier
W3_top:
    s_lshl_b32 s32, s24, 6
    s_lshl_b32 s33, s20, 2
    s_add_u32 s26, s32, s33
    s_add_u32 s26, s26, 0x1142000
    s_lshl_b32 s33, s20, 4
    s_add_u32 s27, s32, s33
    s_add_u32 s28, s27, 0x1141000
    s_add_u32 s29, s27, 0x1143000
    s_lshl_b32 s27, s24, 2
    s_add_u32 s27, s27, s20
    s_lshl_b32 s27, s27, 2
    s_add_u32 s27, s27, 0x1140000
    s_mul_i32 s30, s24, 0x1c000
    s_mul_i32 s33, s20, 28672
    s_add_u32 s30, s30, s33
    s_add_u32 s30, s30, 0x36c8000
    s_mul_i32 s31, s24, 0x70000
    s_mul_i32 s33, s20, 114688
    s_add_u32 s31, s31, s33
    s_lshl_b32 s33, s25, 12
    s_add_u32 s31, s31, s33
    s_add_u32 s31, s31, 0x1148000
    s_mul_i32 s34, s24, 28672
    s_add_u32 s35, s34, 14336
    s_cmp_lg_u32 s20, 0
    s_cbranch_scc1 L_gate_161
L_W3f_162:
    s_sub_u32 s23, s23, 1
    s_cbranch_scc1 M_exit
    buffer_load_dword v248, off, s[4:7], s26 sc1
    s_waitcnt vmcnt(0)
    v_cmp_eq_u32 vcc, 0, v248
    s_cbranch_vccnz L_W3f_162
L_gate_161:
    s_barrier
L_W3h_163:
    s_sub_u32 s23, s23, 1
    s_cbranch_scc1 M_exit
    buffer_load_dword v248, off, s[4:7], s26 sc1
    s_waitcnt vmcnt(0)
    v_cmp_eq_u32 vcc, 0, v248
    s_cbranch_vccnz L_W3h_163
L_W3u_164:
    s_sub_u32 s23, s23, 1
    s_cbranch_scc1 M_exit
    buffer_load_dword v248, off, s[4:7], s27 sc1
    s_waitcnt vmcnt(0)
    v_cmp_ne_u32 vcc, 0x1010101, v248
    s_cbranch_vccnz L_W3u_164
    s_add_u32 s63, s30, 0
    buffer_load_dwordx4 v[32:35], v244, s[4:7], s63 offen sc1
    s_add_u32 s63, s30, 14336
    buffer_load_dwordx4 v[36:39], v244, s[4:7], s63 offen sc1
    s_add_u32 s63, s30, 1024
    buffer_load_dwordx4 v[40:43], v244, s[4:7], s63 offen sc1
    s_add_u32 s63, s30, 15360
    buffer_load_dwordx4 v[44:47], v244, s[4:7], s63 offen sc1
    s_add_u32 s63, s30, 2048
    buffer_load_dwordx4 v[48:51], v244, s[4:7], s63 offen sc1
    s_add_u32 s63, s30, 16384
    buffer_load_dwordx4 v[52:55], v244, s[4:7], s63 offen sc1
    s_add_u32 s63, s30, 3072
    buffer_load_dwordx4 v[56:59], v244, s[4:7], s63 offen sc1
    s_add_u32 s63, s30, 17408
    buffer_load_dwordx4 v[60:63], v244, s[4:7], s63 offen sc1
    s_add_u32 s63, s30, 4096
    buffer_load_dwordx4 v[64:67], v244, s[4:7], s63 offen sc1
    s_add_u32 s63, s30, 18432
    buffer_load_dwordx4 v[68:71], v244, s[4:7], s63 offen sc1
    s_add_u32 s63, s30, 5120
    buffer_load_dwordx4 v[72:75], v244, s[4:7], s63 offen sc1
    s_add_u32 s63, s30, 19456
    buffer_load_dwordx4 v[76:79], v244, s[4:7], s63 offen sc1
    s_add_u32 s63, s30, 6144
    buffer_load_dwordx4 v[80:83], v244, s[4:7], s63 offen sc1
    s_add_u32 s63, s30, 20480
    buffer_load_dwordx4 v[84:87], v244, s[4:7], s63 offen sc1
    s_add_u32 s63, s30, 7168
    buffer_load_dwordx4 v[88:91], v244, s[4:7], s63 offen sc1
    s_add_u32 s63, s30, 21504
    buffer_load_dwordx4 v[92:95], v244, s[4:7], s63 offen sc1
    s_add_u32 s63, s30, 8192
    buffer_load_dwordx4 v[96:99], v244, s[4:7], s63 offen sc1
    s_add_u32 s63, s30, 22528
    buffer_load_dwordx4 v[100:103], v244, s[4:7], s63 offen sc1
    s_add_u32 s63, s30, 9216
    buffer_load_dwordx4 v[104:107], v244, s[4:7], s63 offen sc1
    s_add_u32 s63, s30, 23552
    buffer_load_dwordx4 v[108:111], v244, s[4:7], s63 offen sc1
    s_add_u32 s63, s30, 10240
    buffer_load_dwordx4 v[112:115], v244, s[4:7], s63 offen sc1
    s_add_u32 s63, s30, 24576
    buffer_load_dwordx4 v[116:119], v244, s[4:7], s63 offen sc1
    s_add_u32 s63, s30, 11264
    buffer_load_dwordx4 v[120:123], v244, s[4:7], s63 offen sc1
    s_add_u32 s63, s30, 25600
    buffer_load_dwordx4 v[124:127], v244, s[4:7], s63 offen sc1
    s_add_u32 s63, s30, 12288
    buffer_load_dwordx4 v[128:131], v244, s[4:7], s63 offen sc1
    s_add_u32 s63, s30, 26624
    buffer_load_dwordx4 v[132:135], v244, s[4:7], s63 offen sc1
    s_add_u32 s63, s30, 13312
    buffer_load_dwordx4 v[136:139], v244, s[4:7], s63 offen sc1
    s_add_u32 s63, s30, 27648
    buffer_load_dwordx4 v[140:143], v244, s[4:7], s63 offen sc1
    buffer_load_dwordx4 v[144:147], v244, s[4:7], s31 offen offset:0 sc1
    buffer_load_dwordx4 v[148:151], v244, s[4:7], s31 offen offset:1024 sc1
    buffer_load_dwordx4 v[152:155], v244, s[4:7], s31 offen offset:2048 sc1
    buffer_load_dwordx4 v[156:159], v244, s[4:7], s31 offen offset:3072 sc1
    s_add_u32 s31, s31, 28672
    buffer_load_dwordx4 v[160:163], v244, s[4:7], s31 offen offset:0 sc1
    buffer_load_dwordx4 v[164:167], v244, s[4:7], s31 offen offset:1024 sc1
    buffer_load_dwordx4 v[168:171], v244, s[4:7], s31 offen offset:2048 sc1
    buffer_load_dwordx4 v[172:175], v244, s[4:7], s31 offen offset:3072 sc1
    s_add_u32 s31, s31, 28672
    buffer_load_dwordx4 v[176:179], v244, s[4:7], s31 offen offset:0 sc1
    buffer_load_dwordx4 v[180:183], v244, s[4:7], s31 offen offset:1024 sc1
    buffer_load_dwordx4 v[184:187], v244, s[4:7], s31 offen offset:2048 sc1
    buffer_load_dwordx4 v[188:191], v244, s[4:7], s31 offen offset:3072 sc1
    s_add_u32 s31, s31, 28672
    buffer_load_dwordx4 v[192:195], v244, s[4:7], s31 offen offset:0 sc1
    buffer_load_dwordx4 v[196:199], v244, s[4:7], s31 offen offset:1024 sc1
    buffer_load_dwordx4 v[200:203], v244, s[4:7], s31 offen offset:2048 sc1
    buffer_load_dwordx4 v[204:207], v244, s[4:7], s31 offen offset:3072 sc1
    s_add_u32 s31, s31, 28672
    buffer_load_dwordx2 v[240:241], v245, s[52:55], s34 offen
    buffer_load_dwordx2 v[242:243], v245, s[52:55], s35 offen
    s_waitcnt vmcnt(44)
    v_mfma_f32_16x16x32_bf16 v[0:3], a[0:3], v[32:35], 0
    v_mfma_f32_16x16x32_bf16 v[4:7], a[0:3], v[36:39], 0
    v_mfma_f32_16x16x32_bf16 v[8:11], a[4:7], v[32:35], 0
    v_mfma_f32_16x16x32_bf16 v[12:15], a[4:7], v[36:39], 0
    v_mfma_f32_16x16x32_bf16 v[16:19], a[8:11], v[32:35], 0
    v_mfma_f32_16x16x32_bf16 v[20:23], a[8:11], v[36:39], 0
    v_mfma_f32_16x16x32_bf16 v[24:27], a[12:15], v[32:35], 0
    v_mfma_f32_16x16x32_bf16 v[28:31], a[12:15], v[36:39], 0
    s_waitcnt vmcnt(42)
    v_mfma_f32_16x16x32_bf16 v[0:3], a[16:19], v[40:43], v[0:3]
    v_mfma_f32_16x16x32_bf16 v[4:7], a[16:19], v[44:47], v[4:7]
    v_mfma_f32_16x16x32_bf16 v[8:11], a[20:23], v[40:43], v[8:11]
    v_mfma_f32_16x16x32_bf16 v[12:15], a[20:23], v[44:47], v[12:15]
    v_mfma_f32_16x16x32_bf16 v[16:19], a[24:27], v[40:43], v[16:19]
    v_mfma_f32_16x16x32_bf16 v[20:23], a[24:27], v[44:47], v[20:23]
    v_mfma_f32_16x16x32_bf16 v[24:27], a[28:31], v[40:43], v[24:27]
    v_mfma_f32_16x16x32_bf16 v[28:31], a[28:31], v[44:47], v[28:31]
    s_waitcnt vmcnt(40)
    v_mfma_f32_16x16x32_bf16 v[0:3], a[32:35], v[48:51], v[0:3]
    v_mfma_f32_16x16x32_bf16 v[4:7], a[32:35], v[52:55], v[4:7]
    v_mfma_f32_16x16x32_bf16 v[8:11], a[36:39], v[48:51], v[8:11]
    v_mfma_f32_16x16x32_bf16 v[12:15], a[36:39], v[52:55], v[12:15]
    v_mfma_f32_16x16x32_bf16 v[16:19], a[40:43], v[48:51], v[16:19]
    v_mfma_f32_16x16x32_bf16 v[20:23], a[40:43], v[52:55], v[20:23]
    v_mfma_f32_16x16x32_bf16 v[24:27], a[44:47], v[48:51], v[24:27]
    v_mfma_f32_16x16x32_bf16 v[28:31], a[44:47], v[52:55], v[28:31]
    s_waitcnt vmcnt(38)
    v_mfma_f32_16x16x32_bf16 v[0:3], a[48:51], v[56:59], v[0:3]
    v_mfma_f32_16x16x32_bf16 v[4:7], a[48:51], v[60:63], v[4:7]
    v_mfma_f32_16x16x32_bf16 v[8:11], a[52:55], v[56:59], v[8:11]
    v_mfma_f32_16x16x32_bf16 v[12:15], a[52:55], v[60:63], v[12:15]
    v_mfma_f32_16x16x32_bf16 v[16:19], a[56:59], v[56:59], v[16:19]
    v_mfma_f32_16x16x32_bf16 v[20:23], a[56:59], v[60:63], v[20:23]
    v_mfma_f32_16x16x32_bf16 v[24:27], a[60:63], v[56:59], v[24:27]
    v_mfma_f32_16x16x32_bf16 v[28:31], a[60:63], v[60:63], v[28:31]
    s_waitcnt vmcnt(36)
    v_mfma_f32_16x16x32_bf16 v[0:3], a[64:67], v[64:67], v[0:3]
    v_mfma_f32_16x16x32_bf16 v[4:7], a[64:67], v[68:71], v[4:7]
    v_mfma_f32_16x16x32_bf16 v[8:11], a[68:71], v[64:67], v[8:11]
    v_mfma_f32_16x16x32_bf16 v[12:15], a[68:71], v[68:71], v[12:15]
    v_mfma_f32_16x16x32_bf16 v[16:19], a[72:75], v[64:67], v[16:19]
    v_mfma_f32_16x16x32_bf16 v[20:23], a[72:75], v[68:71], v[20:23]
    v_mfma_f32_16x16x32_bf16 v[24:27], a[76:79], v[64:67], v[24:27]
    v_mfma_f32_16x16x32_bf16 v[28:31], a[76:79], v[68:71], v[28:31]
    s_waitcnt vmcnt(34)
    v_mfma_f32_16x16x32_bf16 v[0:3], a[80:83], v[72:75], v[0:3]
    v_mfma_f32_16x16x32_bf16 v[4:7], a[80:83], v[76:79], v[4:7]
    v_mfma_f32_16x16x32_bf16 v[8:11], a[84:87], v[72:75], v[8:11]
    v_mfma_f32_16x16x32_bf16 v[12:15], a[84:87], v[76:79], v[12:15]
    v_mfma_f32_16x16x32_bf16 v[16:19], a[88:91], v[72:75], v[16:19]
    v_mfma_f32_16x16x32_bf16 v[20:23], a[88:91], v[76:79], v[20:23]
    v_mfma_f32_16x16x32_bf16 v[24:27], a[92:95], v[72:75], v[24:27]
    v_mfma_f32_16x16x32_bf16 v[28:31], a[92:95], v[76:79], v[28:31]
    s_waitcnt vmcnt(32)
    v_mfma_f32_16x16x32_bf16 v[0:3], a[96:99], v[80:83], v[0:3]
    v_mfma_f32_16x16x32_bf16 v[4:7], a[96:99], v[84:87], v[4:7]
    v_mfma_f32_16x16x32_bf16 v[8:11], a[100:103], v[80:83], v[8:11]
    v_mfma_f32_16x16x32_bf16 v[12:15], a[100:103], v[84:87], v[12:15]
    v_mfma_f32_16x16x32_bf16 v[16:19], a[104:107], v[80:83], v[16:19]
    v_mfma_f32_16x16x32_bf16 v[20:23], a[104:107], v[84:87], v[20:23]
    v_mfma_f32_16x16x32_bf16 v[24:27], a[108:111], v[80:83], v[24:27]
    v_mfma_f32_16x16x32_bf16 v[28:31], a[108:111], v[84:87], v[28:31]
    s_waitcnt vmcnt(30)
    v_mfma_f32_16x16x32_bf16 v[0:3], a[112:115], v[88:91], v[0:3]
    v_mfma_f32_16x16x32_bf16 v[4:7], a[112:115], v[92:95], v[4:7]
    v_mfma_f32_16x16x32_bf16 v[8:11], a[116:119], v[88:91], v[8:11]
    v_mfma_f32_16x16x32_bf16 v[12:15], a[116:119], v[92:95], v[12:15]
    v_mfma_f32_16x16x32_bf16 v[16:19], a[120:123], v[88:91], v[16:19]
    v_mfma_f32_16x16x32_bf16 v[20:23], a[120:123], v[92:95], v[20:23]
    v_mfma_f32_16x16x32_bf16 v[24:27], a[124:127], v[88:91], v[24:27]
    v_mfma_f32_16x16x32_bf16 v[28:31], a[124:127], v[92:95], v[28:31]
    s_waitcnt vmcnt(28)
    v_mfma_f32_16x16x32_bf16 v[0:3], a[128:131], v[96:99], v[0:3]
    v_mfma_f32_16x16x32_bf16 v[4:7], a[128:131], v[100:103], v[4:7]
    v_mfma_f32_16x16x32_bf16 v[8:11], a[132:135], v[96:99], v[8:11]
    v_mfma_f32_16x16x32_bf16 v[12:15], a[132:135], v[100:103], v[12:15]
    v_mfma_f32_16x16x32_bf16 v[16:19], a[136:139], v[96:99], v[16:19]
    v_mfma_f32_16x16x32_bf16 v[20:23], a[136:139], v[100:103], v[20:23]
    v_mfma_f32_16x16x32_bf16 v[24:27], a[140:143], v[96:99], v[24:27]
    v_mfma_f32_16x16x32_bf16 v[28:31], a[140:143], v[100:103], v[28:31]
    s_waitcnt vmcnt(26)
    v_mfma_f32_16x16x32_bf16 v[0:3], a[144:147], v[104:107], v[0:3]
    v_mfma_f32_16x16x32_bf16 v[4:7], a[144:147], v[108:111], v[4:7]
    v_mfma_f32_16x16x32_bf16 v[8:11], a[148:151], v[104:107], v[8:11]
    v_mfma_f32_16x16x32_bf16 v[12:15], a[148:151], v[108:111], v[12:15]
    v_mfma_f32_16x16x32_bf16 v[16:19], a[152:155], v[104:107], v[16:19]
    v_mfma_f32_16x16x32_bf16 v[20:23], a[152:155], v[108:111], v[20:23]
    v_mfma_f32_16x16x32_bf16 v[24:27], a[156:159], v[104:107], v[24:27]
    v_mfma_f32_16x16x32_bf16 v[28:31], a[156:159], v[108:111], v[28:31]
    s_waitcnt vmcnt(24)
    v_mfma_f32_16x16x32_bf16 v[0:3], a[160:163], v[112:115], v[0:3]
    v_mfma_f32_16x16x32_bf16 v[4:7], a[160:163], v[116:119], v[4:7]
    v_mfma_f32_16x16x32_bf16 v[8:11], a[164:167], v[112:115], v[8:11]
    v_mfma_f32_16x16x32_bf16 v[12:15], a[164:167], v[116:119], v[12:15]
    v_mfma_f32_16x16x32_bf16 v[16:19], a[168:171], v[112:115], v[16:19]
    v_mfma_f32_16x16x32_bf16 v[20:23], a[168:171], v[116:119], v[20:23]
    v_mfma_f32_16x16x32_bf16 v[24:27], a[172:175], v[112:115], v[24:27]
    v_mfma_f32_16x16x32_bf16 v[28:31], a[172:175], v[116:119], v[28:31]
    s_waitcnt vmcnt(22)
    v_mfma_f32_16x16x32_bf16 v[0:3], a[176:179], v[120:123], v[0:3]
    v_mfma_f32_16x16x32_bf16 v[4:7], a[176:179], v[124:127], v[4:7]
    v_mfma_f32_16x16x32_bf16 v[8:11], a[180:183], v[120:123], v[8:11]
    v_mfma_f32_16x16x32_bf16 v[12:15], a[180:183], v[124:127], v[12:15]
    v_mfma_f32_16x16x32_bf16 v[16:19], a[184:187], v[120:123], v[16:19]
    v_mfma_f32_16x16x32_bf16 v[20:23], a[184:187], v[124:127], v[20:23]
    v_mfma_f32_16x16x32_bf16 v[24:27], a[188:191], v[120:123], v[24:27]
    v_mfma_f32_16x16x32_bf16 v[28:31], a[188:191], v[124:127], v[28:31]
    s_waitcnt vmcnt(20)
    v_mfma_f32_16x16x32_bf16 v[0:3], a[192:195], v[128:131], v[0:3]
    v_mfma_f32_16x16x32_bf16 v[4:7], a[192:195], v[132:135], v[4:7]
    v_mfma_f32_16x16x32_bf16 v[8:11], a[196:199], v[128:131], v[8:11]
    v_mfma_f32_16x16x32_bf16 v[12:15], a[196:199], v[132:135], v[12:15]
    v_mfma_f32_16x16x32_bf16 v[16:19], a[200:203], v[128:131], v[16:19]
    v_mfma_f32_16x16x32_bf16 v[20:23], a[200:203], v[132:135], v[20:23]
    v_mfma_f32_16x16x32_bf16 v[24:27], a[204:207], v[128:131], v[24:27]
    v_mfma_f32_16x16x32_bf16 v[28:31], a[204:207], v[132:135], v[28:31]
    s_waitcnt vmcnt(18)
    v_mfma_f32_16x16x32_bf16 v[0:3], a[208:211], v[136:139], v[0:3]
    v_mfma_f32_16x16x32_bf16 v[4:7], a[208:211], v[140:143], v[4:7]
    v_mfma_f32_16x16x32_bf16 v[8:11], a[212:215], v[136:139], v[8:11]
    v_mfma_f32_16x16x32_bf16 v[12:15], a[212:215], v[140:143], v[12:15]
    v_mfma_f32_16x16x32_bf16 v[16:19], a[216:219], v[136:139], v[16:19]
    v_mfma_f32_16x16x32_bf16 v[20:23], a[216:219], v[140:143], v[20:23]
    v_mfma_f32_16x16x32_bf16 v[24:27], a[220:223], v[136:139], v[24:27]
    v_mfma_f32_16x16x32_bf16 v[28:31], a[220:223], v[140:143], v[28:31]
    s_mul_i32 s30, s24, 40960
    s_lshl_b32 s33, s20, 13
    s_add_u32 s31, s30, s33
    s_add_u32 s31, s31, 0x3448000
    s_lshl_b32 s33, s20, 11
    s_add_u32 s30, s30, s33
    s_add_u32 s30, s30, 0x3450000
    s_mul_i32 s32, s24, 0x1c000
    s_mul_i32 s33, s20, 28672
    s_add_u32 s32, s32, s33
    s_lshl_b32 s33, s25, 12
    s_add_u32 s32, s32, s33
    s_add_u32 s32, s32, 0x2d48000
    s_add_u32 s63, s31, 4096
    s_cmp_eq_u32 s24, 63
    s_cbranch_scc1 W3_last
    s_cmp_lg_u32 s20, 0
    s_cbranch_scc1 L_gate_165
L_W3g_166:
    s_sub_u32 s23, s23, 1
    s_cbranch_scc1 M_exit
    buffer_load_dwordx4 v[248:251], off, s[4:7], s29 sc1
    s_waitcnt vmcnt(0)
    v_min_u32 v248, v248, v249
    v_min_u32 v248, v248, v250
    v_min_u32 v248, v248, v251
    v_cmp_eq_u32 vcc, 0, v248
    s_cbranch_vccnz L_W3g_166
L_gate_165:
    s_barrier
L_W3pv_167:
    s_sub_u32 s23, s23, 1
    s_cbranch_scc1 M_exit
    buffer_load_dwordx4 v[248:251], off, s[4:7], s28 sc1
    buffer_load_dwordx4 v[252:255], off, s[4:7], s29 sc1
    s_waitcnt vmcnt(0)
    v_min3_u32 v248, v248, v249, v250
    v_min3_u32 v248, v248, v251, v252
    v_min3_u32 v248, v248, v253, v254
    v_min_u32 v248, v248, v255
    v_cmp_eq_u32 vcc, 0, v248
    s_cbranch_vccnz L_W3pv_167
    buffer_load_dwordx4 v[208:211], v244, s[4:7], s31 offen offset:0 sc1
    buffer_load_dwordx4 v[212:215], v244, s[4:7], s31 offen offset:1024 sc1
    buffer_load_dwordx4 v[216:219], v244, s[4:7], s31 offen offset:2048 sc1
    buffer_load_dwordx4 v[220:223], v244, s[4:7], s31 offen offset:3072 sc1
    buffer_load_dwordx4 v[224:227], v244, s[4:7], s63 offen offset:0 sc1
    buffer_load_dwordx4 v[228:231], v244, s[4:7], s63 offen offset:1024 sc1
    buffer_load_dwordx4 v[232:235], v244, s[4:7], s63 offen offset:2048 sc1
    buffer_load_dwordx4 v[236:239], v244, s[4:7], s63 offen offset:3072 sc1
    buffer_load_dwordx4 v[48:51], v244, s[4:7], s30 offen offset:0 sc1
    buffer_load_dwordx4 v[52:55], v244, s[4:7], s30 offen offset:1024 sc1
    buffer_load_dwordx4 v[32:35], v244, s[4:7], s32 offen offset:0 sc1
    buffer_load_dwordx4 v[36:39], v244, s[4:7], s32 offen offset:1024 sc1
    buffer_load_dwordx4 v[40:43], v244, s[4:7], s32 offen offset:2048 sc1
    buffer_load_dwordx4 v[44:47], v244, s[4:7], s32 offen offset:3072 sc1
W3_go:
    s_waitcnt vmcnt(12)
    v_mfma_f32_16x16x32_bf16 v[0:3], v[144:147], v[208:211], v[0:3]
    v_mfma_f32_16x16x32_bf16 v[4:7], v[144:147], v[212:215], v[4:7]
    v_mfma_f32_16x16x32_bf16 v[8:11], v[148:151], v[208:211], v[8:11]
    v_mfma_f32_16x16x32_bf16 v[12:15], v[148:151], v[212:215], v[12:15]
    v_mfma_f32_16x16x32_bf16 v[16:19], v[152:155], v[208:211], v[16:19]
    v_mfma_f32_16x16x32_bf16 v[20:23], v[152:155], v[212:215], v[20:23]
    v_mfma_f32_16x16x32_bf16 v[24:27], v[156:159], v[208:211], v[24:27]
    v_mfma_f32_16x16x32_bf16 v[28:31], v[156:159], v[212:215], v[28:31]
    s_waitcnt vmcnt(10)
    v_mfma_f32_16x16x32_bf16 v[0:3], v[160:163], v[216:219], v[0:3]
    v_mfma_f32_16x16x32_bf16 v[4:7], v[160:163], v[220:223], v[4:7]
    v_mfma_f32_16x16x32_bf16 v[8:11], v[164:167], v[216:219], v[8:11]
    v_mfma_f32_16x16x32_bf16 v[12:15], v[164:167], v[220:223], v[12:15]
    v_mfma_f32_16x16x32_bf16 v[16:19], v[168:171], v[216:219], v[16:19]
    v_mfma_f32_16x16x32_bf16 v[20:23], v[168:171], v[220:223], v[20:23]
    v_mfma_f32_16x16x32_bf16 v[24:27], v[172:175], v[216:219], v[24:27]
    v_mfma_f32_16x16x32_bf16 v[28:31], v[172:175], v[220:223], v[28:31]
    s_waitcnt vmcnt(8)
    v_mfma_f32_16x16x32_bf16 v[0:3], v[176:179], v[224:227], v[0:3]
    v_mfma_f32_16x16x32_bf16 v[4:7], v[176:179], v[228:231], v[4:7]
    v_mfma_f32_16x16x32_bf16 v[8:11], v[180:183], v[224:227], v[8:11]
    v_mfma_f32_16x16x32_bf16 v[12:15], v[180:183], v[228:231], v[12:15]
    v_mfma_f32_16x16x32_bf16 v[16:19], v[184:187], v[224:227], v[16:19]
    v_mfma_f32_16x16x32_bf16 v[20:23], v[184:187], v[228:231], v[20:23]
    v_mfma_f32_16x16x32_bf16 v[24:27], v[188:191], v[224:227], v[24:27]
    v_mfma_f32_16x16x32_bf16 v[28:31], v[188:191], v[228:231], v[28:31]
    s_waitcnt vmcnt(6)
    v_mfma_f32_16x16x32_bf16 v[0:3], v[192:195], v[232:235], v[0:3]
    v_mfma_f32_16x16x32_bf16 v[4:7], v[192:195], v[236:239], v[4:7]
    v_mfma_f32_16x16x32_bf16 v[8:11], v[196:199], v[232:235], v[8:11]
    v_mfma_f32_16x16x32_bf16 v[12:15], v[196:199], v[236:239], v[12:15]
    v_mfma_f32_16x16x32_bf16 v[16:19], v[200:203], v[232:235], v[16:19]
    v_mfma_f32_16x16x32_bf16 v[20:23], v[200:203], v[236:239], v[20:23]
    v_mfma_f32_16x16x32_bf16 v[24:27], v[204:207], v[232:235], v[24:27]
    v_mfma_f32_16x16x32_bf16 v[28:31], v[204:207], v[236:239], v[28:31]
    s_waitcnt vmcnt(3)
    v_mfma_f32_16x16x32_bf16 v[0:3], v[32:35], v[48:51], v[0:3]
    v_mfma_f32_16x16x32_bf16 v[4:7], v[32:35], v[52:55], v[4:7]
    s_waitcnt vmcnt(2)
    v_mfma_f32_16x16x32_bf16 v[8:11], v[36:39], v[48:51], v[8:11]
    v_mfma_f32_16x16x32_bf16 v[12:15], v[36:39], v[52:55], v[12:15]
    s_waitcnt vmcnt(1)
    v_mfma_f32_16x16x32_bf16 v[16:19], v[40:43], v[48:51], v[16:19]
    v_mfma_f32_16x16x32_bf16 v[20:23], v[40:43], v[52:55], v[20:23]
    s_waitcnt vmcnt(0)
    v_mfma_f32_16x16x32_bf16 v[24:27], v[44:47], v[48:51], v[24:27]
    v_mfma_f32_16x16x32_bf16 v[28:31], v[44:47], v[52:55], v[28:31]
    s_barrier
    ds_write_b128 v246, v[0:3] offset:0
    ds_write_b128 v246, v[4:7] offset:1024
    ds_write_b128 v246, v[8:11] offset:2048
    ds_write_b128 v246, v[12:15] offset:3072
    ds_write_b128 v246, v[16:19] offset:4096
    ds_write_b128 v246, v[20:23] offset:5120
    s_nop 1
    ds_write_b128 v246, v[24:27] offset:6144
    s_nop 1
    ds_write_b128 v246, v[28:31] offset:7168
    s_waitcnt lgkmcnt(0)
    s_barrier
    ds_read_b128 v[0:3], v247 offset:0
    ds_read_b128 v[4:7], v247 offset:8192
    ds_read_b128 v[8:11], v247 offset:16384
    ds_read_b128 v[12:15], v247 offset:24576
    ds_read_b128 v[16:19], v247 offset:1024
    ds_read_b128 v[20:23], v247 offset:9216
    ds_read_b128 v[24:27], v247 offset:17408
    ds_read_b128 v[28:31], v247 offset:25600
    v_lshlrev_b32 v32, 16, v240
    v_and_b32 v33, 0xffff0000, v240
    v_lshlrev_b32 v34, 16, v241
    v_and_b32 v35, 0xffff0000, v241
    s_waitcnt lgkmcnt(4)
    v_add_f32 v0, v0, v4
    v_add_f32 v8, v8, v12
    v_add_f32 v0, v0, v32
    v_add_f32 v0, v0, v8
    v_add_f32 v1, v1, v5
    v_add_f32 v9, v9, v13
    v_add_f32 v1, v1, v33
    v_add_f32 v1, v1, v9
    v_add_f32 v2, v2, v6
    v_add_f32 v10, v10, v14
    v_add_f32 v2, v2, v34
    v_add_f32 v2, v2, v10
    v_add_f32 v3, v3, v7
    v_add_f32 v11, v11, v15
    v_add_f32 v3, v3, v35
    v_add_f32 v3, v3, v11
    v_cvt_pk_bf16_f32 v36, v0, v1
    v_cvt_pk_bf16_f32 v37, v2, v3
    buffer_store_dwordx2 v[36:37], v245, s[12:15], s34 offen
    v_lshlrev_b32 v32, 16, v242
    v_and_b32 v33, 0xffff0000, v242
    v_lshlrev_b32 v34, 16, v243
    v_and_b32 v35, 0xffff0000, v243
    s_waitcnt lgkmcnt(0)
    v_add_f32 v16, v16, v20
    v_add_f32 v24, v24, v28
    v_add_f32 v16, v16, v32
    v_add_f32 v16, v16, v24
    v_add_f32 v17, v17, v21
    v_add_f32 v25, v25, v29
    v_add_f32 v17, v17, v33
    v_add_f32 v17, v17, v25
    v_add_f32 v18, v18, v22
    v_add_f32 v26, v26, v30
    v_add_f32 v18, v18, v34
    v_add_f32 v18, v18, v26
    v_add_f32 v19, v19, v23
    v_add_f32 v27, v27, v31
    v_add_f32 v19, v19, v35
    v_add_f32 v19, v19, v27
    v_cvt_pk_bf16_f32 v38, v16, v17
    v_cvt_pk_bf16_f32 v39, v18, v19
    buffer_store_dwordx2 v[38:39], v245, s[12:15], s35 offen
    s_add_u32 s24, s24, 9
    s_cmp_lt_u32 s24, 64
    s_cbranch_scc1 W3_top
    s_endpgm
W3_last:
    s_mov_b32 s28, 0x109e400
    s_cmp_lg_u32 s20, 0
    s_cbranch_scc1 L_gate_168
L_W3m_169:
    s_sub_u32 s23, s23, 1
    s_cbranch_scc1 M_exit
    buffer_load_dword v248, off, s[4:7], s28 sc1
    s_waitcnt vmcnt(0)
    v_cmp_eq_u32 vcc, -1, v248
    s_cbranch_vccnz L_W3m_169
L_gate_168:
    s_barrier
L_W3l_170:
    s_sub_u32 s23, s23, 1
    s_cbranch_scc1 M_exit
    buffer_load_dwordx4 v[208:211], v244, s[4:7], s31 offen offset:0 sc1
    buffer_load_dwordx4 v[212:215], v244, s[4:7], s31 offen offset:1024 sc1
    buffer_load_dwordx4 v[216:219], v244, s[4:7], s31 offen offset:2048 sc1
    buffer_load_dwordx4 v[220:223], v244, s[4:7], s31 offen offset:3072 sc1
    buffer_load_dwordx4 v[224:227], v244, s[4:7], s63 offen offset:0 sc1
    buffer_load_dwordx4 v[228:231], v244, s[4:7], s63 offen offset:1024 sc1
    buffer_load_dwordx4 v[232:235], v244, s[4:7], s63 offen offset:2048 sc1
    buffer_load_dwordx4 v[236:239], v244, s[4:7], s63 offen offset:3072 sc1
    buffer_load_dwordx4 v[48:51], v244, s[4:7], s30 offen offset:0 sc1
    buffer_load_dwordx4 v[52:55], v244, s[4:7], s30 offen offset:1024 sc1
    buffer_load_dwordx4 v[32:35], v244, s[4:7], s32 offen offset:0 sc1
    buffer_load_dwordx4 v[36:39], v244, s[4:7], s32 offen offset:1024 sc1
    buffer_load_dwordx4 v[40:43], v244, s[4:7], s32 offen offset:2048 sc1
    buffer_load_dwordx4 v[44:47], v244, s[4:7], s32 offen offset:3072 sc1
    s_waitcnt vmcnt(0)
    v_max3_u32 v248, v208, v209, v210
    v_max3_u32 v248, v248, v211, v212
    v_max3_u32 v248, v248, v213, v214
    v_max3_u32 v248, v248, v215, v216
    v_max3_u32 v248, v248, v217, v218
    v_max3_u32 v248, v248, v219, v220
    v_max3_u32 v248, v248, v221, v222
    v_max3_u32 v248, v248, v223, v224
    v_max3_u32 v248, v248, v225, v226
    v_max3_u32 v248, v248, v227, v228
    v_max3_u32 v248, v248, v229, v230
    v_max3_u32 v248, v248, v231, v232
    v_max3_u32 v248, v248, v233, v234
    v_max3_u32 v248, v248, v235, v236
    v_max3_u32 v248, v248, v237, v238
    v_max3_u32 v248, v248, v239, v32
    v_max3_u32 v248, v248, v33, v34
    v_max3_u32 v248, v248, v35, v36
    v_max3_u32 v248, v248, v37, v38
    v_max3_u32 v248, v248, v39, v40
    v_max3_u32 v248, v248, v41, v42
    v_max3_u32 v248, v248, v43, v44
    v_max3_u32 v248, v248, v45, v46
    v_max3_u32 v248, v248, v47, v48
    v_max3_u32 v248, v248, v49, v50
    v_max3_u32 v248, v248, v51, v52
    v_max3_u32 v248, v248, v53, v54
    v_max_u32 v248, v248, v55
    v_cmp_eq_u32 vcc, -1, v248
    s_cbranch_vccnz L_W3l_170
    s_branch W3_go
J_role:
    s_sub_u32 s26, s65, 1
    s_lshl_b32 s26, s26, 5
    s_add_u32 s26, s26, s66
    s_mul_i32 s57, s26, 9363
    s_lshr_b32 s57, s57, 16
    s_mul_i32 s24, s57, 7
    s_sub_u32 s24, s26, s24
    s_and_b32 s25, s57, 15
    s_mov_b32 s28, 0xa9843210
    s_mov_b32 s29, 0xfed765cb
    s_lshl_b32 s27, s25, 2
    s_lshr_b64 s[28:29], s[28:29], s27
    s_and_b32 s25, s28, 15
    s_and_b32 s57, s57, 16
    s_or_b32 s57, s57, s25
    v_and_b32 v10, 15, v1
    v_lshrrev_b32 v11, 4, v1
    v_and_b32 v13, 7, v1
    v_xor_b32 v13, v13, v11
    v_lshlrev_b32 v4, 4, v13
    v_xor_b32 v5, 64, v4
    v_lshrrev_b32 v13, 3, v1
    v_lshl_add_u32 v2, v13, 13, v4
    v_add_u32 v13, 8, v13
    v_lshl_add_u32 v3, v13, 13, v5
    s_cmp_lt_u32 s65, 5
    s_cbranch_scc1 J_nx
    s_sub_u32 s64, s26, 96
    s_mov_b32 s8, s72
    s_mov_b32 s9, s73
    s_mov_b32 s10, 0x1c0000
    s_mov_b32 s11, 0x20000
    s_lshl_b32 s27, s64, 2
    s_add_u32 s27, s27, s20
    s_mul_i32 s27, s27, 3584
    v_mul_u32_u24 v13, 0x380, v11
    v_lshl_add_u32 v13, v10, 3, v13
    buffer_load_dwordx2 v[230:231], v13, s[8:11], s27 offen offset:0
    buffer_load_dwordx2 v[232:233], v13, s[8:11], s27 offen offset:128
    buffer_load_dwordx2 v[234:235], v13, s[8:11], s27 offen offset:256
    buffer_load_dwordx2 v[236:237], v13, s[8:11], s27 offen offset:384
    buffer_load_dwordx2 v[238:239], v13, s[8:11], s27 offen offset:512
    buffer_load_dwordx2 v[240:241], v13, s[8:11], s27 offen offset:640
    buffer_load_dwordx2 v[242:243], v13, s[8:11], s27 offen offset:768
J_nx:
    s_lshl_b32 s26, s25, 9
    s_lshl_b32 s27, s24, 19
    s_add_u32 s28, s27, s26
    s_lshl_b32 s27, s20, 17
    s_add_u32 s28, s28, s27
    s_lshl_b32 s29, s20, 11
    s_cmp_lt_u32 s57, 16
    s_cselect_b32 s8, s80, s76
    s_cselect_b32 s9, s81, s77
    s_cselect_b32 s12, s82, s78
    s_cselect_b32 s13, s83, s79
    s_mov_b32 s10, 0x380000
    s_mov_b32 s11, 0x20000
    s_mov_b32 s14, 0x380000
    s_mov_b32 s15, 0x20000
    s_add_u32 m0, s29, 0
    s_add_u32 s27, s28, 0
    buffer_load_dwordx4 v2, s[8:11], s27 offen lds
    s_add_u32 m0, s29, 1024
    s_add_u32 s27, s28, 0
    buffer_load_dwordx4 v3, s[8:11], s27 offen lds
    s_add_u32 m0, s29, 8192
    s_add_u32 s27, s28, 128
    buffer_load_dwordx4 v2, s[8:11], s27 offen lds
    s_add_u32 m0, s29, 9216
    s_add_u32 s27, s28, 128
    buffer_load_dwordx4 v3, s[8:11], s27 offen lds
    s_add_u32 m0, s29, 16384
    s_add_u32 s27, s28, 256
    buffer_load_dwordx4 v2, s[8:11], s27 offen lds
    s_add_u32 m0, s29, 17408
    s_add_u32 s27, s28, 256
    buffer_load_dwordx4 v3, s[8:11], s27 offen lds
    s_add_u32 m0, s29, 24576
    s_add_u32 s27, s28, 384
    buffer_load_dwordx4 v2, s[8:11], s27 offen lds
    s_add_u32 m0, s29, 25600
    s_add_u32 s27, s28, 384
    buffer_load_dwordx4 v3, s[8:11], s27 offen lds
    v_lshrrev_b32 v13, 1, v10
    v_xor_b32 v13, v13, v11
    v_lshlrev_b32 v13, 4, v13
    v_lshl_add_u32 v228, v10, 7, v13
    v_xor_b32 v229, 64, v228
    v_lshlrev_b32 v12, 4, v1
    s_mul_i32 s30, s20, 32
    s_add_u32 s30, s30, s24
    s_lshl_b32 s30, s30, 2
    s_mul_i32 s31, s57, 512
    s_add_u32 s30, s30, s31
    s_add_u32 s30, s30, 0x3fc8000
    s_mul_i32 s32, s25, 0x62000
    s_lshl_b32 s33, s24, 11
    s_add_u32 s32, s32, s33
    s_cmp_lt_u32 s57, 16
    s_cbranch_scc1 J_b
    s_mov_b32 s34, 0x3db8aa3b
    s_mul_i32 s33, s20, 100352
    s_add_u32 s32, s32, s33
    v_bfe_u32 v13, v1, 3, 1
    v_bfe_u32 v14, v1, 4, 1
    v_lshl_add_u32 v13, v14, 2, v13
    v_lshrrev_b32 v14, 5, v1
    v_lshl_add_u32 v15, v14, 4, v13
    v_lshl_add_u32 v14, v14, 3, v13
    v_add_u32 v13, 0, v15
    v_lshl_add_u32 v6, v13, 13, v4
    v_add_u32 v13, 0, v14
    v_lshl_add_u32 v8, v13, 13, v4
    v_add_u32 v13, 32, v15
    v_lshl_add_u32 v7, v13, 13, v5
    v_add_u32 v13, 16, v14
    v_lshl_add_u32 v9, v13, 13, v5
    s_lshl_b32 s35, s20, 6
    s_add_u32 s27, s35, 0
    s_lshl_b32 s27, s27, 13
    s_add_u32 s50, s27, s26
    s_add_u32 s27, s35, 2
    s_lshl_b32 s27, s27, 13
    s_add_u32 s51, s27, s26
    s_add_u32 s27, s35, 8
    s_lshl_b32 s27, s27, 13
    s_add_u32 s52, s27, s26
    s_add_u32 s27, s35, 10
    s_lshl_b32 s27, s27, 13
    s_add_u32 s53, s27, s26
    s_lshl_b32 s35, s20, 5
    s_add_u32 s27, s35, 256
    s_lshl_b32 s27, s27, 13
    s_add_u32 s54, s27, s26
    s_add_u32 s27, s35, 258
    s_lshl_b32 s27, s27, 13
    s_add_u32 s55, s27, s26
    s_lshr_b32 s35, s20, 1
    s_lshl_b32 s35, s35, 5
    s_and_b32 s27, s20, 1
    s_lshl_b32 s27, s27, 1
    s_add_u32 s27, s27, s35
    s_add_u32 s27, s27, 384
    s_lshl_b32 s27, s27, 13
    s_add_u32 s56, s27, s26
    s_lshl_b32 s35, s20, 15
    s_add_u32 s35, s35, 32768
    v_add_u32 v220, s35, v228
    v_add_u32 v221, s35, v229
    s_add_u32 m0, s35, 0
    s_add_u32 s27, s50, 0
    buffer_load_dwordx4 v6, s[12:15], s27 offen lds
    s_add_u32 m0, s35, 1024
    s_add_u32 s27, s50, 0
    buffer_load_dwordx4 v7, s[12:15], s27 offen lds
    s_add_u32 m0, s35, 2048
    s_add_u32 s27, s50, 128
    buffer_load_dwordx4 v6, s[12:15], s27 offen lds
    s_add_u32 m0, s35, 3072
    s_add_u32 s27, s50, 128
    buffer_load_dwordx4 v7, s[12:15], s27 offen lds
    s_add_u32 m0, s35, 4096
    s_add_u32 s27, s50, 256
    buffer_load_dwordx4 v6, s[12:15], s27 offen lds
    s_add_u32 m0, s35, 5120
    s_add_u32 s27, s50, 256
    buffer_load_dwordx4 v7, s[12:15], s27 offen lds
    s_add_u32 m0, s35, 6144
    s_add_u32 s27, s50, 384
    buffer_load_dwordx4 v6, s[12:15], s27 offen lds
    s_add_u32 m0, s35, 7168
    s_add_u32 s27, s50, 384
    buffer_load_dwordx4 v7, s[12:15], s27 offen lds
    s_add_u32 m0, s35, 8192
    s_add_u32 s27, s51, 0
    buffer_load_dwordx4 v6, s[12:15], s27 offen lds
    s_add_u32 m0, s35, 9216
    s_add_u32 s27, s51, 0
    buffer_load_dwordx4 v7, s[12:15], s27 offen lds
    s_add_u32 m0, s35, 10240
    s_add_u32 s27, s51, 128
    buffer_load_dwordx4 v6, s[12:15], s27 offen lds
    s_add_u32 m0, s35, 11264
    s_add_u32 s27, s51, 128
    buffer_load_dwordx4 v7, s[12:15], s27 offen lds
    s_add_u32 m0, s35, 12288
    s_add_u32 s27, s51, 256
    buffer_load_dwordx4 v6, s[12:15], s27 offen lds
    s_add_u32 m0, s35, 13312
    s_add_u32 s27, s51, 256
    buffer_load_dwordx4 v7, s[12:15], s27 offen lds
    s_add_u32 m0, s35, 14336
    s_add_u32 s27, s51, 384
    buffer_load_dwordx4 v6, s[12:15], s27 offen lds
    s_add_u32 m0, s35, 15360
    s_add_u32 s27, s51, 384
    buffer_load_dwordx4 v7, s[12:15], s27 offen lds
    s_add_u32 m0, s35, 16384
    s_add_u32 s27, s52, 0
    buffer_load_dwordx4 v6, s[12:15], s27 offen lds
    s_add_u32 m0, s35, 17408
    s_add_u32 s27, s52, 0
    buffer_load_dwordx4 v7, s[12:15], s27 offen lds
    s_add_u32 m0, s35, 18432
    s_add_u32 s27, s52, 128
    buffer_load_dwordx4 v6, s[12:15], s27 offen lds
    s_add_u32 m0, s35, 19456
    s_add_u32 s27, s52, 128
    buffer_load_dwordx4 v7, s[12:15], s27 offen lds
    s_add_u32 m0, s35, 20480
    s_add_u32 s27, s52, 256
    buffer_load_dwordx4 v6, s[12:15], s27 offen lds
    s_add_u32 m0, s35, 21504
    s_add_u32 s27, s52, 256
    buffer_load_dwordx4 v7, s[12:15], s27 offen lds
    s_add_u32 m0, s35, 22528
    s_add_u32 s27, s52, 384
    buffer_load_dwordx4 v6, s[12:15], s27 offen lds
    s_add_u32 m0, s35, 23552
    s_add_u32 s27, s52, 384
    buffer_load_dwordx4 v7, s[12:15], s27 offen lds
    v_lshrrev_b32 v14, 2, v1
    v_and_b32 v15, 3, v1
    v_lshlrev_b32 v14, 13, v14
    v_lshl_add_u32 v14, v15, 7, v14
    buffer_load_dword v246, v14, s[12:15], s28 offen
    s_waitcnt vmcnt(17)
    s_barrier
    ds_read_b128 v[32:35], v220 offset:0
    ds_read_b128 v[36:39], v221 offset:0
    ds_read_b128 v[40:43], v220 offset:2048
    ds_read_b128 v[44:47], v221 offset:2048
    ds_read_b128 v[48:51], v220 offset:4096
    ds_read_b128 v[52:55], v221 offset:4096
    ds_read_b128 v[56:59], v220 offset:6144
    ds_read_b128 v[60:63], v221 offset:6144
    s_waitcnt lgkmcnt(0)
    ds_read_b128 a[0:3], v228 offset:0
    ds_read_b128 a[4:7], v228 offset:2048
    ds_read_b128 a[8:11], v228 offset:4096
    ds_read_b128 a[12:15], v228 offset:6144
    ds_read_b128 a[16:19], v229 offset:0
    ds_read_b128 a[20:23], v229 offset:2048
    ds_read_b128 a[24:27], v229 offset:4096
    ds_read_b128 a[28:31], v229 offset:6144
    ds_read_b128 a[32:35], v228 offset:8192
    ds_read_b128 a[36:39], v228 offset:10240
    ds_read_b128 a[40:43], v228 offset:12288
    ds_read_b128 a[44:47], v228 offset:14336
    s_waitcnt lgkmcnt(8)
    ds_read_b128 a[48:51], v229 offset:8192
    ds_read_b128 a[52:55], v229 offset:10240
    ds_read_b128 a[56:59], v229 offset:12288
    ds_read_b128 a[60:63], v229 offset:14336
    v_mfma_f32_16x16x32_bf16 v[16:19], a[0:3], v[32:35], 0
    s_add_u32 m0, s35, 24576
    s_add_u32 s27, s53, 0
    buffer_load_dwordx4 v6, s[12:15], s27 offen lds
    v_mfma_f32_16x16x32_bf16 v[20:23], a[4:7], v[32:35], 0
    v_mfma_f32_16x16x32_bf16 v[24:27], a[8:11], v[32:35], 0
    v_mfma_f32_16x16x32_bf16 v[28:31], a[12:15], v[32:35], 0
    s_waitcnt lgkmcnt(8)
    ds_read_b128 a[64:67], v228 offset:16384
    ds_read_b128 a[68:71], v228 offset:18432
    ds_read_b128 a[72:75], v228 offset:20480
    ds_read_b128 a[76:79], v228 offset:22528
    v_mfma_f32_16x16x32_bf16 v[16:19], a[16:19], v[36:39], v[16:19]
    s_add_u32 m0, s35, 25600
    s_add_u32 s27, s53, 0
    buffer_load_dwordx4 v7, s[12:15], s27 offen lds
    v_mfma_f32_16x16x32_bf16 v[20:23], a[20:23], v[36:39], v[20:23]
    v_mfma_f32_16x16x32_bf16 v[24:27], a[24:27], v[36:39], v[24:27]
    v_mfma_f32_16x16x32_bf16 v[28:31], a[28:31], v[36:39], v[28:31]
    s_waitcnt lgkmcnt(8)
    ds_read_b128 a[80:83], v229 offset:16384
    ds_read_b128 a[84:87], v229 offset:18432
    ds_read_b128 a[88:91], v229 offset:20480
    ds_read_b128 a[92:95], v229 offset:22528
    v_mfma_f32_16x16x32_bf16 v[16:19], a[32:35], v[40:43], v[16:19]
    s_add_u32 m0, s35, 26624
    s_add_u32 s27, s53, 128
    buffer_load_dwordx4 v6, s[12:15], s27 offen lds
    v_mfma_f32_16x16x32_bf16 v[20:23], a[36:39], v[40:43], v[20:23]
    v_mfma_f32_16x16x32_bf16 v[24:27], a[40:43], v[40:43], v[24:27]
    v_mfma_f32_16x16x32_bf16 v[28:31], a[44:47], v[40:43], v[28:31]
    s_waitcnt lgkmcnt(8)
    ds_read_b128 a[96:99], v228 offset:24576
    ds_read_b128 a[100:103], v228 offset:26624
    ds_read_b128 a[104:107], v228 offset:28672
    ds_read_b128 a[108:111], v228 offset:30720
    v_mfma_f32_16x16x32_bf16 v[16:19], a[48:51], v[44:47], v[16:19]
    s_add_u32 m0, s35, 27648
    s_add_u32 s27, s53, 128
    buffer_load_dwordx4 v7, s[12:15], s27 offen lds
    v_mfma_f32_16x16x32_bf16 v[20:23], a[52:55], v[44:47], v[20:23]
    v_mfma_f32_16x16x32_bf16 v[24:27], a[56:59], v[44:47], v[24:27]
    v_mfma_f32_16x16x32_bf16 v[28:31], a[60:63], v[44:47], v[28:31]
    s_waitcnt lgkmcnt(8)
    ds_read_b128 a[112:115], v229 offset:24576
    ds_read_b128 a[116:119], v229 offset:26624
    ds_read_b128 a[120:123], v229 offset:28672
    ds_read_b128 a[124:127], v229 offset:30720
    v_mfma_f32_16x16x32_bf16 v[16:19], a[64:67], v[48:51], v[16:19]
    s_add_u32 m0, s35, 28672
    s_add_u32 s27, s53, 256
    buffer_load_dwordx4 v6, s[12:15], s27 offen lds
    v_mfma_f32_16x16x32_bf16 v[20:23], a[68:71], v[48:51], v[20:23]
    v_mfma_f32_16x16x32_bf16 v[24:27], a[72:75], v[48:51], v[24:27]
    v_mfma_f32_16x16x32_bf16 v[28:31], a[76:79], v[48:51], v[28:31]
    s_waitcnt lgkmcnt(8)
    v_mfma_f32_16x16x32_bf16 v[16:19], a[80:83], v[52:55], v[16:19]
    s_add_u32 m0, s35, 29696
    s_add_u32 s27, s53, 256
    buffer_load_dwordx4 v7, s[12:15], s27 offen lds
    v_mfma_f32_16x16x32_bf16 v[20:23], a[84:87], v[52:55], v[20:23]
    v_mfma_f32_16x16x32_bf16 v[24:27], a[88:91], v[52:55], v[24:27]
    v_mfma_f32_16x16x32_bf16 v[28:31], a[92:95], v[52:55], v[28:31]
    s_waitcnt lgkmcnt(4)
    v_mfma_f32_16x16x32_bf16 v[16:19], a[96:99], v[56:59], v[16:19]
    s_add_u32 m0, s35, 30720
    s_add_u32 s27, s53, 384
    buffer_load_dwordx4 v6, s[12:15], s27 offen lds
    v_mfma_f32_16x16x32_bf16 v[20:23], a[100:103], v[56:59], v[20:23]
    v_mfma_f32_16x16x32_bf16 v[24:27], a[104:107], v[56:59], v[24:27]
    v_mfma_f32_16x16x32_bf16 v[28:31], a[108:111], v[56:59], v[28:31]
    s_waitcnt lgkmcnt(0)
    v_mfma_f32_16x16x32_bf16 v[16:19], a[112:115], v[60:63], v[16:19]
    s_add_u32 m0, s35, 31744
    s_add_u32 s27, s53, 384
    buffer_load_dwordx4 v7, s[12:15], s27 offen lds
    v_mfma_f32_16x16x32_bf16 v[20:23], a[116:119], v[60:63], v[20:23]
    v_mfma_f32_16x16x32_bf16 v[24:27], a[120:123], v[60:63], v[24:27]
    v_mfma_f32_16x16x32_bf16 v[28:31], a[124:127], v[60:63], v[28:31]
    s_lshl_b32 s27, s20, 12
    v_mov_b32 v219, s27
    buffer_load_dword v216, v219, s[16:19], 0 offen offset:128 sc1
    s_waitcnt vmcnt(18)
    ds_read_b128 v[64:67], v220 offset:8192
    ds_read_b128 v[68:71], v221 offset:8192
    ds_read_b128 v[72:75], v220 offset:10240
    ds_read_b128 v[76:79], v221 offset:10240
    ds_read_b128 v[80:83], v220 offset:12288
    ds_read_b128 v[84:87], v221 offset:12288
    ds_read_b128 v[88:91], v220 offset:14336
    ds_read_b128 v[92:95], v221 offset:14336
    v_mul_f32 v16, s34, v16
    v_mul_f32 v17, s34, v17
    v_mul_f32 v18, s34, v18
    v_mul_f32 v19, s34, v19
    v_mul_f32 v20, s34, v20
    v_mul_f32 v21, s34, v21
    v_mul_f32 v22, s34, v22
    v_mul_f32 v23, s34, v23
    v_mul_f32 v24, s34, v24
    v_mul_f32 v25, s34, v25
    v_mul_f32 v26, s34, v26
    v_mul_f32 v27, s34, v27
    v_mul_f32 v28, s34, v28
    v_mul_f32 v29, s34, v29
    v_mul_f32 v30, s34, v30
    v_mul_f32 v31, s34, v31
    v_cvt_pk_bf16_f32 v160, v16, v17
    v_cvt_pk_bf16_f32 v161, v24, v25
    v_cvt_pk_bf16_f32 v162, v18, v19
    v_cvt_pk_bf16_f32 v163, v26, v27
    v_cvt_pk_bf16_f32 v164, v20, v21
    v_cvt_pk_bf16_f32 v165, v28, v29
    v_cvt_pk_bf16_f32 v166, v22, v23
    v_cvt_pk_bf16_f32 v167, v30, v31
    buffer_store_dwordx4 v[160:163], v12, s[4:7], s32 offen sc1
    buffer_store_dwordx4 v[164:167], v12, s[4:7], s32 offen offset:1024 sc1
    s_add_u32 s32, s32, 14336
    s_waitcnt lgkmcnt(0)
    v_mfma_f32_16x16x32_bf16 v[16:19], a[0:3], v[64:67], 0
    s_add_u32 m0, s35, 0
    s_add_u32 s27, s54, 0
    buffer_load_dwordx4 v8, s[12:15], s27 offen lds
    v_mfma_f32_16x16x32_bf16 v[20:23], a[4:7], v[64:67], 0
    v_mfma_f32_16x16x32_bf16 v[24:27], a[8:11], v[64:67], 0
    v_mfma_f32_16x16x32_bf16 v[28:31], a[12:15], v[64:67], 0
    v_mfma_f32_16x16x32_bf16 v[16:19], a[16:19], v[68:71], v[16:19]
    s_add_u32 m0, s35, 1024
    s_add_u32 s27, s54, 0
    buffer_load_dwordx4 v9, s[12:15], s27 offen lds
    v_mfma_f32_16x16x32_bf16 v[20:23], a[20:23], v[68:71], v[20:23]
    v_mfma_f32_16x16x32_bf16 v[24:27], a[24:27], v[68:71], v[24:27]
    v_mfma_f32_16x16x32_bf16 v[28:31], a[28:31], v[68:71], v[28:31]
    v_mfma_f32_16x16x32_bf16 v[16:19], a[32:35], v[72:75], v[16:19]
    s_add_u32 m0, s35, 2048
    s_add_u32 s27, s54, 128
    buffer_load_dwordx4 v8, s[12:15], s27 offen lds
    v_mfma_f32_16x16x32_bf16 v[20:23], a[36:39], v[72:75], v[20:23]
    v_mfma_f32_16x16x32_bf16 v[24:27], a[40:43], v[72:75], v[24:27]
    v_mfma_f32_16x16x32_bf16 v[28:31], a[44:47], v[72:75], v[28:31]
    v_mfma_f32_16x16x32_bf16 v[16:19], a[48:51], v[76:79], v[16:19]
    s_add_u32 m0, s35, 3072
    s_add_u32 s27, s54, 128
    buffer_load_dwordx4 v9, s[12:15], s27 offen lds
    v_mfma_f32_16x16x32_bf16 v[20:23], a[52:55], v[76:79], v[20:23]
    v_mfma_f32_16x16x32_bf16 v[24:27], a[56:59], v[76:79], v[24:27]
    v_mfma_f32_16x16x32_bf16 v[28:31], a[60:63], v[76:79], v[28:31]
    v_mfma_f32_16x16x32_bf16 v[16:19], a[64:67], v[80:83], v[16:19]
    s_add_u32 m0, s35, 4096
    s_add_u32 s27, s54, 256
    buffer_load_dwordx4 v8, s[12:15], s27 offen lds
    v_mfma_f32_16x16x32_bf16 v[20:23], a[68:71], v[80:83], v[20:23]
    v_mfma_f32_16x16x32_bf16 v[24:27], a[72:75], v[80:83], v[24:27]
    v_mfma_f32_16x16x32_bf16 v[28:31], a[76:79], v[80:83], v[28:31]
    v_mfma_f32_16x16x32_bf16 v[16:19], a[80:83], v[84:87], v[16:19]
    s_add_u32 m0, s35, 5120
    s_add_u32 s27, s54, 256
    buffer_load_dwordx4 v9, s[12:15], s27 offen lds
    v_mfma_f32_16x16x32_bf16 v[20:23], a[84:87], v[84:87], v[20:23]
    v_mfma_f32_16x16x32_bf16 v[24:27], a[88:91], v[84:87], v[24:27]
    v_mfma_f32_16x16x32_bf16 v[28:31], a[92:95], v[84:87], v[28:31]
    v_mfma_f32_16x16x32_bf16 v[16:19], a[96:99], v[88:91], v[16:19]
    s_add_u32 m0, s35, 6144
    s_add_u32 s27, s54, 384
    buffer_load_dwordx4 v8, s[12:15], s27 offen lds
    v_mfma_f32_16x16x32_bf16 v[20:23], a[100:103], v[88:91], v[20:23]
    v_mfma_f32_16x16x32_bf16 v[24:27], a[104:107], v[88:91], v[24:27]
    v_mfma_f32_16x16x32_bf16 v[28:31], a[108:111], v[88:91], v[28:31]
    v_mfma_f32_16x16x32_bf16 v[16:19], a[112:115], v[92:95], v[16:19]
    s_add_u32 m0, s35, 7168
    s_add_u32 s27, s54, 384
    buffer_load_dwordx4 v9, s[12:15], s27 offen lds
    v_mfma_f32_16x16x32_bf16 v[20:23], a[116:119], v[92:95], v[20:23]
    v_mfma_f32_16x16x32_bf16 v[24:27], a[120:123], v[92:95], v[24:27]
    v_mfma_f32_16x16x32_bf16 v[28:31], a[124:127], v[92:95], v[28:31]
    s_waitcnt vmcnt(20)
    s_cmp_lg_u32 s20, 0
    s_cbranch_scc1 L_gate_171
    s_waitcnt vmcnt(10)
    v_cmp_gt_u32 vcc, 1, v216
    s_cbranch_vccz L_Jiok_172
L_Ji_173:
    s_sub_u32 s23, s23, 1
    s_cbranch_scc1 M_exit
    buffer_load_dword v216, off, s[16:19], 0 offset:128 sc1
    s_waitcnt vmcnt(0)
    v_cmp_gt_u32 vcc, 1, v216
    s_cbranch_vccnz L_Ji_173
L_Jiok_172:
L_gate_171:
    s_barrier
    ds_read_b128 v[96:99], v220 offset:16384
    ds_read_b128 v[100:103], v221 offset:16384
    ds_read_b128 v[104:107], v220 offset:18432
    ds_read_b128 v[108:111], v221 offset:18432
    ds_read_b128 v[112:115], v220 offset:20480
    ds_read_b128 v[116:119], v221 offset:20480
    ds_read_b128 v[120:123], v220 offset:22528
    ds_read_b128 v[124:127], v221 offset:22528
    s_waitcnt vmcnt(8)
    v_mov_b32 v218, 1
    s_mov_b64 exec, 1
    buffer_store_dword v218, off, s[4:7], s30 sc1
    s_mov_b64 exec, -1
    v_mul_f32 v16, s34, v16
    v_mul_f32 v17, s34, v17
    v_mul_f32 v18, s34, v18
    v_mul_f32 v19, s34, v19
    v_mul_f32 v20, s34, v20
    v_mul_f32 v21, s34, v21
    v_mul_f32 v22, s34, v22
    v_mul_f32 v23, s34, v23
    v_mul_f32 v24, s34, v24
    v_mul_f32 v25, s34, v25
    v_mul_f32 v26, s34, v26
    v_mul_f32 v27, s34, v27
    v_mul_f32 v28, s34, v28
    v_mul_f32 v29, s34, v29
    v_mul_f32 v30, s34, v30
    v_mul_f32 v31, s34, v31
    v_cvt_pk_bf16_f32 v168, v16, v17
    v_cvt_pk_bf16_f32 v169, v24, v25
    v_cvt_pk_bf16_f32 v170, v18, v19
    v_cvt_pk_bf16_f32 v171, v26, v27
    v_cvt_pk_bf16_f32 v172, v20, v21
    v_cvt_pk_bf16_f32 v173, v28, v29
    v_cvt_pk_bf16_f32 v174, v22, v23
    v_cvt_pk_bf16_f32 v175, v30, v31
    buffer_store_dwordx4 v[168:171], v12, s[4:7], s32 offen sc1
    buffer_store_dwordx4 v[172:175], v12, s[4:7], s32 offen offset:1024 sc1
    s_add_u32 s32, s32, 14336
    s_waitcnt lgkmcnt(0)
    v_mfma_f32_16x16x32_bf16 v[16:19], a[0:3], v[96:99], 0
    s_add_u32 m0, s35, 8192
    s_add_u32 s27, s55, 0
    buffer_load_dwordx4 v8, s[12:15], s27 offen lds
    v_mfma_f32_16x16x32_bf16 v[20:23], a[4:7], v[96:99], 0
    v_mfma_f32_16x16x32_bf16 v[24:27], a[8:11], v[96:99], 0
    v_mfma_f32_16x16x32_bf16 v[28:31], a[12:15], v[96:99], 0
    v_mfma_f32_16x16x32_bf16 v[16:19], a[16:19], v[100:103], v[16:19]
    s_add_u32 m0, s35, 9216
    s_add_u32 s27, s55, 0
    buffer_load_dwordx4 v9, s[12:15], s27 offen lds
    v_mfma_f32_16x16x32_bf16 v[20:23], a[20:23], v[100:103], v[20:23]
    v_mfma_f32_16x16x32_bf16 v[24:27], a[24:27], v[100:103], v[24:27]
    v_mfma_f32_16x16x32_bf16 v[28:31], a[28:31], v[100:103], v[28:31]
    v_mfma_f32_16x16x32_bf16 v[16:19], a[32:35], v[104:107], v[16:19]
    s_add_u32 m0, s35, 10240
    s_add_u32 s27, s55, 128
    buffer_load_dwordx4 v8, s[12:15], s27 offen lds
    v_mfma_f32_16x16x32_bf16 v[20:23], a[36:39], v[104:107], v[20:23]
    v_mfma_f32_16x16x32_bf16 v[24:27], a[40:43], v[104:107], v[24:27]
    v_mfma_f32_16x16x32_bf16 v[28:31], a[44:47], v[104:107], v[28:31]
    v_mfma_f32_16x16x32_bf16 v[16:19], a[48:51], v[108:111], v[16:19]
    s_add_u32 m0, s35, 11264
    s_add_u32 s27, s55, 128
    buffer_load_dwordx4 v9, s[12:15], s27 offen lds
    v_mfma_f32_16x16x32_bf16 v[20:23], a[52:55], v[108:111], v[20:23]
    v_mfma_f32_16x16x32_bf16 v[24:27], a[56:59], v[108:111], v[24:27]
    v_mfma_f32_16x16x32_bf16 v[28:31], a[60:63], v[108:111], v[28:31]
    v_mfma_f32_16x16x32_bf16 v[16:19], a[64:67], v[112:115], v[16:19]
    s_add_u32 m0, s35, 12288
    s_add_u32 s27, s55, 256
    buffer_load_dwordx4 v8, s[12:15], s27 offen lds
    v_mfma_f32_16x16x32_bf16 v[20:23], a[68:71], v[112:115], v[20:23]
    v_mfma_f32_16x16x32_bf16 v[24:27], a[72:75], v[112:115], v[24:27]
    v_mfma_f32_16x16x32_bf16 v[28:31], a[76:79], v[112:115], v[28:31]
    v_mfma_f32_16x16x32_bf16 v[16:19], a[80:83], v[116:119], v[16:19]
    s_add_u32 m0, s35, 13312
    s_add_u32 s27, s55, 256
    buffer_load_dwordx4 v9, s[12:15], s27 offen lds
    v_mfma_f32_16x16x32_bf16 v[20:23], a[84:87], v[116:119], v[20:23]
    v_mfma_f32_16x16x32_bf16 v[24:27], a[88:91], v[116:119], v[24:27]
    v_mfma_f32_16x16x32_bf16 v[28:31], a[92:95], v[116:119], v[28:31]
    v_mfma_f32_16x16x32_bf16 v[16:19], a[96:99], v[120:123], v[16:19]
    s_add_u32 m0, s35, 14336
    s_add_u32 s27, s55, 384
    buffer_load_dwordx4 v8, s[12:15], s27 offen lds
    v_mfma_f32_16x16x32_bf16 v[20:23], a[100:103], v[120:123], v[20:23]
    v_mfma_f32_16x16x32_bf16 v[24:27], a[104:107], v[120:123], v[24:27]
    v_mfma_f32_16x16x32_bf16 v[28:31], a[108:111], v[120:123], v[28:31]
    v_mfma_f32_16x16x32_bf16 v[16:19], a[112:115], v[124:127], v[16:19]
    s_add_u32 m0, s35, 15360
    s_add_u32 s27, s55, 384
    buffer_load_dwordx4 v9, s[12:15], s27 offen lds
    v_mfma_f32_16x16x32_bf16 v[20:23], a[116:119], v[124:127], v[20:23]
    v_mfma_f32_16x16x32_bf16 v[24:27], a[120:123], v[124:127], v[24:27]
    v_mfma_f32_16x16x32_bf16 v[28:31], a[124:127], v[124:127], v[28:31]
    s_waitcnt vmcnt(22)
    ds_read_b128 v[128:131], v220 offset:24576
    ds_read_b128 v[132:135], v221 offset:24576
    ds_read_b128 v[136:139], v220 offset:26624
    ds_read_b128 v[140:143], v221 offset:26624
    ds_read_b128 v[144:147], v220 offset:28672
    ds_read_b128 v[148:151], v221 offset:28672
    ds_read_b128 v[152:155], v220 offset:30720
    ds_read_b128 v[156:159], v221 offset:30720
    s_waitcnt vmcnt(8)
    v_mov_b32 v217, 2
    s_mov_b64 exec, 1
    buffer_store_dword v217, off, s[4:7], s30 sc1
    s_mov_b64 exec, -1
    v_mul_f32 v16, s34, v16
    v_mul_f32 v17, s34, v17
    v_mul_f32 v18, s34, v18
    v_mul_f32 v19, s34, v19
    v_mul_f32 v20, s34, v20
    v_mul_f32 v21, s34, v21
    v_mul_f32 v22, s34, v22
    v_mul_f32 v23, s34, v23
    v_mul_f32 v24, s34, v24
    v_mul_f32 v25, s34, v25
    v_mul_f32 v26, s34, v26
    v_mul_f32 v27, s34, v27
    v_mul_f32 v28, s34, v28
    v_mul_f32 v29, s34, v29
    v_mul_f32 v30, s34, v30
    v_mul_f32 v31, s34, v31
    v_cvt_pk_bf16_f32 v176, v16, v17
    v_cvt_pk_bf16_f32 v177, v24, v25
    v_cvt_pk_bf16_f32 v178, v18, v19
    v_cvt_pk_bf16_f32 v179, v26, v27
    v_cvt_pk_bf16_f32 v180, v20, v21
    v_cvt_pk_bf16_f32 v181, v28, v29
    v_cvt_pk_bf16_f32 v182, v22, v23
    v_cvt_pk_bf16_f32 v183, v30, v31
    buffer_store_dwordx4 v[176:179], v12, s[4:7], s32 offen sc1
    buffer_store_dwordx4 v[180:183], v12, s[4:7], s32 offen offset:1024 sc1
    s_add_u32 s32, s32, 14336
    s_waitcnt lgkmcnt(0)
    v_mfma_f32_16x16x32_bf16 v[16:19], a[0:3], v[128:131], 0
    s_add_u32 m0, s35, 16384
    s_add_u32 s27, s56, 0
    buffer_load_dwordx4 v8, s[12:15], s27 offen lds
    v_mfma_f32_16x16x32_bf16 v[20:23], a[4:7], v[128:131], 0
    v_mfma_f32_16x16x32_bf16 v[24:27], a[8:11], v[128:131], 0
    v_mfma_f32_16x16x32_bf16 v[28:31], a[12:15], v[128:131], 0
    v_mfma_f32_16x16x32_bf16 v[16:19], a[16:19], v[132:135], v[16:19]
    s_add_u32 m0, s35, 17408
    s_add_u32 s27, s56, 0
    buffer_load_dwordx4 v9, s[12:15], s27 offen lds
    v_mfma_f32_16x16x32_bf16 v[20:23], a[20:23], v[132:135], v[20:23]
    v_mfma_f32_16x16x32_bf16 v[24:27], a[24:27], v[132:135], v[24:27]
    v_mfma_f32_16x16x32_bf16 v[28:31], a[28:31], v[132:135], v[28:31]
    v_mfma_f32_16x16x32_bf16 v[16:19], a[32:35], v[136:139], v[16:19]
    s_add_u32 m0, s35, 18432
    s_add_u32 s27, s56, 128
    buffer_load_dwordx4 v8, s[12:15], s27 offen lds
    v_mfma_f32_16x16x32_bf16 v[20:23], a[36:39], v[136:139], v[20:23]
    v_mfma_f32_16x16x32_bf16 v[24:27], a[40:43], v[136:139], v[24:27]
    v_mfma_f32_16x16x32_bf16 v[28:31], a[44:47], v[136:139], v[28:31]
    v_mfma_f32_16x16x32_bf16 v[16:19], a[48:51], v[140:143], v[16:19]
    s_add_u32 m0, s35, 19456
    s_add_u32 s27, s56, 128
    buffer_load_dwordx4 v9, s[12:15], s27 offen lds
    v_mfma_f32_16x16x32_bf16 v[20:23], a[52:55], v[140:143], v[20:23]
    v_mfma_f32_16x16x32_bf16 v[24:27], a[56:59], v[140:143], v[24:27]
    v_mfma_f32_16x16x32_bf16 v[28:31], a[60:63], v[140:143], v[28:31]
    v_mfma_f32_16x16x32_bf16 v[16:19], a[64:67], v[144:147], v[16:19]
    s_add_u32 m0, s35, 20480
    s_add_u32 s27, s56, 256
    buffer_load_dwordx4 v8, s[12:15], s27 offen lds
    v_mfma_f32_16x16x32_bf16 v[20:23], a[68:71], v[144:147], v[20:23]
    v_mfma_f32_16x16x32_bf16 v[24:27], a[72:75], v[144:147], v[24:27]
    v_mfma_f32_16x16x32_bf16 v[28:31], a[76:79], v[144:147], v[28:31]
    v_mfma_f32_16x16x32_bf16 v[16:19], a[80:83], v[148:151], v[16:19]
    s_add_u32 m0, s35, 21504
    s_add_u32 s27, s56, 256
    buffer_load_dwordx4 v9, s[12:15], s27 offen lds
    v_mfma_f32_16x16x32_bf16 v[20:23], a[84:87], v[148:151], v[20:23]
    v_mfma_f32_16x16x32_bf16 v[24:27], a[88:91], v[148:151], v[24:27]
    v_mfma_f32_16x16x32_bf16 v[28:31], a[92:95], v[148:151], v[28:31]
    v_mfma_f32_16x16x32_bf16 v[16:19], a[96:99], v[152:155], v[16:19]
    s_add_u32 m0, s35, 22528
    s_add_u32 s27, s56, 384
    buffer_load_dwordx4 v8, s[12:15], s27 offen lds
    v_mfma_f32_16x16x32_bf16 v[20:23], a[100:103], v[152:155], v[20:23]
    v_mfma_f32_16x16x32_bf16 v[24:27], a[104:107], v[152:155], v[24:27]
    v_mfma_f32_16x16x32_bf16 v[28:31], a[108:111], v[152:155], v[28:31]
    v_mfma_f32_16x16x32_bf16 v[16:19], a[112:115], v[156:159], v[16:19]
    s_add_u32 m0, s35, 23552
    s_add_u32 s27, s56, 384
    buffer_load_dwordx4 v9, s[12:15], s27 offen lds
    v_mfma_f32_16x16x32_bf16 v[20:23], a[116:119], v[156:159], v[20:23]
    v_mfma_f32_16x16x32_bf16 v[24:27], a[120:123], v[156:159], v[24:27]
    v_mfma_f32_16x16x32_bf16 v[28:31], a[124:127], v[156:159], v[28:31]
    s_waitcnt vmcnt(22)
    ds_read_b128 v[32:35], v220 offset:0
    ds_read_b128 v[36:39], v221 offset:0
    ds_read_b128 v[40:43], v220 offset:2048
    ds_read_b128 v[44:47], v221 offset:2048
    ds_read_b128 v[48:51], v220 offset:4096
    ds_read_b128 v[52:55], v221 offset:4096
    ds_read_b128 v[56:59], v220 offset:6144
    ds_read_b128 v[60:63], v221 offset:6144
    s_waitcnt vmcnt(8)
    v_mov_b32 v218, 3
    s_mov_b64 exec, 1
    buffer_store_dword v218, off, s[4:7], s30 sc1
    s_mov_b64 exec, -1
    v_mul_f32 v16, s34, v16
    v_mul_f32 v17, s34, v17
    v_mul_f32 v18, s34, v18
    v_mul_f32 v19, s34, v19
    v_mul_f32 v20, s34, v20
    v_mul_f32 v21, s34, v21
    v_mul_f32 v22, s34, v22
    v_mul_f32 v23, s34, v23
    v_mul_f32 v24, s34, v24
    v_mul_f32 v25, s34, v25
    v_mul_f32 v26, s34, v26
    v_mul_f32 v27, s34, v27
    v_mul_f32 v28, s34, v28
    v_mul_f32 v29, s34, v29
    v_mul_f32 v30, s34, v30
    v_mul_f32 v31, s34, v31
    v_cvt_pk_bf16_f32 v184, v16, v17
    v_cvt_pk_bf16_f32 v185, v24, v25
    v_cvt_pk_bf16_f32 v186, v18, v19
    v_cvt_pk_bf16_f32 v187, v26, v27
    v_cvt_pk_bf16_f32 v188, v20, v21
    v_cvt_pk_bf16_f32 v189, v28, v29
    v_cvt_pk_bf16_f32 v190, v22, v23
    v_cvt_pk_bf16_f32 v191, v30, v31
    buffer_store_dwordx4 v[184:187], v12, s[4:7], s32 offen sc1
    buffer_store_dwordx4 v[188:191], v12, s[4:7], s32 offen offset:1024 sc1
    s_add_u32 s32, s32, 14336
    s_waitcnt lgkmcnt(0)
    v_mfma_f32_16x16x32_bf16 v[16:19], a[0:3], v[32:35], 0
    v_mfma_f32_16x16x32_bf16 v[20:23], a[4:7], v[32:35], 0
    v_mfma_f32_16x16x32_bf16 v[24:27], a[8:11], v[32:35], 0
    v_mfma_f32_16x16x32_bf16 v[28:31], a[12:15], v[32:35], 0
    v_mfma_f32_16x16x32_bf16 v[16:19], a[16:19], v[36:39], v[16:19]
    v_mfma_f32_16x16x32_bf16 v[20:23], a[20:23], v[36:39], v[20:23]
    v_mfma_f32_16x16x32_bf16 v[24:27], a[24:27], v[36:39], v[24:27]
    v_mfma_f32_16x16x32_bf16 v[28:31], a[28:31], v[36:39], v[28:31]
    v_mfma_f32_16x16x32_bf16 v[16:19], a[32:35], v[40:43], v[16:19]
    v_mfma_f32_16x16x32_bf16 v[20:23], a[36:39], v[40:43], v[20:23]
    v_mfma_f32_16x16x32_bf16 v[24:27], a[40:43], v[40:43], v[24:27]
    v_mfma_f32_16x16x32_bf16 v[28:31], a[44:47], v[40:43], v[28:31]
    v_mfma_f32_16x16x32_bf16 v[16:19], a[48:51], v[44:47], v[16:19]
    v_mfma_f32_16x16x32_bf16 v[20:23], a[52:55], v[44:47], v[20:23]
    v_mfma_f32_16x16x32_bf16 v[24:27], a[56:59], v[44:47], v[24:27]
    v_mfma_f32_16x16x32_bf16 v[28:31], a[60:63], v[44:47], v[28:31]
    v_mfma_f32_16x16x32_bf16 v[16:19], a[64:67], v[48:51], v[16:19]
    v_mfma_f32_16x16x32_bf16 v[20:23], a[68:71], v[48:51], v[20:23]
    v_mfma_f32_16x16x32_bf16 v[24:27], a[72:75], v[48:51], v[24:27]
    v_mfma_f32_16x16x32_bf16 v[28:31], a[76:79], v[48:51], v[28:31]
    v_mfma_f32_16x16x32_bf16 v[16:19], a[80:83], v[52:55], v[16:19]
    v_mfma_f32_16x16x32_bf16 v[20:23], a[84:87], v[52:55], v[20:23]
    v_mfma_f32_16x16x32_bf16 v[24:27], a[88:91], v[52:55], v[24:27]
    v_mfma_f32_16x16x32_bf16 v[28:31], a[92:95], v[52:55], v[28:31]
    v_mfma_f32_16x16x32_bf16 v[16:19], a[96:99], v[56:59], v[16:19]
    v_mfma_f32_16x16x32_bf16 v[20:23], a[100:103], v[56:59], v[20:23]
    v_mfma_f32_16x16x32_bf16 v[24:27], a[104:107], v[56:59], v[24:27]
    v_mfma_f32_16x16x32_bf16 v[28:31], a[108:111], v[56:59], v[28:31]
    v_mfma_f32_16x16x32_bf16 v[16:19], a[112:115], v[60:63], v[16:19]
    v_mfma_f32_16x16x32_bf16 v[20:23], a[116:119], v[60:63], v[20:23]
    v_mfma_f32_16x16x32_bf16 v[24:27], a[120:123], v[60:63], v[24:27]
    v_mfma_f32_16x16x32_bf16 v[28:31], a[124:127], v[60:63], v[28:31]
    s_waitcnt vmcnt(14)
    ds_read_b128 v[64:67], v220 offset:8192
    ds_read_b128 v[68:71], v221 offset:8192
    ds_read_b128 v[72:75], v220 offset:10240
    ds_read_b128 v[76:79], v221 offset:10240
    ds_read_b128 v[80:83], v220 offset:12288
    ds_read_b128 v[84:87], v221 offset:12288
    ds_read_b128 v[88:91], v220 offset:14336
    ds_read_b128 v[92:95], v221 offset:14336
    s_waitcnt vmcnt(0)
    v_mov_b32 v217, 4
    s_mov_b64 exec, 1
    buffer_store_dword v217, off, s[4:7], s30 sc1
    s_mov_b64 exec, -1
    v_mul_f32 v16, s34, v16
    v_mul_f32 v17, s34, v17
    v_mul_f32 v18, s34, v18
    v_mul_f32 v19, s34, v19
    v_mul_f32 v20, s34, v20
    v_mul_f32 v21, s34, v21
    v_mul_f32 v22, s34, v22
    v_mul_f32 v23, s34, v23
    v_mul_f32 v24, s34, v24
    v_mul_f32 v25, s34, v25
    v_mul_f32 v26, s34, v26
    v_mul_f32 v27, s34, v27
    v_mul_f32 v28, s34, v28
    v_mul_f32 v29, s34, v29
    v_mul_f32 v30, s34, v30
    v_mul_f32 v31, s34, v31
    v_cvt_pk_bf16_f32 v192, v16, v17
    v_cvt_pk_bf16_f32 v193, v24, v25
    v_cvt_pk_bf16_f32 v194, v18, v19
    v_cvt_pk_bf16_f32 v195, v26, v27
    v_cvt_pk_bf16_f32 v196, v20, v21
    v_cvt_pk_bf16_f32 v197, v28, v29
    v_cvt_pk_bf16_f32 v198, v22, v23
    v_cvt_pk_bf16_f32 v199, v30, v31
    buffer_store_dwordx4 v[192:195], v12, s[4:7], s32 offen sc1
    buffer_store_dwordx4 v[196:199], v12, s[4:7], s32 offen offset:1024 sc1
    s_add_u32 s32, s32, 14336
    s_waitcnt lgkmcnt(0)
    v_mfma_f32_16x16x32_bf16 v[16:19], a[0:3], v[64:67], 0
    v_mfma_f32_16x16x32_bf16 v[20:23], a[4:7], v[64:67], 0
    v_mfma_f32_16x16x32_bf16 v[24:27], a[8:11], v[64:67], 0
    v_mfma_f32_16x16x32_bf16 v[28:31], a[12:15], v[64:67], 0
    v_mfma_f32_16x16x32_bf16 v[16:19], a[16:19], v[68:71], v[16:19]
    v_mfma_f32_16x16x32_bf16 v[20:23], a[20:23], v[68:71], v[20:23]
    v_mfma_f32_16x16x32_bf16 v[24:27], a[24:27], v[68:71], v[24:27]
    v_mfma_f32_16x16x32_bf16 v[28:31], a[28:31], v[68:71], v[28:31]
    v_mfma_f32_16x16x32_bf16 v[16:19], a[32:35], v[72:75], v[16:19]
    v_mfma_f32_16x16x32_bf16 v[20:23], a[36:39], v[72:75], v[20:23]
    v_mfma_f32_16x16x32_bf16 v[24:27], a[40:43], v[72:75], v[24:27]
    v_mfma_f32_16x16x32_bf16 v[28:31], a[44:47], v[72:75], v[28:31]
    v_mfma_f32_16x16x32_bf16 v[16:19], a[48:51], v[76:79], v[16:19]
    v_mfma_f32_16x16x32_bf16 v[20:23], a[52:55], v[76:79], v[20:23]
    v_mfma_f32_16x16x32_bf16 v[24:27], a[56:59], v[76:79], v[24:27]
    v_mfma_f32_16x16x32_bf16 v[28:31], a[60:63], v[76:79], v[28:31]
    v_mfma_f32_16x16x32_bf16 v[16:19], a[64:67], v[80:83], v[16:19]
    v_mfma_f32_16x16x32_bf16 v[20:23], a[68:71], v[80:83], v[20:23]
    v_mfma_f32_16x16x32_bf16 v[24:27], a[72:75], v[80:83], v[24:27]
    v_mfma_f32_16x16x32_bf16 v[28:31], a[76:79], v[80:83], v[28:31]
    v_mfma_f32_16x16x32_bf16 v[16:19], a[80:83], v[84:87], v[16:19]
    v_mfma_f32_16x16x32_bf16 v[20:23], a[84:87], v[84:87], v[20:23]
    v_mfma_f32_16x16x32_bf16 v[24:27], a[88:91], v[84:87], v[24:27]
    v_mfma_f32_16x16x32_bf16 v[28:31], a[92:95], v[84:87], v[28:31]
    v_mfma_f32_16x16x32_bf16 v[16:19], a[96:99], v[88:91], v[16:19]
    v_mfma_f32_16x16x32_bf16 v[20:23], a[100:103], v[88:91], v[20:23]
    v_mfma_f32_16x16x32_bf16 v[24:27], a[104:107], v[88:91], v[24:27]
    v_mfma_f32_16x16x32_bf16 v[28:31], a[108:111], v[88:91], v[28:31]
    v_mfma_f32_16x16x32_bf16 v[16:19], a[112:115], v[92:95], v[16:19]
    v_mfma_f32_16x16x32_bf16 v[20:23], a[116:119], v[92:95], v[20:23]
    v_mfma_f32_16x16x32_bf16 v[24:27], a[120:123], v[92:95], v[24:27]
    v_mfma_f32_16x16x32_bf16 v[28:31], a[124:127], v[92:95], v[28:31]
    s_waitcnt vmcnt(6)
    ds_read_b128 v[96:99], v220 offset:16384
    ds_read_b128 v[100:103], v221 offset:16384
    ds_read_b128 v[104:107], v220 offset:18432
    ds_read_b128 v[108:111], v221 offset:18432
    ds_read_b128 v[112:115], v220 offset:20480
    ds_read_b128 v[116:119], v221 offset:20480
    ds_read_b128 v[120:123], v220 offset:22528
    ds_read_b128 v[124:127], v221 offset:22528
    s_waitcnt vmcnt(0)
    v_mov_b32 v218, 5
    s_mov_b64 exec, 1
    buffer_store_dword v218, off, s[4:7], s30 sc1
    s_mov_b64 exec, -1
    v_mul_f32 v16, s34, v16
    v_mul_f32 v17, s34, v17
    v_mul_f32 v18, s34, v18
    v_mul_f32 v19, s34, v19
    v_mul_f32 v20, s34, v20
    v_mul_f32 v21, s34, v21
    v_mul_f32 v22, s34, v22
    v_mul_f32 v23, s34, v23
    v_mul_f32 v24, s34, v24
    v_mul_f32 v25, s34, v25
    v_mul_f32 v26, s34, v26
    v_mul_f32 v27, s34, v27
    v_mul_f32 v28, s34, v28
    v_mul_f32 v29, s34, v29
    v_mul_f32 v30, s34, v30
    v_mul_f32 v31, s34, v31
    v_cvt_pk_bf16_f32 v200, v16, v17
    v_cvt_pk_bf16_f32 v201, v24, v25
    v_cvt_pk_bf16_f32 v202, v18, v19
    v_cvt_pk_bf16_f32 v203, v26, v27
    v_cvt_pk_bf16_f32 v204, v20, v21
    v_cvt_pk_bf16_f32 v205, v28, v29
    v_cvt_pk_bf16_f32 v206, v22, v23
    v_cvt_pk_bf16_f32 v207, v30, v31
    buffer_store_dwordx4 v[200:203], v12, s[4:7], s32 offen sc1
    buffer_store_dwordx4 v[204:207], v12, s[4:7], s32 offen offset:1024 sc1
    s_add_u32 s32, s32, 14336
    s_waitcnt lgkmcnt(0)
    v_mfma_f32_16x16x32_bf16 v[16:19], a[0:3], v[96:99], 0
    v_mfma_f32_16x16x32_bf16 v[20:23], a[4:7], v[96:99], 0
    v_mfma_f32_16x16x32_bf16 v[24:27], a[8:11], v[96:99], 0
    v_mfma_f32_16x16x32_bf16 v[28:31], a[12:15], v[96:99], 0
    v_mfma_f32_16x16x32_bf16 v[16:19], a[16:19], v[100:103], v[16:19]
    v_mfma_f32_16x16x32_bf16 v[20:23], a[20:23], v[100:103], v[20:23]
    v_mfma_f32_16x16x32_bf16 v[24:27], a[24:27], v[100:103], v[24:27]
    v_mfma_f32_16x16x32_bf16 v[28:31], a[28:31], v[100:103], v[28:31]
    v_mfma_f32_16x16x32_bf16 v[16:19], a[32:35], v[104:107], v[16:19]
    v_mfma_f32_16x16x32_bf16 v[20:23], a[36:39], v[104:107], v[20:23]
    v_mfma_f32_16x16x32_bf16 v[24:27], a[40:43], v[104:107], v[24:27]
    v_mfma_f32_16x16x32_bf16 v[28:31], a[44:47], v[104:107], v[28:31]
    v_mfma_f32_16x16x32_bf16 v[16:19], a[48:51], v[108:111], v[16:19]
    v_mfma_f32_16x16x32_bf16 v[20:23], a[52:55], v[108:111], v[20:23]
    v_mfma_f32_16x16x32_bf16 v[24:27], a[56:59], v[108:111], v[24:27]
    v_mfma_f32_16x16x32_bf16 v[28:31], a[60:63], v[108:111], v[28:31]
    v_mfma_f32_16x16x32_bf16 v[16:19], a[64:67], v[112:115], v[16:19]
    v_mfma_f32_16x16x32_bf16 v[20:23], a[68:71], v[112:115], v[20:23]
    v_mfma_f32_16x16x32_bf16 v[24:27], a[72:75], v[112:115], v[24:27]
    v_mfma_f32_16x16x32_bf16 v[28:31], a[76:79], v[112:115], v[28:31]
    v_mfma_f32_16x16x32_bf16 v[16:19], a[80:83], v[116:119], v[16:19]
    v_mfma_f32_16x16x32_bf16 v[20:23], a[84:87], v[116:119], v[20:23]
    v_mfma_f32_16x16x32_bf16 v[24:27], a[88:91], v[116:119], v[24:27]
    v_mfma_f32_16x16x32_bf16 v[28:31], a[92:95], v[116:119], v[28:31]
    v_mfma_f32_16x16x32_bf16 v[16:19], a[96:99], v[120:123], v[16:19]
    v_mfma_f32_16x16x32_bf16 v[20:23], a[100:103], v[120:123], v[20:23]
    v_mfma_f32_16x16x32_bf16 v[24:27], a[104:107], v[120:123], v[24:27]
    v_mfma_f32_16x16x32_bf16 v[28:31], a[108:111], v[120:123], v[28:31]
    v_mfma_f32_16x16x32_bf16 v[16:19], a[112:115], v[124:127], v[16:19]
    v_mfma_f32_16x16x32_bf16 v[20:23], a[116:119], v[124:127], v[20:23]
    v_mfma_f32_16x16x32_bf16 v[24:27], a[120:123], v[124:127], v[24:27]
    v_mfma_f32_16x16x32_bf16 v[28:31], a[124:127], v[124:127], v[28:31]
    s_nop 6
    v_mul_f32 v16, s34, v16
    v_mul_f32 v17, s34, v17
    v_mul_f32 v18, s34, v18
    v_mul_f32 v19, s34, v19
    v_mul_f32 v20, s34, v20
    v_mul_f32 v21, s34, v21
    v_mul_f32 v22, s34, v22
    v_mul_f32 v23, s34, v23
    v_mul_f32 v24, s34, v24
    v_mul_f32 v25, s34, v25
    v_mul_f32 v26, s34, v26
    v_mul_f32 v27, s34, v27
    v_mul_f32 v28, s34, v28
    v_mul_f32 v29, s34, v29
    v_mul_f32 v30, s34, v30
    v_mul_f32 v31, s34, v31
    v_cvt_pk_bf16_f32 v208, v16, v17
    v_cvt_pk_bf16_f32 v209, v24, v25
    v_cvt_pk_bf16_f32 v210, v18, v19
    v_cvt_pk_bf16_f32 v211, v26, v27
    v_cvt_pk_bf16_f32 v212, v20, v21
    v_cvt_pk_bf16_f32 v213, v28, v29
    v_cvt_pk_bf16_f32 v214, v22, v23
    v_cvt_pk_bf16_f32 v215, v30, v31
    buffer_store_dwordx4 v[208:211], v12, s[4:7], s32 offen sc1
    buffer_store_dwordx4 v[212:215], v12, s[4:7], s32 offen offset:1024 sc1
    s_add_u32 s32, s32, 14336
    s_branch J_tail
J_b:
    s_lshr_b32 s33, s25, 2
    s_lshl_b32 s33, s33, 1
    s_add_u32 s27, s33, 0
    s_cmp_ge_u32 s27, 7
    s_cselect_b32 s31, 7, 0
    s_sub_u32 s50, s27, s31
    s_add_u32 s27, s33, 1
    s_cmp_ge_u32 s27, 7
    s_cselect_b32 s31, 7, 0
    s_sub_u32 s51, s27, s31
    s_add_u32 s27, s33, 2
    s_cmp_ge_u32 s27, 7
    s_cselect_b32 s31, 7, 0
    s_sub_u32 s52, s27, s31
    s_add_u32 s27, s33, 3
    s_cmp_ge_u32 s27, 7
    s_cselect_b32 s31, 7, 0
    s_sub_u32 s53, s27, s31
    s_add_u32 s27, s33, 4
    s_cmp_ge_u32 s27, 7
    s_cselect_b32 s31, 7, 0
    s_sub_u32 s54, s27, s31
    s_add_u32 s27, s33, 5
    s_cmp_ge_u32 s27, 7
    s_cselect_b32 s31, 7, 0
    s_sub_u32 s55, s27, s31
    s_add_u32 s27, s33, 6
    s_cmp_ge_u32 s27, 7
    s_cselect_b32 s31, 7, 0
    s_sub_u32 s56, s27, s31
    s_mul_i32 s27, s20, 14336
    s_add_u32 s34, s32, s27
    s_add_u32 s34, s34, 0x620000
    s_mul_i32 s27, s50, 57344
    s_add_u32 s32, s34, s27
    s_mul_i32 s26, s25, 229376
    s_mul_i32 s27, s20, 57344
    s_add_u32 s26, s26, s27
    v_lshrrev_b32 v13, 3, v1
    v_mul_u32_u24 v13, 0x380, v13
    v_lshlrev_b32 v14, 1, v11
    v_and_b32 v15, 7, v1
    v_xor_b32 v14, v14, v15
    v_lshl_add_u32 v6, v14, 4, v13
    v_xor_b32 v14, 4, v14
    v_lshl_add_u32 v7, v14, 4, v13
    s_lshl_b32 s35, s20, 13
    s_add_u32 s35, s35, 32768
    v_bfe_u32 v13, v1, 2, 2
    v_lshrrev_b32 v14, 1, v13
    v_lshl_add_u32 v14, v11, 1, v14
    v_and_b32 v14, 3, v14
    v_xor_b32 v14, s20, v14
    v_lshl_add_u32 v13, v11, 3, v13
    v_lshlrev_b32 v13, 7, v13
    v_lshl_add_u32 v13, v14, 5, v13
    v_and_b32 v14, 3, v1
    v_lshl_add_u32 v13, v14, 3, v13
    v_add_u32 v220, 32768, v13
    v_xor_b32 v221, 64, v220
    v_add_u32 v221, 512, v221
    v_add_u32 v222, 0x10000, v220
    v_add_u32 v223, 0x10000, v221
    s_lshl_b32 s31, s50, 7
    s_add_u32 s31, s31, s26
    s_add_u32 m0, s35, 0
    s_add_u32 s27, s31, 0
    buffer_load_dwordx4 v6, s[12:15], s27 offen lds
    s_add_u32 m0, s35, 1024
    s_add_u32 s27, s31, 7168
    buffer_load_dwordx4 v7, s[12:15], s27 offen lds
    s_add_u32 m0, s35, 2048
    s_add_u32 s27, s31, 14336
    buffer_load_dwordx4 v6, s[12:15], s27 offen lds
    s_add_u32 m0, s35, 3072
    s_add_u32 s27, s31, 21504
    buffer_load_dwordx4 v7, s[12:15], s27 offen lds
    s_add_u32 m0, s35, 4096
    s_add_u32 s27, s31, 28672
    buffer_load_dwordx4 v6, s[12:15], s27 offen lds
    s_add_u32 m0, s35, 5120
    s_add_u32 s27, s31, 35840
    buffer_load_dwordx4 v7, s[12:15], s27 offen lds
    s_add_u32 m0, s35, 6144
    s_add_u32 s27, s31, 43008
    buffer_load_dwordx4 v6, s[12:15], s27 offen lds
    s_add_u32 m0, s35, 7168
    s_add_u32 s27, s31, 50176
    buffer_load_dwordx4 v7, s[12:15], s27 offen lds
    s_lshl_b32 s31, s51, 7
    s_add_u32 s31, s31, s26
    s_add_u32 m0, s35, 32768
    s_add_u32 s27, s31, 0
    buffer_load_dwordx4 v6, s[12:15], s27 offen lds
    s_add_u32 m0, s35, 33792
    s_add_u32 s27, s31, 7168
    buffer_load_dwordx4 v7, s[12:15], s27 offen lds
    s_add_u32 m0, s35, 34816
    s_add_u32 s27, s31, 14336
    buffer_load_dwordx4 v6, s[12:15], s27 offen lds
    s_add_u32 m0, s35, 35840
    s_add_u32 s27, s31, 21504
    buffer_load_dwordx4 v7, s[12:15], s27 offen lds
    s_add_u32 m0, s35, 36864
    s_add_u32 s27, s31, 28672
    buffer_load_dwordx4 v6, s[12:15], s27 offen lds
    s_add_u32 m0, s35, 37888
    s_add_u32 s27, s31, 35840
    buffer_load_dwordx4 v7, s[12:15], s27 offen lds
    s_add_u32 m0, s35, 38912
    s_add_u32 s27, s31, 43008
    buffer_load_dwordx4 v6, s[12:15], s27 offen lds
    s_add_u32 m0, s35, 39936
    s_add_u32 s27, s31, 50176
    buffer_load_dwordx4 v7, s[12:15], s27 offen lds
    s_lshl_b32 s31, s52, 7
    s_add_u32 s31, s31, s26
    s_add_u32 m0, s35, 65536
    s_add_u32 s27, s31, 0
    buffer_load_dwordx4 v6, s[12:15], s27 offen lds
    s_add_u32 m0, s35, 66560
    s_add_u32 s27, s31, 7168
    buffer_load_dwordx4 v7, s[12:15], s27 offen lds
    s_add_u32 m0, s35, 67584
    s_add_u32 s27, s31, 14336
    buffer_load_dwordx4 v6, s[12:15], s27 offen lds
    s_add_u32 m0, s35, 68608
    s_add_u32 s27, s31, 21504
    buffer_load_dwordx4 v7, s[12:15], s27 offen lds
    s_add_u32 m0, s35, 69632
    s_add_u32 s27, s31, 28672
    buffer_load_dwordx4 v6, s[12:15], s27 offen lds
    s_add_u32 m0, s35, 70656
    s_add_u32 s27, s31, 35840
    buffer_load_dwordx4 v7, s[12:15], s27 offen lds
    s_add_u32 m0, s35, 71680
    s_add_u32 s27, s31, 43008
    buffer_load_dwordx4 v6, s[12:15], s27 offen lds
    s_add_u32 m0, s35, 72704
    s_add_u32 s27, s31, 50176
    buffer_load_dwordx4 v7, s[12:15], s27 offen lds
    s_lshl_b32 s27, s24, 2
    s_add_u32 s27, s27, s20
    s_lshl_b32 s27, s27, 13
    s_mul_i32 s31, s25, 229376
    s_add_u32 s27, s27, s31
    v_lshlrev_b32 v14, 7, v1
    buffer_load_dword v246, v14, s[12:15], s27 offen
    s_waitcnt vmcnt(17)
    s_barrier
    ds_read_b64_tr_b16 v[32:33], v220 offset:0
    ds_read_b64_tr_b16 v[34:35], v221 offset:0
    ds_read_b64_tr_b16 v[36:37], v220 offset:4096
    ds_read_b64_tr_b16 v[38:39], v221 offset:4096
    ds_read_b64_tr_b16 v[40:41], v220 offset:8192
    ds_read_b64_tr_b16 v[42:43], v221 offset:8192
    ds_read_b64_tr_b16 v[44:45], v220 offset:12288
    ds_read_b64_tr_b16 v[46:47], v221 offset:12288
    ds_read_b64_tr_b16 v[48:49], v220 offset:16384
    ds_read_b64_tr_b16 v[50:51], v221 offset:16384
    ds_read_b64_tr_b16 v[52:53], v220 offset:20480
    ds_read_b64_tr_b16 v[54:55], v221 offset:20480
    ds_read_b64_tr_b16 v[56:57], v220 offset:24576
    ds_read_b64_tr_b16 v[58:59], v221 offset:24576
    s_waitcnt lgkmcnt(12)
    ds_read_b64_tr_b16 v[60:61], v220 offset:28672
    ds_read_b64_tr_b16 v[62:63], v221 offset:28672
    s_waitcnt lgkmcnt(0)
    ds_read_b128 a[0:3], v228 offset:0
    ds_read_b128 a[4:7], v228 offset:2048
    ds_read_b128 a[8:11], v228 offset:4096
    ds_read_b128 a[12:15], v228 offset:6144
    ds_read_b128 a[16:19], v229 offset:0
    ds_read_b128 a[20:23], v229 offset:2048
    ds_read_b128 a[24:27], v229 offset:4096
    ds_read_b128 a[28:31], v229 offset:6144
    ds_read_b128 a[32:35], v228 offset:8192
    ds_read_b128 a[36:39], v228 offset:10240
    ds_read_b128 a[40:43], v228 offset:12288
    ds_read_b128 a[44:47], v228 offset:14336
    s_waitcnt lgkmcnt(8)
    ds_read_b128 a[48:51], v229 offset:8192
    ds_read_b128 a[52:55], v229 offset:10240
    ds_read_b128 a[56:59], v229 offset:12288
    ds_read_b128 a[60:63], v229 offset:14336
    v_mfma_f32_16x16x32_bf16 v[16:19], a[0:3], v[32:35], 0
    s_lshl_b32 s31, s53, 7
    s_add_u32 s31, s31, s26
    s_add_u32 m0, s35, 98304
    s_add_u32 s27, s31, 0
    buffer_load_dwordx4 v6, s[12:15], s27 offen lds
    v_mfma_f32_16x16x32_bf16 v[20:23], a[4:7], v[32:35], 0
    v_mfma_f32_16x16x32_bf16 v[24:27], a[8:11], v[32:35], 0
    v_mfma_f32_16x16x32_bf16 v[28:31], a[12:15], v[32:35], 0
    s_waitcnt lgkmcnt(8)
    ds_read_b128 a[64:67], v228 offset:16384
    ds_read_b128 a[68:71], v228 offset:18432
    ds_read_b128 a[72:75], v228 offset:20480
    ds_read_b128 a[76:79], v228 offset:22528
    v_mfma_f32_16x16x32_bf16 v[16:19], a[16:19], v[36:39], v[16:19]
    s_add_u32 m0, s35, 99328
    s_add_u32 s27, s31, 7168
    buffer_load_dwordx4 v7, s[12:15], s27 offen lds
    v_mfma_f32_16x16x32_bf16 v[20:23], a[20:23], v[36:39], v[20:23]
    v_mfma_f32_16x16x32_bf16 v[24:27], a[24:27], v[36:39], v[24:27]
    v_mfma_f32_16x16x32_bf16 v[28:31], a[28:31], v[36:39], v[28:31]
    s_waitcnt lgkmcnt(8)
    ds_read_b128 a[80:83], v229 offset:16384
    ds_read_b128 a[84:87], v229 offset:18432
    ds_read_b128 a[88:91], v229 offset:20480
    ds_read_b128 a[92:95], v229 offset:22528
    v_mfma_f32_16x16x32_bf16 v[16:19], a[32:35], v[40:43], v[16:19]
    s_add_u32 m0, s35, 100352
    s_add_u32 s27, s31, 14336
    buffer_load_dwordx4 v6, s[12:15], s27 offen lds
    v_mfma_f32_16x16x32_bf16 v[20:23], a[36:39], v[40:43], v[20:23]
    v_mfma_f32_16x16x32_bf16 v[24:27], a[40:43], v[40:43], v[24:27]
    v_mfma_f32_16x16x32_bf16 v[28:31], a[44:47], v[40:43], v[28:31]
    s_waitcnt lgkmcnt(8)
    ds_read_b128 a[96:99], v228 offset:24576
    ds_read_b128 a[100:103], v228 offset:26624
    ds_read_b128 a[104:107], v228 offset:28672
    ds_read_b128 a[108:111], v228 offset:30720
    v_mfma_f32_16x16x32_bf16 v[16:19], a[48:51], v[44:47], v[16:19]
    s_add_u32 m0, s35, 101376
    s_add_u32 s27, s31, 21504
    buffer_load_dwordx4 v7, s[12:15], s27 offen lds
    v_mfma_f32_16x16x32_bf16 v[20:23], a[52:55], v[44:47], v[20:23]
    v_mfma_f32_16x16x32_bf16 v[24:27], a[56:59], v[44:47], v[24:27]
    v_mfma_f32_16x16x32_bf16 v[28:31], a[60:63], v[44:47], v[28:31]
    s_waitcnt lgkmcnt(8)
    ds_read_b128 a[112:115], v229 offset:24576
    ds_read_b128 a[116:119], v229 offset:26624
    ds_read_b128 a[120:123], v229 offset:28672
    ds_read_b128 a[124:127], v229 offset:30720
    v_mfma_f32_16x16x32_bf16 v[16:19], a[64:67], v[48:51], v[16:19]
    s_add_u32 m0, s35, 102400
    s_add_u32 s27, s31, 28672
    buffer_load_dwordx4 v6, s[12:15], s27 offen lds
    v_mfma_f32_16x16x32_bf16 v[20:23], a[68:71], v[48:51], v[20:23]
    v_mfma_f32_16x16x32_bf16 v[24:27], a[72:75], v[48:51], v[24:27]
    v_mfma_f32_16x16x32_bf16 v[28:31], a[76:79], v[48:51], v[28:31]
    s_waitcnt lgkmcnt(8)
    v_mfma_f32_16x16x32_bf16 v[16:19], a[80:83], v[52:55], v[16:19]
    s_add_u32 m0, s35, 103424
    s_add_u32 s27, s31, 35840
    buffer_load_dwordx4 v7, s[12:15], s27 offen lds
    v_mfma_f32_16x16x32_bf16 v[20:23], a[84:87], v[52:55], v[20:23]
    v_mfma_f32_16x16x32_bf16 v[24:27], a[88:91], v[52:55], v[24:27]
    v_mfma_f32_16x16x32_bf16 v[28:31], a[92:95], v[52:55], v[28:31]
    s_waitcnt lgkmcnt(4)
    v_mfma_f32_16x16x32_bf16 v[16:19], a[96:99], v[56:59], v[16:19]
    s_add_u32 m0, s35, 104448
    s_add_u32 s27, s31, 43008
    buffer_load_dwordx4 v6, s[12:15], s27 offen lds
    v_mfma_f32_16x16x32_bf16 v[20:23], a[100:103], v[56:59], v[20:23]
    v_mfma_f32_16x16x32_bf16 v[24:27], a[104:107], v[56:59], v[24:27]
    v_mfma_f32_16x16x32_bf16 v[28:31], a[108:111], v[56:59], v[28:31]
    s_waitcnt lgkmcnt(0)
    v_mfma_f32_16x16x32_bf16 v[16:19], a[112:115], v[60:63], v[16:19]
    s_add_u32 m0, s35, 105472
    s_add_u32 s27, s31, 50176
    buffer_load_dwordx4 v7, s[12:15], s27 offen lds
    v_mfma_f32_16x16x32_bf16 v[20:23], a[116:119], v[60:63], v[20:23]
    v_mfma_f32_16x16x32_bf16 v[24:27], a[120:123], v[60:63], v[24:27]
    v_mfma_f32_16x16x32_bf16 v[28:31], a[124:127], v[60:63], v[28:31]
    s_lshl_b32 s27, s20, 12
    v_mov_b32 v219, s27
    buffer_load_dword v216, v219, s[16:19], 0 offen offset:128 sc1
    s_waitcnt vmcnt(18)
    s_barrier
    ds_read_b64_tr_b16 v[64:65], v220 offset:32768
    ds_read_b64_tr_b16 v[66:67], v221 offset:32768
    ds_read_b64_tr_b16 v[68:69], v220 offset:36864
    ds_read_b64_tr_b16 v[70:71], v221 offset:36864
    ds_read_b64_tr_b16 v[72:73], v220 offset:40960
    ds_read_b64_tr_b16 v[74:75], v221 offset:40960
    ds_read_b64_tr_b16 v[76:77], v220 offset:45056
    ds_read_b64_tr_b16 v[78:79], v221 offset:45056
    ds_read_b64_tr_b16 v[80:81], v220 offset:49152
    ds_read_b64_tr_b16 v[82:83], v221 offset:49152
    ds_read_b64_tr_b16 v[84:85], v220 offset:53248
    ds_read_b64_tr_b16 v[86:87], v221 offset:53248
    ds_read_b64_tr_b16 v[88:89], v220 offset:57344
    ds_read_b64_tr_b16 v[90:91], v221 offset:57344
    s_waitcnt lgkmcnt(12)
    ds_read_b64_tr_b16 v[92:93], v220 offset:61440
    ds_read_b64_tr_b16 v[94:95], v221 offset:61440
    v_cvt_pk_bf16_f32 v160, v16, v17
    v_cvt_pk_bf16_f32 v161, v24, v25
    v_cvt_pk_bf16_f32 v162, v18, v19
    v_cvt_pk_bf16_f32 v163, v26, v27
    v_cvt_pk_bf16_f32 v164, v20, v21
    v_cvt_pk_bf16_f32 v165, v28, v29
    v_cvt_pk_bf16_f32 v166, v22, v23
    v_cvt_pk_bf16_f32 v167, v30, v31
    buffer_store_dwordx4 v[160:163], v12, s[4:7], s32 offen sc1
    buffer_store_dwordx4 v[164:167], v12, s[4:7], s32 offen offset:1024 sc1
    s_mul_i32 s27, s51, 57344
    s_add_u32 s32, s34, s27
    s_waitcnt lgkmcnt(0)
    v_mfma_f32_16x16x32_bf16 v[16:19], a[0:3], v[64:67], 0
    s_lshl_b32 s31, s54, 7
    s_add_u32 s31, s31, s26
    s_add_u32 m0, s35, 0
    s_add_u32 s27, s31, 0
    buffer_load_dwordx4 v6, s[12:15], s27 offen lds
    v_mfma_f32_16x16x32_bf16 v[20:23], a[4:7], v[64:67], 0
    v_mfma_f32_16x16x32_bf16 v[24:27], a[8:11], v[64:67], 0
    v_mfma_f32_16x16x32_bf16 v[28:31], a[12:15], v[64:67], 0
    v_mfma_f32_16x16x32_bf16 v[16:19], a[16:19], v[68:71], v[16:19]
    s_add_u32 m0, s35, 1024
    s_add_u32 s27, s31, 7168
    buffer_load_dwordx4 v7, s[12:15], s27 offen lds
    v_mfma_f32_16x16x32_bf16 v[20:23], a[20:23], v[68:71], v[20:23]
    v_mfma_f32_16x16x32_bf16 v[24:27], a[24:27], v[68:71], v[24:27]
    v_mfma_f32_16x16x32_bf16 v[28:31], a[28:31], v[68:71], v[28:31]
    v_mfma_f32_16x16x32_bf16 v[16:19], a[32:35], v[72:75], v[16:19]
    s_add_u32 m0, s35, 2048
    s_add_u32 s27, s31, 14336
    buffer_load_dwordx4 v6, s[12:15], s27 offen lds
    v_mfma_f32_16x16x32_bf16 v[20:23], a[36:39], v[72:75], v[20:23]
    v_mfma_f32_16x16x32_bf16 v[24:27], a[40:43], v[72:75], v[24:27]
    v_mfma_f32_16x16x32_bf16 v[28:31], a[44:47], v[72:75], v[28:31]
    v_mfma_f32_16x16x32_bf16 v[16:19], a[48:51], v[76:79], v[16:19]
    s_add_u32 m0, s35, 3072
    s_add_u32 s27, s31, 21504
    buffer_load_dwordx4 v7, s[12:15], s27 offen lds
    v_mfma_f32_16x16x32_bf16 v[20:23], a[52:55], v[76:79], v[20:23]
    v_mfma_f32_16x16x32_bf16 v[24:27], a[56:59], v[76:79], v[24:27]
    v_mfma_f32_16x16x32_bf16 v[28:31], a[60:63], v[76:79], v[28:31]
    v_mfma_f32_16x16x32_bf16 v[16:19], a[64:67], v[80:83], v[16:19]
    s_add_u32 m0, s35, 4096
    s_add_u32 s27, s31, 28672
    buffer_load_dwordx4 v6, s[12:15], s27 offen lds
    v_mfma_f32_16x16x32_bf16 v[20:23], a[68:71], v[80:83], v[20:23]
    v_mfma_f32_16x16x32_bf16 v[24:27], a[72:75], v[80:83], v[24:27]
    v_mfma_f32_16x16x32_bf16 v[28:31], a[76:79], v[80:83], v[28:31]
    v_mfma_f32_16x16x32_bf16 v[16:19], a[80:83], v[84:87], v[16:19]
    s_add_u32 m0, s35, 5120
    s_add_u32 s27, s31, 35840
    buffer_load_dwordx4 v7, s[12:15], s27 offen lds
    v_mfma_f32_16x16x32_bf16 v[20:23], a[84:87], v[84:87], v[20:23]
    v_mfma_f32_16x16x32_bf16 v[24:27], a[88:91], v[84:87], v[24:27]
    v_mfma_f32_16x16x32_bf16 v[28:31], a[92:95], v[84:87], v[28:31]
    v_mfma_f32_16x16x32_bf16 v[16:19], a[96:99], v[88:91], v[16:19]
    s_add_u32 m0, s35, 6144
    s_add_u32 s27, s31, 43008
    buffer_load_dwordx4 v6, s[12:15], s27 offen lds
    v_mfma_f32_16x16x32_bf16 v[20:23], a[100:103], v[88:91], v[20:23]
    v_mfma_f32_16x16x32_bf16 v[24:27], a[104:107], v[88:91], v[24:27]
    v_mfma_f32_16x16x32_bf16 v[28:31], a[108:111], v[88:91], v[28:31]
    v_mfma_f32_16x16x32_bf16 v[16:19], a[112:115], v[92:95], v[16:19]
    s_add_u32 m0, s35, 7168
    s_add_u32 s27, s31, 50176
    buffer_load_dwordx4 v7, s[12:15], s27 offen lds
    v_mfma_f32_16x16x32_bf16 v[20:23], a[116:119], v[92:95], v[20:23]
    v_mfma_f32_16x16x32_bf16 v[24:27], a[120:123], v[92:95], v[24:27]
    v_mfma_f32_16x16x32_bf16 v[28:31], a[124:127], v[92:95], v[28:31]
    s_waitcnt vmcnt(20)
    s_cmp_lg_u32 s20, 0
    s_cbranch_scc1 L_gate_174
    s_waitcnt vmcnt(10)
    v_cmp_gt_u32 vcc, 1, v216
    s_cbranch_vccz L_Jiok_175
L_Ji_176:
    s_sub_u32 s23, s23, 1
    s_cbranch_scc1 M_exit
    buffer_load_dword v216, off, s[16:19], 0 offset:128 sc1
    s_waitcnt vmcnt(0)
    v_cmp_gt_u32 vcc, 1, v216
    s_cbranch_vccnz L_Ji_176
L_Jiok_175:
L_gate_174:
    s_barrier
    ds_read_b64_tr_b16 v[96:97], v222 offset:0
    ds_read_b64_tr_b16 v[98:99], v223 offset:0
    ds_read_b64_tr_b16 v[100:101], v222 offset:4096
    ds_read_b64_tr_b16 v[102:103], v223 offset:4096
    ds_read_b64_tr_b16 v[104:105], v222 offset:8192
    ds_read_b64_tr_b16 v[106:107], v223 offset:8192
    ds_read_b64_tr_b16 v[108:109], v222 offset:12288
    ds_read_b64_tr_b16 v[110:111], v223 offset:12288
    ds_read_b64_tr_b16 v[112:113], v222 offset:16384
    ds_read_b64_tr_b16 v[114:115], v223 offset:16384
    ds_read_b64_tr_b16 v[116:117], v222 offset:20480
    ds_read_b64_tr_b16 v[118:119], v223 offset:20480
    ds_read_b64_tr_b16 v[120:121], v222 offset:24576
    ds_read_b64_tr_b16 v[122:123], v223 offset:24576
    s_waitcnt lgkmcnt(12)
    ds_read_b64_tr_b16 v[124:125], v222 offset:28672
    ds_read_b64_tr_b16 v[126:127], v223 offset:28672
    s_waitcnt vmcnt(8)
    v_mov_b32 v218, 1
    s_mov_b64 exec, 1
    buffer_store_dword v218, off, s[4:7], s30 sc1
    s_mov_b64 exec, -1
    v_cvt_pk_bf16_f32 v168, v16, v17
    v_cvt_pk_bf16_f32 v169, v24, v25
    v_cvt_pk_bf16_f32 v170, v18, v19
    v_cvt_pk_bf16_f32 v171, v26, v27
    v_cvt_pk_bf16_f32 v172, v20, v21
    v_cvt_pk_bf16_f32 v173, v28, v29
    v_cvt_pk_bf16_f32 v174, v22, v23
    v_cvt_pk_bf16_f32 v175, v30, v31
    buffer_store_dwordx4 v[168:171], v12, s[4:7], s32 offen sc1
    buffer_store_dwordx4 v[172:175], v12, s[4:7], s32 offen offset:1024 sc1
    s_mul_i32 s27, s52, 57344
    s_add_u32 s32, s34, s27
    s_waitcnt lgkmcnt(0)
    v_mfma_f32_16x16x32_bf16 v[16:19], a[0:3], v[96:99], 0
    s_lshl_b32 s31, s55, 7
    s_add_u32 s31, s31, s26
    s_add_u32 m0, s35, 32768
    s_add_u32 s27, s31, 0
    buffer_load_dwordx4 v6, s[12:15], s27 offen lds
    v_mfma_f32_16x16x32_bf16 v[20:23], a[4:7], v[96:99], 0
    v_mfma_f32_16x16x32_bf16 v[24:27], a[8:11], v[96:99], 0
    v_mfma_f32_16x16x32_bf16 v[28:31], a[12:15], v[96:99], 0
    v_mfma_f32_16x16x32_bf16 v[16:19], a[16:19], v[100:103], v[16:19]
    s_add_u32 m0, s35, 33792
    s_add_u32 s27, s31, 7168
    buffer_load_dwordx4 v7, s[12:15], s27 offen lds
    v_mfma_f32_16x16x32_bf16 v[20:23], a[20:23], v[100:103], v[20:23]
    v_mfma_f32_16x16x32_bf16 v[24:27], a[24:27], v[100:103], v[24:27]
    v_mfma_f32_16x16x32_bf16 v[28:31], a[28:31], v[100:103], v[28:31]
    v_mfma_f32_16x16x32_bf16 v[16:19], a[32:35], v[104:107], v[16:19]
    s_add_u32 m0, s35, 34816
    s_add_u32 s27, s31, 14336
    buffer_load_dwordx4 v6, s[12:15], s27 offen lds
    v_mfma_f32_16x16x32_bf16 v[20:23], a[36:39], v[104:107], v[20:23]
    v_mfma_f32_16x16x32_bf16 v[24:27], a[40:43], v[104:107], v[24:27]
    v_mfma_f32_16x16x32_bf16 v[28:31], a[44:47], v[104:107], v[28:31]
    v_mfma_f32_16x16x32_bf16 v[16:19], a[48:51], v[108:111], v[16:19]
    s_add_u32 m0, s35, 35840
    s_add_u32 s27, s31, 21504
    buffer_load_dwordx4 v7, s[12:15], s27 offen lds
    v_mfma_f32_16x16x32_bf16 v[20:23], a[52:55], v[108:111], v[20:23]
    v_mfma_f32_16x16x32_bf16 v[24:27], a[56:59], v[108:111], v[24:27]
    v_mfma_f32_16x16x32_bf16 v[28:31], a[60:63], v[108:111], v[28:31]
    v_mfma_f32_16x16x32_bf16 v[16:19], a[64:67], v[112:115], v[16:19]
    s_add_u32 m0, s35, 36864
    s_add_u32 s27, s31, 28672
    buffer_load_dwordx4 v6, s[12:15], s27 offen lds
    v_mfma_f32_16x16x32_bf16 v[20:23], a[68:71], v[112:115], v[20:23]
    v_mfma_f32_16x16x32_bf16 v[24:27], a[72:75], v[112:115], v[24:27]
    v_mfma_f32_16x16x32_bf16 v[28:31], a[76:79], v[112:115], v[28:31]
    v_mfma_f32_16x16x32_bf16 v[16:19], a[80:83], v[116:119], v[16:19]
    s_add_u32 m0, s35, 37888
    s_add_u32 s27, s31, 35840
    buffer_load_dwordx4 v7, s[12:15], s27 offen lds
    v_mfma_f32_16x16x32_bf16 v[20:23], a[84:87], v[116:119], v[20:23]
    v_mfma_f32_16x16x32_bf16 v[24:27], a[88:91], v[116:119], v[24:27]
    v_mfma_f32_16x16x32_bf16 v[28:31], a[92:95], v[116:119], v[28:31]
    v_mfma_f32_16x16x32_bf16 v[16:19], a[96:99], v[120:123], v[16:19]
    s_add_u32 m0, s35, 38912
    s_add_u32 s27, s31, 43008
    buffer_load_dwordx4 v6, s[12:15], s27 offen lds
    v_mfma_f32_16x16x32_bf16 v[20:23], a[100:103], v[120:123], v[20:23]
    v_mfma_f32_16x16x32_bf16 v[24:27], a[104:107], v[120:123], v[24:27]
    v_mfma_f32_16x16x32_bf16 v[28:31], a[108:111], v[120:123], v[28:31]
    v_mfma_f32_16x16x32_bf16 v[16:19], a[112:115], v[124:127], v[16:19]
    s_add_u32 m0, s35, 39936
    s_add_u32 s27, s31, 50176
    buffer_load_dwordx4 v7, s[12:15], s27 offen lds
    v_mfma_f32_16x16x32_bf16 v[20:23], a[116:119], v[124:127], v[20:23]
    v_mfma_f32_16x16x32_bf16 v[24:27], a[120:123], v[124:127], v[24:27]
    v_mfma_f32_16x16x32_bf16 v[28:31], a[124:127], v[124:127], v[28:31]
    s_waitcnt vmcnt(22)
    s_barrier
    ds_read_b64_tr_b16 v[128:129], v222 offset:32768
    ds_read_b64_tr_b16 v[130:131], v223 offset:32768
    ds_read_b64_tr_b16 v[132:133], v222 offset:36864
    ds_read_b64_tr_b16 v[134:135], v223 offset:36864
    ds_read_b64_tr_b16 v[136:137], v222 offset:40960
    ds_read_b64_tr_b16 v[138:139], v223 offset:40960
    ds_read_b64_tr_b16 v[140:141], v222 offset:45056
    ds_read_b64_tr_b16 v[142:143], v223 offset:45056
    ds_read_b64_tr_b16 v[144:145], v222 offset:49152
    ds_read_b64_tr_b16 v[146:147], v223 offset:49152
    ds_read_b64_tr_b16 v[148:149], v222 offset:53248
    ds_read_b64_tr_b16 v[150:151], v223 offset:53248
    ds_read_b64_tr_b16 v[152:153], v222 offset:57344
    ds_read_b64_tr_b16 v[154:155], v223 offset:57344
    s_waitcnt lgkmcnt(12)
    ds_read_b64_tr_b16 v[156:157], v222 offset:61440
    ds_read_b64_tr_b16 v[158:159], v223 offset:61440
    s_waitcnt vmcnt(8)
    v_mov_b32 v217, 2
    s_mov_b64 exec, 1
    buffer_store_dword v217, off, s[4:7], s30 sc1
    s_mov_b64 exec, -1
    v_cvt_pk_bf16_f32 v176, v16, v17
    v_cvt_pk_bf16_f32 v177, v24, v25
    v_cvt_pk_bf16_f32 v178, v18, v19
    v_cvt_pk_bf16_f32 v179, v26, v27
    v_cvt_pk_bf16_f32 v180, v20, v21
    v_cvt_pk_bf16_f32 v181, v28, v29
    v_cvt_pk_bf16_f32 v182, v22, v23
    v_cvt_pk_bf16_f32 v183, v30, v31
    buffer_store_dwordx4 v[176:179], v12, s[4:7], s32 offen sc1
    buffer_store_dwordx4 v[180:183], v12, s[4:7], s32 offen offset:1024 sc1
    s_mul_i32 s27, s53, 57344
    s_add_u32 s32, s34, s27
    s_waitcnt lgkmcnt(0)
    v_mfma_f32_16x16x32_bf16 v[16:19], a[0:3], v[128:131], 0
    s_lshl_b32 s31, s56, 7
    s_add_u32 s31, s31, s26
    s_add_u32 m0, s35, 65536
    s_add_u32 s27, s31, 0
    buffer_load_dwordx4 v6, s[12:15], s27 offen lds
    v_mfma_f32_16x16x32_bf16 v[20:23], a[4:7], v[128:131], 0
    v_mfma_f32_16x16x32_bf16 v[24:27], a[8:11], v[128:131], 0
    v_mfma_f32_16x16x32_bf16 v[28:31], a[12:15], v[128:131], 0
    v_mfma_f32_16x16x32_bf16 v[16:19], a[16:19], v[132:135], v[16:19]
    s_add_u32 m0, s35, 66560
    s_add_u32 s27, s31, 7168
    buffer_load_dwordx4 v7, s[12:15], s27 offen lds
    v_mfma_f32_16x16x32_bf16 v[20:23], a[20:23], v[132:135], v[20:23]
    v_mfma_f32_16x16x32_bf16 v[24:27], a[24:27], v[132:135], v[24:27]
    v_mfma_f32_16x16x32_bf16 v[28:31], a[28:31], v[132:135], v[28:31]
    v_mfma_f32_16x16x32_bf16 v[16:19], a[32:35], v[136:139], v[16:19]
    s_add_u32 m0, s35, 67584
    s_add_u32 s27, s31, 14336
    buffer_load_dwordx4 v6, s[12:15], s27 offen lds
    v_mfma_f32_16x16x32_bf16 v[20:23], a[36:39], v[136:139], v[20:23]
    v_mfma_f32_16x16x32_bf16 v[24:27], a[40:43], v[136:139], v[24:27]
    v_mfma_f32_16x16x32_bf16 v[28:31], a[44:47], v[136:139], v[28:31]
    v_mfma_f32_16x16x32_bf16 v[16:19], a[48:51], v[140:143], v[16:19]
    s_add_u32 m0, s35, 68608
    s_add_u32 s27, s31, 21504
    buffer_load_dwordx4 v7, s[12:15], s27 offen lds
    v_mfma_f32_16x16x32_bf16 v[20:23], a[52:55], v[140:143], v[20:23]
    v_mfma_f32_16x16x32_bf16 v[24:27], a[56:59], v[140:143], v[24:27]
    v_mfma_f32_16x16x32_bf16 v[28:31], a[60:63], v[140:143], v[28:31]
    v_mfma_f32_16x16x32_bf16 v[16:19], a[64:67], v[144:147], v[16:19]
    s_add_u32 m0, s35, 69632
    s_add_u32 s27, s31, 28672
    buffer_load_dwordx4 v6, s[12:15], s27 offen lds
    v_mfma_f32_16x16x32_bf16 v[20:23], a[68:71], v[144:147], v[20:23]
    v_mfma_f32_16x16x32_bf16 v[24:27], a[72:75], v[144:147], v[24:27]
    v_mfma_f32_16x16x32_bf16 v[28:31], a[76:79], v[144:147], v[28:31]
    v_mfma_f32_16x16x32_bf16 v[16:19], a[80:83], v[148:151], v[16:19]
    s_add_u32 m0, s35, 70656
    s_add_u32 s27, s31, 35840
    buffer_load_dwordx4 v7, s[12:15], s27 offen lds
    v_mfma_f32_16x16x32_bf16 v[20:23], a[84:87], v[148:151], v[20:23]
    v_mfma_f32_16x16x32_bf16 v[24:27], a[88:91], v[148:151], v[24:27]
    v_mfma_f32_16x16x32_bf16 v[28:31], a[92:95], v[148:151], v[28:31]
    v_mfma_f32_16x16x32_bf16 v[16:19], a[96:99], v[152:155], v[16:19]
    s_add_u32 m0, s35, 71680
    s_add_u32 s27, s31, 43008
    buffer_load_dwordx4 v6, s[12:15], s27 offen lds
    v_mfma_f32_16x16x32_bf16 v[20:23], a[100:103], v[152:155], v[20:23]
    v_mfma_f32_16x16x32_bf16 v[24:27], a[104:107], v[152:155], v[24:27]
    v_mfma_f32_16x16x32_bf16 v[28:31], a[108:111], v[152:155], v[28:31]
    v_mfma_f32_16x16x32_bf16 v[16:19], a[112:115], v[156:159], v[16:19]
    s_add_u32 m0, s35, 72704
    s_add_u32 s27, s31, 50176
    buffer_load_dwordx4 v7, s[12:15], s27 offen lds
    v_mfma_f32_16x16x32_bf16 v[20:23], a[116:119], v[156:159], v[20:23]
    v_mfma_f32_16x16x32_bf16 v[24:27], a[120:123], v[156:159], v[24:27]
    v_mfma_f32_16x16x32_bf16 v[28:31], a[124:127], v[156:159], v[28:31]
    s_waitcnt vmcnt(22)
    s_barrier
    ds_read_b64_tr_b16 v[32:33], v220 offset:0
    ds_read_b64_tr_b16 v[34:35], v221 offset:0
    ds_read_b64_tr_b16 v[36:37], v220 offset:4096
    ds_read_b64_tr_b16 v[38:39], v221 offset:4096
    ds_read_b64_tr_b16 v[40:41], v220 offset:8192
    ds_read_b64_tr_b16 v[42:43], v221 offset:8192
    ds_read_b64_tr_b16 v[44:45], v220 offset:12288
    ds_read_b64_tr_b16 v[46:47], v221 offset:12288
    ds_read_b64_tr_b16 v[48:49], v220 offset:16384
    ds_read_b64_tr_b16 v[50:51], v221 offset:16384
    ds_read_b64_tr_b16 v[52:53], v220 offset:20480
    ds_read_b64_tr_b16 v[54:55], v221 offset:20480
    ds_read_b64_tr_b16 v[56:57], v220 offset:24576
    ds_read_b64_tr_b16 v[58:59], v221 offset:24576
    s_waitcnt lgkmcnt(12)
    ds_read_b64_tr_b16 v[60:61], v220 offset:28672
    ds_read_b64_tr_b16 v[62:63], v221 offset:28672
    s_waitcnt vmcnt(8)
    v_mov_b32 v218, 3
    s_mov_b64 exec, 1
    buffer_store_dword v218, off, s[4:7], s30 sc1
    s_mov_b64 exec, -1
    v_cvt_pk_bf16_f32 v184, v16, v17
    v_cvt_pk_bf16_f32 v185, v24, v25
    v_cvt_pk_bf16_f32 v186, v18, v19
    v_cvt_pk_bf16_f32 v187, v26, v27
    v_cvt_pk_bf16_f32 v188, v20, v21
    v_cvt_pk_bf16_f32 v189, v28, v29
    v_cvt_pk_bf16_f32 v190, v22, v23
    v_cvt_pk_bf16_f32 v191, v30, v31
    buffer_store_dwordx4 v[184:187], v12, s[4:7], s32 offen sc1
    buffer_store_dwordx4 v[188:191], v12, s[4:7], s32 offen offset:1024 sc1
    s_mul_i32 s27, s54, 57344
    s_add_u32 s32, s34, s27
    s_waitcnt lgkmcnt(0)
    v_mfma_f32_16x16x32_bf16 v[16:19], a[0:3], v[32:35], 0
    v_mfma_f32_16x16x32_bf16 v[20:23], a[4:7], v[32:35], 0
    v_mfma_f32_16x16x32_bf16 v[24:27], a[8:11], v[32:35], 0
    v_mfma_f32_16x16x32_bf16 v[28:31], a[12:15], v[32:35], 0
    v_mfma_f32_16x16x32_bf16 v[16:19], a[16:19], v[36:39], v[16:19]
    v_mfma_f32_16x16x32_bf16 v[20:23], a[20:23], v[36:39], v[20:23]
    v_mfma_f32_16x16x32_bf16 v[24:27], a[24:27], v[36:39], v[24:27]
    v_mfma_f32_16x16x32_bf16 v[28:31], a[28:31], v[36:39], v[28:31]
    v_mfma_f32_16x16x32_bf16 v[16:19], a[32:35], v[40:43], v[16:19]
    v_mfma_f32_16x16x32_bf16 v[20:23], a[36:39], v[40:43], v[20:23]
    v_mfma_f32_16x16x32_bf16 v[24:27], a[40:43], v[40:43], v[24:27]
    v_mfma_f32_16x16x32_bf16 v[28:31], a[44:47], v[40:43], v[28:31]
    v_mfma_f32_16x16x32_bf16 v[16:19], a[48:51], v[44:47], v[16:19]
    v_mfma_f32_16x16x32_bf16 v[20:23], a[52:55], v[44:47], v[20:23]
    v_mfma_f32_16x16x32_bf16 v[24:27], a[56:59], v[44:47], v[24:27]
    v_mfma_f32_16x16x32_bf16 v[28:31], a[60:63], v[44:47], v[28:31]
    v_mfma_f32_16x16x32_bf16 v[16:19], a[64:67], v[48:51], v[16:19]
    v_mfma_f32_16x16x32_bf16 v[20:23], a[68:71], v[48:51], v[20:23]
    v_mfma_f32_16x16x32_bf16 v[24:27], a[72:75], v[48:51], v[24:27]
    v_mfma_f32_16x16x32_bf16 v[28:31], a[76:79], v[48:51], v[28:31]
    v_mfma_f32_16x16x32_bf16 v[16:19], a[80:83], v[52:55], v[16:19]
    v_mfma_f32_16x16x32_bf16 v[20:23], a[84:87], v[52:55], v[20:23]
    v_mfma_f32_16x16x32_bf16 v[24:27], a[88:91], v[52:55], v[24:27]
    v_mfma_f32_16x16x32_bf16 v[28:31], a[92:95], v[52:55], v[28:31]
    v_mfma_f32_16x16x32_bf16 v[16:19], a[96:99], v[56:59], v[16:19]
    v_mfma_f32_16x16x32_bf16 v[20:23], a[100:103], v[56:59], v[20:23]
    v_mfma_f32_16x16x32_bf16 v[24:27], a[104:107], v[56:59], v[24:27]
    v_mfma_f32_16x16x32_bf16 v[28:31], a[108:111], v[56:59], v[28:31]
    v_mfma_f32_16x16x32_bf16 v[16:19], a[112:115], v[60:63], v[16:19]
    v_mfma_f32_16x16x32_bf16 v[20:23], a[116:119], v[60:63], v[20:23]
    v_mfma_f32_16x16x32_bf16 v[24:27], a[120:123], v[60:63], v[24:27]
    v_mfma_f32_16x16x32_bf16 v[28:31], a[124:127], v[60:63], v[28:31]
    s_waitcnt vmcnt(14)
    s_barrier
    ds_read_b64_tr_b16 v[64:65], v220 offset:32768
    ds_read_b64_tr_b16 v[66:67], v221 offset:32768
    ds_read_b64_tr_b16 v[68:69], v220 offset:36864
    ds_read_b64_tr_b16 v[70:71], v221 offset:36864
    ds_read_b64_tr_b16 v[72:73], v220 offset:40960
    ds_read_b64_tr_b16 v[74:75], v221 offset:40960
    ds_read_b64_tr_b16 v[76:77], v220 offset:45056
    ds_read_b64_tr_b16 v[78:79], v221 offset:45056
    ds_read_b64_tr_b16 v[80:81], v220 offset:49152
    ds_read_b64_tr_b16 v[82:83], v221 offset:49152
    ds_read_b64_tr_b16 v[84:85], v220 offset:53248
    ds_read_b64_tr_b16 v[86:87], v221 offset:53248
    ds_read_b64_tr_b16 v[88:89], v220 offset:57344
    ds_read_b64_tr_b16 v[90:91], v221 offset:57344
    s_waitcnt lgkmcnt(12)
    ds_read_b64_tr_b16 v[92:93], v220 offset:61440
    ds_read_b64_tr_b16 v[94:95], v221 offset:61440
    s_waitcnt vmcnt(0)
    v_mov_b32 v217, 4
    s_mov_b64 exec, 1
    buffer_store_dword v217, off, s[4:7], s30 sc1
    s_mov_b64 exec, -1
    v_cvt_pk_bf16_f32 v192, v16, v17
    v_cvt_pk_bf16_f32 v193, v24, v25
    v_cvt_pk_bf16_f32 v194, v18, v19
    v_cvt_pk_bf16_f32 v195, v26, v27
    v_cvt_pk_bf16_f32 v196, v20, v21
    v_cvt_pk_bf16_f32 v197, v28, v29
    v_cvt_pk_bf16_f32 v198, v22, v23
    v_cvt_pk_bf16_f32 v199, v30, v31
    buffer_store_dwordx4 v[192:195], v12, s[4:7], s32 offen sc1
    buffer_store_dwordx4 v[196:199], v12, s[4:7], s32 offen offset:1024 sc1
    s_mul_i32 s27, s55, 57344
    s_add_u32 s32, s34, s27
    s_waitcnt lgkmcnt(0)
    v_mfma_f32_16x16x32_bf16 v[16:19], a[0:3], v[64:67], 0
    v_mfma_f32_16x16x32_bf16 v[20:23], a[4:7], v[64:67], 0
    v_mfma_f32_16x16x32_bf16 v[24:27], a[8:11], v[64:67], 0
    v_mfma_f32_16x16x32_bf16 v[28:31], a[12:15], v[64:67], 0
    v_mfma_f32_16x16x32_bf16 v[16:19], a[16:19], v[68:71], v[16:19]
    v_mfma_f32_16x16x32_bf16 v[20:23], a[20:23], v[68:71], v[20:23]
    v_mfma_f32_16x16x32_bf16 v[24:27], a[24:27], v[68:71], v[24:27]
    v_mfma_f32_16x16x32_bf16 v[28:31], a[28:31], v[68:71], v[28:31]
    v_mfma_f32_16x16x32_bf16 v[16:19], a[32:35], v[72:75], v[16:19]
    v_mfma_f32_16x16x32_bf16 v[20:23], a[36:39], v[72:75], v[20:23]
    v_mfma_f32_16x16x32_bf16 v[24:27], a[40:43], v[72:75], v[24:27]
    v_mfma_f32_16x16x32_bf16 v[28:31], a[44:47], v[72:75], v[28:31]
    v_mfma_f32_16x16x32_bf16 v[16:19], a[48:51], v[76:79], v[16:19]
    v_mfma_f32_16x16x32_bf16 v[20:23], a[52:55], v[76:79], v[20:23]
    v_mfma_f32_16x16x32_bf16 v[24:27], a[56:59], v[76:79], v[24:27]
    v_mfma_f32_16x16x32_bf16 v[28:31], a[60:63], v[76:79], v[28:31]
    v_mfma_f32_16x16x32_bf16 v[16:19], a[64:67], v[80:83], v[16:19]
    v_mfma_f32_16x16x32_bf16 v[20:23], a[68:71], v[80:83], v[20:23]
    v_mfma_f32_16x16x32_bf16 v[24:27], a[72:75], v[80:83], v[24:27]
    v_mfma_f32_16x16x32_bf16 v[28:31], a[76:79], v[80:83], v[28:31]
    v_mfma_f32_16x16x32_bf16 v[16:19], a[80:83], v[84:87], v[16:19]
    v_mfma_f32_16x16x32_bf16 v[20:23], a[84:87], v[84:87], v[20:23]
    v_mfma_f32_16x16x32_bf16 v[24:27], a[88:91], v[84:87], v[24:27]
    v_mfma_f32_16x16x32_bf16 v[28:31], a[92:95], v[84:87], v[28:31]
    v_mfma_f32_16x16x32_bf16 v[16:19], a[96:99], v[88:91], v[16:19]
    v_mfma_f32_16x16x32_bf16 v[20:23], a[100:103], v[88:91], v[20:23]
    v_mfma_f32_16x16x32_bf16 v[24:27], a[104:107], v[88:91], v[24:27]
    v_mfma_f32_16x16x32_bf16 v[28:31], a[108:111], v[88:91], v[28:31]
    v_mfma_f32_16x16x32_bf16 v[16:19], a[112:115], v[92:95], v[16:19]
    v_mfma_f32_16x16x32_bf16 v[20:23], a[116:119], v[92:95], v[20:23]
    v_mfma_f32_16x16x32_bf16 v[24:27], a[120:123], v[92:95], v[24:27]
    v_mfma_f32_16x16x32_bf16 v[28:31], a[124:127], v[92:95], v[28:31]
    s_waitcnt vmcnt(6)
    s_barrier
    ds_read_b64_tr_b16 v[96:97], v222 offset:0
    ds_read_b64_tr_b16 v[98:99], v223 offset:0
    ds_read_b64_tr_b16 v[100:101], v222 offset:4096
    ds_read_b64_tr_b16 v[102:103], v223 offset:4096
    ds_read_b64_tr_b16 v[104:105], v222 offset:8192
    ds_read_b64_tr_b16 v[106:107], v223 offset:8192
    ds_read_b64_tr_b16 v[108:109], v222 offset:12288
    ds_read_b64_tr_b16 v[110:111], v223 offset:12288
    ds_read_b64_tr_b16 v[112:113], v222 offset:16384
    ds_read_b64_tr_b16 v[114:115], v223 offset:16384
    ds_read_b64_tr_b16 v[116:117], v222 offset:20480
    ds_read_b64_tr_b16 v[118:119], v223 offset:20480
    ds_read_b64_tr_b16 v[120:121], v222 offset:24576
    ds_read_b64_tr_b16 v[122:123], v223 offset:24576
    s_waitcnt lgkmcnt(12)
    ds_read_b64_tr_b16 v[124:125], v222 offset:28672
    ds_read_b64_tr_b16 v[126:127], v223 offset:28672
    s_waitcnt vmcnt(0)
    v_mov_b32 v218, 5
    s_mov_b64 exec, 1
    buffer_store_dword v218, off, s[4:7], s30 sc1
    s_mov_b64 exec, -1
    v_cvt_pk_bf16_f32 v200, v16, v17
    v_cvt_pk_bf16_f32 v201, v24, v25
    v_cvt_pk_bf16_f32 v202, v18, v19
    v_cvt_pk_bf16_f32 v203, v26, v27
    v_cvt_pk_bf16_f32 v204, v20, v21
    v_cvt_pk_bf16_f32 v205, v28, v29
    v_cvt_pk_bf16_f32 v206, v22, v23
    v_cvt_pk_bf16_f32 v207, v30, v31
    buffer_store_dwordx4 v[200:203], v12, s[4:7], s32 offen sc1
    buffer_store_dwordx4 v[204:207], v12, s[4:7], s32 offen offset:1024 sc1
    s_mul_i32 s27, s56, 57344
    s_add_u32 s32, s34, s27
    s_waitcnt lgkmcnt(0)
    v_mfma_f32_16x16x32_bf16 v[16:19], a[0:3], v[96:99], 0
    v_mfma_f32_16x16x32_bf16 v[20:23], a[4:7], v[96:99], 0
    v_mfma_f32_16x16x32_bf16 v[24:27], a[8:11], v[96:99], 0
    v_mfma_f32_16x16x32_bf16 v[28:31], a[12:15], v[96:99], 0
    v_mfma_f32_16x16x32_bf16 v[16:19], a[16:19], v[100:103], v[16:19]
    v_mfma_f32_16x16x32_bf16 v[20:23], a[20:23], v[100:103], v[20:23]
    v_mfma_f32_16x16x32_bf16 v[24:27], a[24:27], v[100:103], v[24:27]
    v_mfma_f32_16x16x32_bf16 v[28:31], a[28:31], v[100:103], v[28:31]
    v_mfma_f32_16x16x32_bf16 v[16:19], a[32:35], v[104:107], v[16:19]
    v_mfma_f32_16x16x32_bf16 v[20:23], a[36:39], v[104:107], v[20:23]
    v_mfma_f32_16x16x32_bf16 v[24:27], a[40:43], v[104:107], v[24:27]
    v_mfma_f32_16x16x32_bf16 v[28:31], a[44:47], v[104:107], v[28:31]
    v_mfma_f32_16x16x32_bf16 v[16:19], a[48:51], v[108:111], v[16:19]
    v_mfma_f32_16x16x32_bf16 v[20:23], a[52:55], v[108:111], v[20:23]
    v_mfma_f32_16x16x32_bf16 v[24:27], a[56:59], v[108:111], v[24:27]
    v_mfma_f32_16x16x32_bf16 v[28:31], a[60:63], v[108:111], v[28:31]
    v_mfma_f32_16x16x32_bf16 v[16:19], a[64:67], v[112:115], v[16:19]
    v_mfma_f32_16x16x32_bf16 v[20:23], a[68:71], v[112:115], v[20:23]
    v_mfma_f32_16x16x32_bf16 v[24:27], a[72:75], v[112:115], v[24:27]
    v_mfma_f32_16x16x32_bf16 v[28:31], a[76:79], v[112:115], v[28:31]
    v_mfma_f32_16x16x32_bf16 v[16:19], a[80:83], v[116:119], v[16:19]
    v_mfma_f32_16x16x32_bf16 v[20:23], a[84:87], v[116:119], v[20:23]
    v_mfma_f32_16x16x32_bf16 v[24:27], a[88:91], v[116:119], v[24:27]
    v_mfma_f32_16x16x32_bf16 v[28:31], a[92:95], v[116:119], v[28:31]
    v_mfma_f32_16x16x32_bf16 v[16:19], a[96:99], v[120:123], v[16:19]
    v_mfma_f32_16x16x32_bf16 v[20:23], a[100:103], v[120:123], v[20:23]
    v_mfma_f32_16x16x32_bf16 v[24:27], a[104:107], v[120:123], v[24:27]
    v_mfma_f32_16x16x32_bf16 v[28:31], a[108:111], v[120:123], v[28:31]
    v_mfma_f32_16x16x32_bf16 v[16:19], a[112:115], v[124:127], v[16:19]
    v_mfma_f32_16x16x32_bf16 v[20:23], a[116:119], v[124:127], v[20:23]
    v_mfma_f32_16x16x32_bf16 v[24:27], a[120:123], v[124:127], v[24:27]
    v_mfma_f32_16x16x32_bf16 v[28:31], a[124:127], v[124:127], v[28:31]
    s_nop 6
    v_cvt_pk_bf16_f32 v208, v16, v17
    v_cvt_pk_bf16_f32 v209, v24, v25
    v_cvt_pk_bf16_f32 v210, v18, v19
    v_cvt_pk_bf16_f32 v211, v26, v27
    v_cvt_pk_bf16_f32 v212, v20, v21
    v_cvt_pk_bf16_f32 v213, v28, v29
    v_cvt_pk_bf16_f32 v214, v22, v23
    v_cvt_pk_bf16_f32 v215, v30, v31
    buffer_store_dwordx4 v[208:211], v12, s[4:7], s32 offen sc1
    buffer_store_dwordx4 v[212:215], v12, s[4:7], s32 offen offset:1024 sc1
    s_branch J_tail
J_tail:
    s_waitcnt vmcnt(5)
    v_mov_b32 v218, 5
    s_mov_b64 exec, 1
    buffer_store_dword v218, off, s[4:7], s30 sc1
    s_mov_b64 exec, -1
    s_cmp_lt_u32 s65, 5
    s_cbranch_scc1 J_t1
    v_lshlrev_b32 v32, 16, v230
    v_and_b32 v33, 0xffff0000, v230
    v_lshlrev_b32 v34, 16, v231
    v_and_b32 v35, 0xffff0000, v231
    v_lshlrev_b32 v36, 16, v232
    v_and_b32 v37, 0xffff0000, v232
    v_lshlrev_b32 v38, 16, v233
    v_and_b32 v39, 0xffff0000, v233
    v_lshlrev_b32 v40, 16, v234
    v_and_b32 v41, 0xffff0000, v234
    v_lshlrev_b32 v42, 16, v235
    v_and_b32 v43, 0xffff0000, v235
    v_lshlrev_b32 v44, 16, v236
    v_and_b32 v45, 0xffff0000, v236
    v_lshlrev_b32 v46, 16, v237
    v_and_b32 v47, 0xffff0000, v237
    v_lshlrev_b32 v48, 16, v238
    v_and_b32 v49, 0xffff0000, v238
    v_lshlrev_b32 v50, 16, v239
    v_and_b32 v51, 0xffff0000, v239
    v_lshlrev_b32 v52, 16, v240
    v_and_b32 v53, 0xffff0000, v240
    v_lshlrev_b32 v54, 16, v241
    v_and_b32 v55, 0xffff0000, v241
    v_lshlrev_b32 v56, 16, v242
    v_and_b32 v57, 0xffff0000, v242
    v_lshlrev_b32 v58, 16, v243
    v_and_b32 v59, 0xffff0000, v243
    v_mov_b32 v16, v32
    v_mov_b32 v17, v33
    v_mov_b32 v18, v34
    v_mov_b32 v19, v35
    v_add_f32 v16, v16, v36
    v_add_f32 v17, v17, v37
    v_add_f32 v18, v18, v38
    v_add_f32 v19, v19, v39
    v_add_f32 v16, v16, v40
    v_add_f32 v17, v17, v41
    v_add_f32 v18, v18, v42
    v_add_f32 v19, v19, v43
    v_add_f32 v16, v16, v44
    v_add_f32 v17, v17, v45
    v_add_f32 v18, v18, v46
    v_add_f32 v19, v19, v47
    v_add_f32 v16, v16, v48
    v_add_f32 v17, v17, v49
    v_add_f32 v18, v18, v50
    v_add_f32 v19, v19, v51
    v_add_f32 v16, v16, v52
    v_add_f32 v17, v17, v53
    v_add_f32 v18, v18, v54
    v_add_f32 v19, v19, v55
    v_add_f32 v16, v16, v56
    v_add_f32 v17, v17, v57
    v_add_f32 v18, v18, v58
    v_add_f32 v19, v19, v59
    v_add_f32 v16, v16, v17
    v_add_f32 v18, v18, v19
    v_add_f32 v16, v16, v18
    s_nop 1
    v_add_f32_dpp v16, v16, v16 row_ror:8 row_mask:0xf bank_mask:0xf
    s_nop 1
    v_add_f32_dpp v16, v16, v16 row_ror:4 row_mask:0xf bank_mask:0xf
    s_nop 1
    v_add_f32_dpp v16, v16, v16 row_ror:2 row_mask:0xf bank_mask:0xf
    s_nop 1
    v_add_f32_dpp v16, v16, v16 row_ror:1 row_mask:0xf bank_mask:0xf
    v_mul_f32 v20, 0x3b124925, v16
    v_sub_f32 v21, v32, v20
    v_mul_f32 v16, v21, v21
    v_sub_f32 v21, v33, v20
    v_mul_f32 v17, v21, v21
    v_sub_f32 v21, v34, v20
    v_mul_f32 v18, v21, v21
    v_sub_f32 v21, v35, v20
    v_mul_f32 v19, v21, v21
    v_sub_f32 v21, v36, v20
    v_fmac_f32 v16, v21, v21
    v_sub_f32 v22, v37, v20
    v_fmac_f32 v17, v22, v22
    v_sub_f32 v21, v38, v20
    v_fmac_f32 v18, v21, v21
    v_sub_f32 v22, v39, v20
    v_fmac_f32 v19, v22, v22
    v_sub_f32 v21, v40, v20
    v_fmac_f32 v16, v21, v21
    v_sub_f32 v22, v41, v20
    v_fmac_f32 v17, v22, v22
    v_sub_f32 v21, v42, v20
    v_fmac_f32 v18, v21, v21
    v_sub_f32 v22, v43, v20
    v_fmac_f32 v19, v22, v22
    v_sub_f32 v21, v44, v20
    v_fmac_f32 v16, v21, v21
    v_sub_f32 v22, v45, v20
    v_fmac_f32 v17, v22, v22
    v_sub_f32 v21, v46, v20
    v_fmac_f32 v18, v21, v21
    v_sub_f32 v22, v47, v20
    v_fmac_f32 v19, v22, v22
    v_sub_f32 v21, v48, v20
    v_fmac_f32 v16, v21, v21
    v_sub_f32 v22, v49, v20
    v_fmac_f32 v17, v22, v22
    v_sub_f32 v21, v50, v20
    v_fmac_f32 v18, v21, v21
    v_sub_f32 v22, v51, v20
    v_fmac_f32 v19, v22, v22
    v_sub_f32 v21, v52, v20
    v_fmac_f32 v16, v21, v21
    v_sub_f32 v22, v53, v20
    v_fmac_f32 v17, v22, v22
    v_sub_f32 v21, v54, v20
    v_fmac_f32 v18, v21, v21
    v_sub_f32 v22, v55, v20
    v_fmac_f32 v19, v22, v22
    v_sub_f32 v21, v56, v20
    v_fmac_f32 v16, v21, v21
    v_sub_f32 v22, v57, v20
    v_fmac_f32 v17, v22, v22
    v_sub_f32 v21, v58, v20
    v_fmac_f32 v18, v21, v21
    v_sub_f32 v22, v59, v20
    v_fmac_f32 v19, v22, v22
    v_add_f32 v16, v16, v17
    v_add_f32 v18, v18, v19
    v_add_f32 v16, v16, v18
    s_nop 1
    v_add_f32_dpp v16, v16, v16 row_ror:8 row_mask:0xf bank_mask:0xf
    s_nop 1
    v_add_f32_dpp v16, v16, v16 row_ror:4 row_mask:0xf bank_mask:0xf
    s_nop 1
    v_add_f32_dpp v16, v16, v16 row_ror:2 row_mask:0xf bank_mask:0xf
    s_nop 1
    v_add_f32_dpp v16, v16, v16 row_ror:1 row_mask:0xf bank_mask:0xf
    v_mul_f32 v16, 0x3b124925, v16
    v_cvt_pk_bf16_f32 v16, v16, v16
    v_lshlrev_b32 v16, 16, v16
    v_add_f32 v16, 0x3727c5ac, v16
    v_cvt_pk_bf16_f32 v16, v16, v16
    v_lshlrev_b32 v16, 16, v16
    v_sqrt_f32 v16, v16
    s_nop 0
    v_cvt_pk_bf16_f32 v16, v16, v16
    v_lshlrev_b32 v16, 16, v16
    v_rcp_f32 v16, v16
    v_cvt_pk_bf16_f32 v20, v20, v20
    v_lshlrev_b32 v20, 16, v20
J_t1:
    s_waitcnt vmcnt(3)
    v_mov_b32 v217, 6
    s_mov_b64 exec, 1
    buffer_store_dword v217, off, s[4:7], s30 sc1
    s_mov_b64 exec, -1
    s_cmp_lt_u32 s65, 5
    s_cbranch_scc1 J_t2
    s_lshl_b32 s26, s20, 2
    v_add_u32 v13, s26, v11
    v_lshrrev_b32 v14, 1, v13
    v_lshrrev_b32 v15, 1, v10
    v_xor_b32 v14, v14, v15
    v_mul_u32_u24 v13, 0x380, v13
    v_lshl_add_u32 v13, v14, 4, v13
    v_and_b32 v14, 1, v10
    v_lshl_add_u32 v13, v14, 3, v13
    v_sub_f32 v32, v32, v20
    v_sub_f32 v33, v33, v20
    v_cvt_pk_bf16_f32 v21, v32, v33
    v_lshlrev_b32 v32, 16, v21
    v_and_b32 v33, 0xffff0000, v21
    v_mul_f32 v32, v16, v32
    v_mul_f32 v33, v16, v33
    v_cvt_pk_bf16_f32 v230, v32, v33
    v_sub_f32 v34, v34, v20
    v_sub_f32 v35, v35, v20
    v_cvt_pk_bf16_f32 v21, v34, v35
    v_lshlrev_b32 v34, 16, v21
    v_and_b32 v35, 0xffff0000, v21
    v_mul_f32 v34, v16, v34
    v_mul_f32 v35, v16, v35
    v_cvt_pk_bf16_f32 v231, v34, v35
    ds_write_b64 v13, v[230:231] offset:0
    v_sub_f32 v36, v36, v20
    v_sub_f32 v37, v37, v20
    v_cvt_pk_bf16_f32 v21, v36, v37
    v_lshlrev_b32 v36, 16, v21
    v_and_b32 v37, 0xffff0000, v21
    v_mul_f32 v36, v16, v36
    v_mul_f32 v37, v16, v37
    v_cvt_pk_bf16_f32 v232, v36, v37
    v_sub_f32 v38, v38, v20
    v_sub_f32 v39, v39, v20
    v_cvt_pk_bf16_f32 v21, v38, v39
    v_lshlrev_b32 v38, 16, v21
    v_and_b32 v39, 0xffff0000, v21
    v_mul_f32 v38, v16, v38
    v_mul_f32 v39, v16, v39
    v_cvt_pk_bf16_f32 v233, v38, v39
    ds_write_b64 v13, v[232:233] offset:128
    v_sub_f32 v40, v40, v20
    v_sub_f32 v41, v41, v20
    v_cvt_pk_bf16_f32 v21, v40, v41
    v_lshlrev_b32 v40, 16, v21
    v_and_b32 v41, 0xffff0000, v21
    v_mul_f32 v40, v16, v40
    v_mul_f32 v41, v16, v41
    v_cvt_pk_bf16_f32 v234, v40, v41
    v_sub_f32 v42, v42, v20
    v_sub_f32 v43, v43, v20
    v_cvt_pk_bf16_f32 v21, v42, v43
    v_lshlrev_b32 v42, 16, v21
    v_and_b32 v43, 0xffff0000, v21
    v_mul_f32 v42, v16, v42
    v_mul_f32 v43, v16, v43
    v_cvt_pk_bf16_f32 v235, v42, v43
    ds_write_b64 v13, v[234:235] offset:256
    v_sub_f32 v44, v44, v20
    v_sub_f32 v45, v45, v20
    v_cvt_pk_bf16_f32 v21, v44, v45
    v_lshlrev_b32 v44, 16, v21
    v_and_b32 v45, 0xffff0000, v21
    v_mul_f32 v44, v16, v44
    v_mul_f32 v45, v16, v45
    v_cvt_pk_bf16_f32 v236, v44, v45
    v_sub_f32 v46, v46, v20
    v_sub_f32 v47, v47, v20
    v_cvt_pk_bf16_f32 v21, v46, v47
    v_lshlrev_b32 v46, 16, v21
    v_and_b32 v47, 0xffff0000, v21
    v_mul_f32 v46, v16, v46
    v_mul_f32 v47, v16, v47
    v_cvt_pk_bf16_f32 v237, v46, v47
    ds_write_b64 v13, v[236:237] offset:384
    v_sub_f32 v48, v48, v20
    v_sub_f32 v49, v49, v20
    v_cvt_pk_bf16_f32 v21, v48, v49
    v_lshlrev_b32 v48, 16, v21
    v_and_b32 v49, 0xffff0000, v21
    v_mul_f32 v48, v16, v48
    v_mul_f32 v49, v16, v49
    v_cvt_pk_bf16_f32 v238, v48, v49
    v_sub_f32 v50, v50, v20
    v_sub_f32 v51, v51, v20
    v_cvt_pk_bf16_f32 v21, v50, v51
    v_lshlrev_b32 v50, 16, v21
    v_and_b32 v51, 0xffff0000, v21
    v_mul_f32 v50, v16, v50
    v_mul_f32 v51, v16, v51
    v_cvt_pk_bf16_f32 v239, v50, v51
    ds_write_b64 v13, v[238:239] offset:512
    v_sub_f32 v52, v52, v20
    v_sub_f32 v53, v53, v20
    v_cvt_pk_bf16_f32 v21, v52, v53
    v_lshlrev_b32 v52, 16, v21
    v_and_b32 v53, 0xffff0000, v21
    v_mul_f32 v52, v16, v52
    v_mul_f32 v53, v16, v53
    v_cvt_pk_bf16_f32 v240, v52, v53
    v_sub_f32 v54, v54, v20
    v_sub_f32 v55, v55, v20
    v_cvt_pk_bf16_f32 v21, v54, v55
    v_lshlrev_b32 v54, 16, v21
    v_and_b32 v55, 0xffff0000, v21
    v_mul_f32 v54, v16, v54
    v_mul_f32 v55, v16, v55
    v_cvt_pk_bf16_f32 v241, v54, v55
    ds_write_b64 v13, v[240:241] offset:640
    v_sub_f32 v56, v56, v20
    v_sub_f32 v57, v57, v20
    v_cvt_pk_bf16_f32 v21, v56, v57
    v_lshlrev_b32 v56, 16, v21
    v_and_b32 v57, 0xffff0000, v21
    v_mul_f32 v56, v16, v56
    v_mul_f32 v57, v16, v57
    v_cvt_pk_bf16_f32 v242, v56, v57
    v_sub_f32 v58, v58, v20
    v_sub_f32 v59, v59, v20
    v_cvt_pk_bf16_f32 v21, v58, v59
    v_lshlrev_b32 v58, 16, v21
    v_and_b32 v59, 0xffff0000, v21
    v_mul_f32 v58, v16, v58
    v_mul_f32 v59, v16, v59
    v_cvt_pk_bf16_f32 v243, v58, v59
    ds_write_b64 v13, v[242:243] offset:768
    v_mul_u32_u24 v2, 0x380, v10
    v_lshrrev_b32 v3, 1, v10
    s_and_b32 s26, s20, 1
    s_waitcnt lgkmcnt(0)
    s_barrier
    s_cmp_ge_u32 s20, 2
    s_cbranch_scc1 J_k
    v_and_b32 v14, 1, v11
    v_lshl_add_u32 v2, v14, 3, v2
    v_lshrrev_b32 v14, 1, v11
    v_xor_b32 v3, v3, v14
    s_lshl_b32 s27, s26, 1
    v_xor_b32 v3, s27, v3
    v_lshl_add_u32 v4, v3, 4, v2
    v_xor_b32 v3, 4, v3
    v_lshl_add_u32 v5, v3, 4, v2
    ds_read_b64 v[32:33], v4 offset:0
    ds_read_b64 v[34:35], v5 offset:0
    ds_read_b64 v[36:37], v4 offset:128
    ds_read_b64 v[38:39], v5 offset:128
    ds_read_b64 v[40:41], v4 offset:256
    ds_read_b64 v[42:43], v5 offset:256
    ds_read_b64 v[44:45], v4 offset:384
    ds_read_b64 v[46:47], v5 offset:384
    ds_read_b64 v[48:49], v4 offset:512
    ds_read_b64 v[50:51], v5 offset:512
    ds_read_b64 v[52:53], v4 offset:640
    ds_read_b64 v[54:55], v5 offset:640
    ds_read_b64 v[56:57], v4 offset:768
    ds_read_b64 v[58:59], v5 offset:768
    s_mul_i32 s27, s64, 14336
    s_lshl_b32 s26, s26, 10
    s_add_u32 s26, s26, s27
    s_add_u32 s26, s26, 0xe00000
    s_waitcnt lgkmcnt(0)
    v_swap_b32 v33, v34
    v_swap_b32 v37, v38
    v_swap_b32 v41, v42
    v_swap_b32 v45, v46
    v_swap_b32 v49, v50
    v_swap_b32 v53, v54
    v_swap_b32 v57, v58
    s_waitcnt vmcnt(2)
    v_mov_b32 v218, 7
    s_mov_b64 exec, 1
    buffer_store_dword v218, off, s[4:7], s30 sc1
    s_mov_b64 exec, -1
    buffer_store_dwordx4 v[32:35], v12, s[4:7], s26 offen offset:0 sc1
    buffer_store_dwordx4 v[36:39], v12, s[4:7], s26 offen offset:2048 sc1
    s_add_u32 s26, s26, 4096
    buffer_store_dwordx4 v[40:43], v12, s[4:7], s26 offen offset:0 sc1
    buffer_store_dwordx4 v[44:47], v12, s[4:7], s26 offen offset:2048 sc1
    s_add_u32 s26, s26, 4096
    buffer_store_dwordx4 v[48:51], v12, s[4:7], s26 offen offset:0 sc1
    buffer_store_dwordx4 v[52:55], v12, s[4:7], s26 offen offset:2048 sc1
    s_add_u32 s26, s26, 4096
    buffer_store_dwordx4 v[56:59], v12, s[4:7], s26 offen offset:0 sc1
    s_branch J_t3
J_k:
    v_xor_b32 v3, v3, v11
    s_lshl_b32 s27, s26, 2
    v_xor_b32 v3, s27, v3
    v_lshl_add_u32 v4, v3, 4, v2
    ds_read_b128 v[32:35], v4 offset:0
    ds_read_b128 v[36:39], v4 offset:128
    ds_read_b128 v[40:43], v4 offset:256
    ds_read_b128 v[44:47], v4 offset:384
    ds_read_b128 v[48:51], v4 offset:512
    ds_read_b128 v[52:55], v4 offset:640
    ds_read_b128 v[56:59], v4 offset:768
    v_lshrrev_b32 v13, 1, v11
    v_and_b32 v14, 1, v11
    v_lshlrev_b32 v14, 9, v14
    v_lshl_add_u32 v14, v10, 4, v14
    v_lshl_add_u32 v14, v13, 10, v14
    s_lshr_b32 s27, s64, 1
    s_lshl_b32 s27, s27, 15
    s_and_b32 s28, s64, 1
    s_lshl_b32 s28, s28, 11
    s_add_u32 s27, s27, s28
    s_add_u32 s27, s27, 0x3dc8000
    s_lshl_b32 s28, s26, 10
    s_add_u32 s28, s28, s27
    s_lshl_b32 s29, s26, 13
    s_add_u32 s29, s29, s27
    s_lshl_b32 s31, s26, 14
    s_add_u32 s31, s31, s27
    s_waitcnt vmcnt(2)
    v_mov_b32 v218, 7
    s_mov_b64 exec, 1
    buffer_store_dword v218, off, s[4:7], s30 sc1
    s_mov_b64 exec, -1
    s_waitcnt lgkmcnt(0)
    s_add_u32 s27, s28, 0
    buffer_store_dwordx4 v[32:35], v12, s[4:7], s27 offen sc1
    s_add_u32 s27, s28, 8192
    buffer_store_dwordx4 v[36:39], v12, s[4:7], s27 offen sc1
    s_add_u32 s27, s28, 16384
    buffer_store_dwordx4 v[40:43], v12, s[4:7], s27 offen sc1
    s_add_u32 s27, s28, 24576
    buffer_store_dwordx4 v[44:47], v12, s[4:7], s27 offen sc1
    s_add_u32 s27, s29, 4096
    buffer_store_dwordx4 v[48:51], v14, s[4:7], s27 offen sc1
    s_add_u32 s27, s29, 20480
    buffer_store_dwordx4 v[52:55], v14, s[4:7], s27 offen sc1
    s_add_u32 s27, s31, 4352
    buffer_store_dwordx4 v[56:59], v14, s[4:7], s27 offen sc1
    s_add_u32 s27, s31, 12544
    buffer_store_dwordx4 v[56:59], v14, s[4:7], s27 offen sc1
J_t3:
    s_waitcnt vmcnt(0)
    s_barrier
    s_cmp_lg_u32 s20, 0
    s_cbranch_scc1 J_t4
    s_lshl_b32 s30, s64, 2
    s_add_u32 s30, s30, 0x3fcc000
    v_mov_b32 v2, 1
    s_mov_b64 exec, 1
    buffer_store_dword v2, off, s[4:7], s30 sc1
    s_mov_b64 exec, -1
J_t4:
    s_branch M_roles
J_t2:
    s_waitcnt vmcnt(2)
    v_mov_b32 v218, 7
    s_mov_b64 exec, 1
    buffer_store_dword v218, off, s[4:7], s30 sc1
    s_mov_b64 exec, -1
    s_barrier
    s_branch M_roles
.section .rodata,"a"
.p2align 6
.amdhsa_kernel parallel_sum__memory_aug_recurrent_mem_tr__dense_activation_silu__prompt_kernel
  .amdhsa_next_free_vgpr 512
  .amdhsa_next_free_sgpr 102
  .amdhsa_accum_offset 256
  .amdhsa_group_segment_fixed_size 0
  .amdhsa_kernarg_size 104
  .amdhsa_user_sgpr_count 2
  .amdhsa_user_sgpr_kernarg_segment_ptr 1
  .amdhsa_system_sgpr_workgroup_id_x 1
.end_amdhsa_kernel
```
